```python
import torch

def _softmax(x, axis=-1):
    return torch.softmax(x, dim=axis)
def _gelu(x):
    return torch.nn.functional.gelu(x, approximate="tanh")
def _silu(x):
    return torch.nn.functional.silu(x)
def _sigmoid(x):
    return torch.sigmoid(x)
def _layernorm(x, axis=-1, eps=1e-5):
    m = x.mean(dim=axis, keepdim=True)
    v = x.var(dim=axis, keepdim=True, unbiased=False)
    return (x - m) / torch.sqrt(v + eps)
def _scatter_add(tgt, idx, src, axis=0):
    return tgt.clone().index_add_(axis, idx, src)
def _segment_sum(src, seg, n):
    out = torch.zeros((n,) + src.shape[1:], dtype=src.dtype)
    return out.index_add_(0, seg, src)
def _pad(x, pw):
    flat = tuple(v for pair in reversed(pw) for v in pair)
    return torch.nn.functional.pad(x, flat)

kernel_name = 'sequential_preLN__linear_attn_block__dense_activation_squared_relu__prompt'

def setup_inputs():

    _w = (lambda a: (lambda t: t.to(torch.bfloat16) if t.is_floating_point() else t)(torch.as_tensor(a)))
    def _A_setup():
        B, S, D = 1, 2048, 576
        return {
            "x": _w((lambda *s: torch.randn(*s, dtype=torch.bfloat16) * 0.05)(B, S, D)),
            "wqkv": _w((lambda *s: torch.randn(*s, dtype=torch.bfloat16) * 0.1)(D, 3 * D)),
            "wo": _w((lambda *s: torch.randn(*s, dtype=torch.bfloat16) * 0.05)(D, D)),
        }
    _A_in = _A_setup()

    def _B_setup():
        B, S, D, F = 1, 2048, 576, 4608
        return {
            "x": _w((lambda *s: torch.randn(*s, dtype=torch.bfloat16) * 0.05)(B, S, D)),
            "w1": _w((lambda *s: torch.randn(*s, dtype=torch.bfloat16) * 0.05)(D, F)),
            "b1": _w((lambda *s: torch.randn(*s, dtype=torch.bfloat16) * 0.2)(F)),
            "w2": _w((lambda *s: torch.randn(*s, dtype=torch.bfloat16) * 0.05)(F, D)),
            "b2": _w((lambda *s: torch.randn(*s, dtype=torch.bfloat16) * 1.6)(D)),
        }
    _B_in = _B_setup()

    return {
        "A_x": _A_in["x"],
        "A_wqkv": _A_in["wqkv"],
        "A_wo": _A_in["wo"],
        "B_x": _B_in["x"],
        "B_w1": _B_in["w1"],
        "B_b1": _B_in["b1"],
        "B_w2": _B_in["w2"],
        "B_b2": _B_in["b2"],
    }

def reference(A_x, A_wqkv, A_wo, B_x, B_w1, B_b1, B_w2, B_b2):
    def _A_ref(x, wqkv, wo):
        B, S, D = x.shape
        H = 32; Dh = D // H
        qkv = (lambda x, *d: x.permute(*d))((x @ wqkv).reshape(B, S, 3, H, Dh), 2, 0, 3, 1, 4)
        q, k, v = qkv[0], qkv[1], qkv[2]
        phi = lambda t: torch.where(t > 0, t + 1, torch.exp(t)) + 1e-6
        pq, pk = phi(q), phi(k)
        kv = torch.einsum("bhsd,bhse->bhde", pk, v)
        z = torch.einsum("bhsd->bhd", pk)
        num = torch.einsum("bhqd,bhde->bhqe", pq, kv)
        den = torch.einsum("bhqd,bhd->bhq", pq, z)[..., None] + 1e-6
        o = num / den
        return (lambda x, *d: x.permute(*d))(o, 0, 2, 1, 3).reshape(B, S, D) @ wo

    def _B_ref(x, w1, b1, w2, b2):
        h = torch.einsum("bsd,df->bsf", x, w1) + b1
        zero = torch.zeros_like(h)
        r = torch.where(h > zero, h, zero)
        h = r * r
        out = torch.einsum("bsf,fd->bsd", h, w2) + b2
        return out

    x = A_x
    h = x + _A_ref(_layernorm(x, axis=-1), A_wqkv, A_wo)
    h2 = h + _B_ref(_layernorm(h, axis=-1), B_w1, B_b1, B_w2, B_b2)
    return h2
```

```asm
; @launch grid=(256,1,1) block=(256,1,1) lds=163840
.amdgcn_target "amdgcn-amd-amdhsa--gfx950"
.text
.globl sequential_preLN__linear_attn_block__dense_activation_squared_relu__prompt_kernel
.p2align 8
.type sequential_preLN__linear_attn_block__dense_activation_squared_relu__prompt_kernel,@function
sequential_preLN__linear_attn_block__dense_activation_squared_relu__prompt_kernel:
    s_cmp_ge_u32 s2, 256
    s_cbranch_scc1 L_end
    s_load_dwordx16 s[64:79], s[0:1], 0
    s_load_dwordx4 s[96:99], s[0:1], 64
    s_load_dwordx2 s[100:101], s[0:1], 80
    v_lshrrev_b32 v1, 6, v0
    v_and_b32 v248, 63, v0
    v_readfirstlane_b32 s20, v1
    v_and_b32 v249, 15, v248
    v_lshrrev_b32 v250, 4, v248
    v_lshlrev_b32 v251, 4, v248
    s_and_b32 s21, s2, 7
    s_lshr_b32 s22, s2, 3
    s_mov_b32 s60, 0x3fb8aa3b
    s_mov_b32 s61, 0x3fb8aa3b
    s_mov_b32 s62, 0x358637bd
    s_mov_b32 s63, 0x358637bd
    s_mov_b32 s58, 0x3f803f80
    s_mov_b32 s59, 0xffff0000
    s_getpc_b64 s[50:51]
L_pc0:
    s_sub_u32 s50, s50, L_pc0-sequential_preLN__linear_attn_block__dense_activation_squared_relu__prompt_kernel
    s_subb_u32 s51, s51, 0
    s_lshl_b32 s24, s22, 2
    s_add_u32 s24, s24, s20
    v_min_u32 v246, 3, v248
    v_lshl_add_u32 v246, s24, 2, v246
    v_lshlrev_b32 v246, 7, v246
    v_min_u32 v246, L_end-sequential_preLN__linear_attn_block__dense_activation_squared_relu__prompt_kernel, v246
    global_load_dword v247, v246, s[50:51]
    s_lshr_b32 s31, s22, 3
    s_cmp_eq_u32 s31, 3
    s_cbranch_scc1 L_pack
    s_lshr_b32 s24, s21, 1
    s_lshl_b32 s24, s24, 2
    s_and_b32 s27, s21, 1
    s_cmp_eq_u32 s31, 2
    s_cbranch_scc1 L_decq
    s_lshr_b32 s25, s22, 2
    s_and_b32 s26, s22, 3
    s_lshl_b32 s29, s27, 2
    s_add_u32 s29, s29, s26
    s_mul_i32 s39, s29, 144
    s_add_u32 s39, s39, 1152
    s_branch L_decd
L_decq:
    s_bfe_u32 s25, s22, 0x20001
    s_and_b32 s26, s22, 1
    s_lshl_b32 s29, s27, 1
    s_add_u32 s29, s29, s26
    s_mul_i32 s39, s29, 288
    s_add_u32 s26, s26, 4
L_decd:
    s_add_u32 s28, s24, s25
    s_mul_i32 s25, s25, 9
    s_lshr_b32 s25, s25, 2
    s_mul_i32 s26, s26, 3
    s_lshr_b32 s26, s26, 1
    s_add_u32 s25, s25, s26
    s_sub_u32 s26, s25, 9
    s_cmp_ge_u32 s25, 9
    s_cselect_b32 s37, s26, s25
    s_lshl_b32 s24, s28, 2
    s_add_u32 s24, s24, s20
    s_mul_i32 s38, s24, 36864
    v_lshrrev_b32 v208, 3, v248
    v_and_b32 v209, 7, v248
    v_xor_b32 v209, v209, v250
    v_mul_u32_u24 v208, 1152, v208
    v_lshl_add_u32 v124, v209, 4, v208
    v_xor_b32 v209, 4, v209
    v_lshl_add_u32 v125, v209, 4, v208
    v_add_u32 v125, 9216, v125
    v_add_u32 v126, 18432, v124
    v_add_u32 v127, 18432, v125
    s_lshl_b32 s34, s20, 12
    s_mul_i32 s36, s20, 512
    s_add_u32 s36, s36, 12288
    s_cmp_eq_u32 s31, 2
    s_cselect_b32 s26, 0, 1008
    s_lshl_b32 s25, s20, 4
    v_add_u32 v208, 0, v248
    v_mul_u32_u24 v209, 3641, v208
    v_lshrrev_b32 v209, 16, v209
    v_mul_u32_u24 v210, 18, v209
    v_sub_u32 v210, v208, v210
    v_add_u32 v209, s25, v209
    v_and_b32 v211, 51, v209
    v_bfe_u32 v212, v209, 2, 1
    v_lshl_add_u32 v211, v212, 3, v211
    v_bfe_u32 v212, v209, 3, 1
    v_lshl_add_u32 v211, v212, 2, v211
    v_cmp_le_u32 vcc, 9, v210
    v_mul_u32_u24 v211, 3456, v211
    v_lshl_add_u32 v211, v210, 4, v211
    v_add_u32 v212, s26, v211
    v_cndmask_b32 v128, v211, v212, vcc
    v_add_u32 v208, 64, v248
    v_mul_u32_u24 v209, 3641, v208
    v_lshrrev_b32 v209, 16, v209
    v_mul_u32_u24 v210, 18, v209
    v_sub_u32 v210, v208, v210
    v_add_u32 v209, s25, v209
    v_and_b32 v211, 51, v209
    v_bfe_u32 v212, v209, 2, 1
    v_lshl_add_u32 v211, v212, 3, v211
    v_bfe_u32 v212, v209, 3, 1
    v_lshl_add_u32 v211, v212, 2, v211
    v_cmp_le_u32 vcc, 9, v210
    v_mul_u32_u24 v211, 3456, v211
    v_lshl_add_u32 v211, v210, 4, v211
    v_add_u32 v212, s26, v211
    v_cndmask_b32 v129, v211, v212, vcc
    s_waitcnt lgkmcnt(0)
    s_mov_b32 s4, s64
    s_mov_b32 s5, s65
    s_mov_b32 s6, 0x240000
    s_mov_b32 s7, 0x20000
    s_mov_b32 s8, s66
    s_mov_b32 s9, s67
    s_mov_b32 s10, 0x1e6000
    s_mov_b32 s11, 0x20000
    s_mov_b32 s12, s100
    s_mov_b32 s13, s101
    s_mov_b32 s14, 0x2800000
    s_mov_b32 s15, 0x20000
    s_lshl_b32 s32, s37, 7
    s_add_u32 s32, s32, s38
    s_mul_i32 s33, s37, 221184
    s_add_u32 s33, s33, s39
    s_mov_b32 m0, s34
    s_add_u32 s37, s37, 1
    s_cmp_eq_u32 s37, 9
    s_cselect_b32 s37, 0, s37
    s_add_u32 s34, s34, 34816
    s_sub_u32 s24, s34, 139264
    s_cmp_ge_u32 s34, 139264
    s_cselect_b32 s34, s24, s34
    buffer_load_dwordx4 v124, s[4:7], s32 offen lds
    s_add_u32 m0, m0, 0x400
    s_nop 0
    buffer_load_dwordx4 v125, s[4:7], s32 offen lds
    s_add_u32 m0, m0, 0x400
    s_nop 0
    buffer_load_dwordx4 v126, s[4:7], s32 offen lds
    s_add_u32 m0, m0, 0x400
    s_nop 0
    buffer_load_dwordx4 v127, s[4:7], s32 offen lds
    s_add_u32 m0, m0, 0x400
    s_add_u32 m0, m0, s36
    s_nop 0
    buffer_load_dwordx4 v128, s[8:11], s33 offen lds
    s_add_u32 m0, m0, 0x400
    s_nop 0
    buffer_load_dwordx4 v129, s[8:11], s33 offen lds
    s_add_u32 m0, m0, 0x400
    s_nop 0
    v_add_u32 v208, 128, v248
    v_mul_u32_u24 v209, 3641, v208
    v_lshrrev_b32 v209, 16, v209
    v_mul_u32_u24 v210, 18, v209
    v_sub_u32 v210, v208, v210
    v_add_u32 v209, s25, v209
    v_and_b32 v211, 51, v209
    v_bfe_u32 v212, v209, 2, 1
    v_lshl_add_u32 v211, v212, 3, v211
    v_bfe_u32 v212, v209, 3, 1
    v_lshl_add_u32 v211, v212, 2, v211
    v_cmp_le_u32 vcc, 9, v210
    v_mul_u32_u24 v211, 3456, v211
    v_lshl_add_u32 v211, v210, 4, v211
    v_add_u32 v212, s26, v211
    v_cndmask_b32 v130, v211, v212, vcc
    buffer_load_dwordx4 v130, s[8:11], s33 offen lds
    s_add_u32 m0, m0, 0x400
    v_add_u32 v208, 192, v248
    v_mul_u32_u24 v209, 3641, v208
    v_lshrrev_b32 v209, 16, v209
    v_mul_u32_u24 v210, 18, v209
    v_sub_u32 v210, v208, v210
    v_add_u32 v209, s25, v209
    v_and_b32 v211, 51, v209
    v_bfe_u32 v212, v209, 2, 1
    v_lshl_add_u32 v211, v212, 3, v211
    v_bfe_u32 v212, v209, 3, 1
    v_lshl_add_u32 v211, v212, 2, v211
    v_cmp_le_u32 vcc, 9, v210
    v_mul_u32_u24 v211, 3456, v211
    v_lshl_add_u32 v211, v210, 4, v211
    v_add_u32 v212, s26, v211
    v_cndmask_b32 v131, v211, v212, vcc
    buffer_load_dwordx4 v131, s[8:11], s33 offen lds
    s_add_u32 m0, m0, 0x400
    v_add_u32 v208, 256, v248
    v_mul_u32_u24 v209, 3641, v208
    v_lshrrev_b32 v209, 16, v209
    v_mul_u32_u24 v210, 18, v209
    v_sub_u32 v210, v208, v210
    v_add_u32 v209, s25, v209
    v_and_b32 v211, 51, v209
    v_bfe_u32 v212, v209, 2, 1
    v_lshl_add_u32 v211, v212, 3, v211
    v_bfe_u32 v212, v209, 3, 1
    v_lshl_add_u32 v211, v212, 2, v211
    v_cmp_le_u32 vcc, 9, v210
    v_mul_u32_u24 v211, 3456, v211
    v_lshl_add_u32 v211, v210, 4, v211
    v_add_u32 v212, s26, v211
    v_cndmask_b32 v132, v211, v212, vcc
    s_mov_b32 exec_hi, 0
    buffer_load_dwordx4 v132, s[8:11], s33 offen lds
    s_mov_b32 exec_hi, -1
    v_lshrrev_b32 v208, 3, v249
    s_lshl_b32 s32, s37, 7
    s_add_u32 s32, s32, s38
    s_mul_i32 s33, s37, 221184
    s_add_u32 s33, s33, s39
    s_mov_b32 m0, s34
    s_add_u32 s37, s37, 1
    s_cmp_eq_u32 s37, 9
    s_cselect_b32 s37, 0, s37
    s_add_u32 s34, s34, 34816
    s_sub_u32 s24, s34, 139264
    s_cmp_ge_u32 s34, 139264
    s_cselect_b32 s34, s24, s34
    v_lshlrev_b32 v208, 10, v208
    v_and_b32 v209, 7, v249
    v_lshl_add_u32 v208, v209, 7, v208
    v_lshrrev_b32 v209, 1, v249
    v_xor_b32 v209, v209, v250
    v_lshl_add_u32 v208, v209, 4, v208
    s_lshl_b32 s25, s20, 12
    v_add_u32 v133, s25, v208
    v_xor_b32 v134, 64, v133
    v_lshrrev_b32 v208, 1, v250
    v_lshlrev_b32 v208, 4, v208
    v_and_b32 v209, 1, v250
    v_lshl_add_u32 v208, v209, 2, v208
    v_lshrrev_b32 v209, 2, v249
    v_add_u32 v208, v208, v209
    v_and_b32 v209, 3, v249
    v_lshlrev_b32 v209, 3, v209
    v_mul_u32_u24 v135, 288, v208
    v_add_u32 v135, v135, v209
    v_add_u32 v135, 16384, v135
    v_mov_b32 v0, 0
    v_mov_b32 v1, 0
    v_mov_b32 v2, 0
    v_mov_b32 v3, 0
    v_mov_b32 v4, 0
    v_mov_b32 v5, 0
    v_mov_b32 v6, 0
    v_mov_b32 v7, 0
    v_mov_b32 v8, 0
    v_mov_b32 v9, 0
    v_mov_b32 v10, 0
    v_mov_b32 v11, 0
    v_mov_b32 v12, 0
    v_mov_b32 v13, 0
    v_mov_b32 v14, 0
    v_mov_b32 v15, 0
    v_mov_b32 v16, 0
    v_mov_b32 v17, 0
    v_mov_b32 v18, 0
    v_mov_b32 v19, 0
    v_mov_b32 v20, 0
    v_mov_b32 v21, 0
    buffer_load_dwordx4 v124, s[4:7], s32 offen lds
    s_add_u32 m0, m0, 0x400
    v_mov_b32 v22, 0
    v_mov_b32 v23, 0
    v_mov_b32 v24, 0
    v_mov_b32 v25, 0
    v_mov_b32 v26, 0
    v_mov_b32 v27, 0
    v_mov_b32 v28, 0
    v_mov_b32 v29, 0
    v_mov_b32 v30, 0
    v_mov_b32 v31, 0
    v_mov_b32 v32, 0
    v_mov_b32 v33, 0
    v_mov_b32 v34, 0
    v_mov_b32 v35, 0
    v_mov_b32 v36, 0
    v_mov_b32 v37, 0
    v_mov_b32 v38, 0
    v_mov_b32 v39, 0
    v_mov_b32 v40, 0
    v_mov_b32 v41, 0
    v_mov_b32 v42, 0
    v_mov_b32 v43, 0
    v_mov_b32 v44, 0
    v_mov_b32 v45, 0
    v_mov_b32 v46, 0
    v_mov_b32 v47, 0
    v_mov_b32 v48, 0
    v_mov_b32 v49, 0
    v_mov_b32 v50, 0
    v_mov_b32 v51, 0
    v_mov_b32 v52, 0
    v_mov_b32 v53, 0
    v_mov_b32 v54, 0
    v_mov_b32 v55, 0
    v_mov_b32 v56, 0
    v_mov_b32 v57, 0
    v_mov_b32 v58, 0
    v_mov_b32 v59, 0
    v_mov_b32 v60, 0
    v_mov_b32 v61, 0
    v_mov_b32 v62, 0
    v_mov_b32 v63, 0
    buffer_load_dwordx4 v125, s[4:7], s32 offen lds
    s_add_u32 m0, m0, 0x400
    v_mov_b32 v64, 0
    v_mov_b32 v65, 0
    v_mov_b32 v66, 0
    v_mov_b32 v67, 0
    v_mov_b32 v68, 0
    v_mov_b32 v69, 0
    v_mov_b32 v70, 0
    v_mov_b32 v71, 0
    v_mov_b32 v96, 0
    v_mov_b32 v97, 0
    v_mov_b32 v98, 0
    v_mov_b32 v99, 0
    v_mov_b32 v100, 0
    v_mov_b32 v101, 0
    v_mov_b32 v102, 0
    v_mov_b32 v103, 0
    v_mov_b32 v104, 0
    v_mov_b32 v105, 0
    v_mov_b32 v106, 0
    v_mov_b32 v107, 0
    v_mov_b32 v116, 0
    v_mov_b32 v117, 0
    v_mov_b32 v118, 0
    v_mov_b32 v119, 0
    v_mov_b32 v120, 0
    v_mov_b32 v121, 0
    v_mov_b32 v122, 0
    v_mov_b32 v123, 0
    v_mov_b32 v136, s58
    v_mov_b32 v203, 0
    v_cmp_gt_u32 s[48:49], 8, v249
    s_mov_b32 s30, 0
    s_mov_b32 s16, s98
    s_mov_b32 s17, s99
    s_mov_b32 s18, 0x100
    s_mov_b32 s19, 0x20000
    v_mul_u32_u24 v192, 336, v249
    v_lshl_add_u32 v192, v250, 4, v192
    s_mul_i32 s25, s20, 26880
    s_add_u32 s25, s25, 34816
    v_add_u32 v192, s25, v192
    s_mul_i32 s26, s20, 72
    s_add_u32 s26, s26, 34816
    s_mul_i32 s25, s20, 18
    s_add_u32 s25, s25, 8
    v_add_u32 v208, 0, v248
    v_mul_u32_u24 v209, 3641, v208
    v_lshrrev_b32 v209, 16, v209
    v_mul_u32_u24 v210, 18, v209
    v_sub_u32 v210, v208, v210
    v_add_u32 v209, s25, v209
    v_mul_u32_u24 v209, 336, v209
    v_lshl_add_u32 v209, v210, 2, v209
    buffer_load_dwordx4 v126, s[4:7], s32 offen lds
    s_add_u32 m0, m0, 0x400
    v_add_u32 v194, s26, v209
    v_add_u32 v208, 64, v248
    v_mul_u32_u24 v209, 3641, v208
    v_lshrrev_b32 v209, 16, v209
    v_mul_u32_u24 v210, 18, v209
    v_sub_u32 v210, v208, v210
    v_add_u32 v209, s25, v209
    v_mul_u32_u24 v209, 336, v209
    v_lshl_add_u32 v209, v210, 2, v209
    v_add_u32 v195, s26, v209
    v_add_u32 v208, 128, v248
    v_mul_u32_u24 v209, 3641, v208
    v_lshrrev_b32 v209, 16, v209
    v_mul_u32_u24 v210, 18, v209
    v_sub_u32 v210, v208, v210
    v_add_u32 v209, s25, v209
    v_mul_u32_u24 v209, 336, v209
    v_lshl_add_u32 v209, v210, 2, v209
    v_add_u32 v196, s26, v209
    v_add_u32 v208, 192, v248
    v_mul_u32_u24 v209, 3641, v208
    v_lshrrev_b32 v209, 16, v209
    v_mul_u32_u24 v210, 18, v209
    v_sub_u32 v210, v208, v210
    v_add_u32 v209, s25, v209
    v_mul_u32_u24 v209, 336, v209
    v_lshl_add_u32 v209, v210, 2, v209
    v_add_u32 v197, s26, v209
    v_add_u32 v208, 256, v248
    v_mul_u32_u24 v209, 3641, v208
    v_lshrrev_b32 v209, 16, v209
    v_mul_u32_u24 v210, 18, v209
    v_sub_u32 v210, v208, v210
    v_add_u32 v209, s25, v209
    v_mul_u32_u24 v209, 336, v209
    v_lshl_add_u32 v209, v210, 2, v209
    v_add_u32 v198, s26, v209
    v_add_u32 v208, 320, v248
    v_mul_u32_u24 v209, 3641, v208
    v_lshrrev_b32 v209, 16, v209
    v_mul_u32_u24 v210, 18, v209
    v_sub_u32 v210, v208, v210
    buffer_load_dwordx4 v127, s[4:7], s32 offen lds
    s_add_u32 m0, m0, 0x400
    s_add_u32 m0, m0, s36
    v_cmp_gt_u32 vcc, 18, v209
    v_add_u32 v209, s25, v209
    s_nop 0
    v_cndmask_b32 v209, 0, v209, vcc
    v_mul_u32_u24 v209, 336, v209
    v_lshl_add_u32 v209, v210, 2, v209
    v_add_u32 v199, s26, v209
    s_mul_i32 s41, s20, 12288
    v_lshlrev_b32 v208, 1, v248
    v_add_u32 v208, 0, v208
    v_mul_u32_u24 v209, 7282, v208
    v_lshrrev_b32 v209, 16, v209
    v_mul_u32_u24 v210, 3450, v209
    v_lshrrev_b32 v210, 16, v210
    v_add_u32 v208, v208, v210
    v_mul_u32_u24 v209, 11, v209
    v_add_u32 v208, v208, v209
    v_lshl_add_u32 v216, v208, 2, s41
    v_lshlrev_b32 v208, 1, v248
    v_add_u32 v208, 1, v208
    v_mul_u32_u24 v209, 7282, v208
    v_lshrrev_b32 v209, 16, v209
    v_mul_u32_u24 v210, 3450, v209
    v_lshrrev_b32 v210, 16, v210
    v_add_u32 v208, v208, v210
    v_mul_u32_u24 v209, 11, v209
    v_add_u32 v208, v208, v209
    v_lshl_add_u32 v217, v208, 2, s41
    v_lshlrev_b32 v208, 1, v248
    v_add_u32 v208, 128, v208
    v_mul_u32_u24 v209, 7282, v208
    v_lshrrev_b32 v209, 16, v209
    v_mul_u32_u24 v210, 3450, v209
    v_lshrrev_b32 v210, 16, v210
    v_add_u32 v208, v208, v210
    v_mul_u32_u24 v209, 11, v209
    v_add_u32 v208, v208, v209
    v_lshl_add_u32 v218, v208, 2, s41
    v_lshlrev_b32 v208, 1, v248
    v_add_u32 v208, 129, v208
    v_mul_u32_u24 v209, 7282, v208
    v_lshrrev_b32 v209, 16, v209
    v_mul_u32_u24 v210, 3450, v209
    v_lshrrev_b32 v210, 16, v210
    buffer_load_dwordx4 v128, s[8:11], s33 offen lds
    s_add_u32 m0, m0, 0x400
    v_add_u32 v208, v208, v210
    v_mul_u32_u24 v209, 11, v209
    v_add_u32 v208, v208, v209
    v_lshl_add_u32 v219, v208, 2, s41
    v_lshlrev_b32 v208, 1, v248
    v_add_u32 v208, 256, v208
    v_mul_u32_u24 v209, 7282, v208
    v_lshrrev_b32 v209, 16, v209
    v_mul_u32_u24 v210, 3450, v209
    v_lshrrev_b32 v210, 16, v210
    v_add_u32 v208, v208, v210
    v_mul_u32_u24 v209, 11, v209
    v_add_u32 v208, v208, v209
    v_lshl_add_u32 v220, v208, 2, s41
    v_lshlrev_b32 v208, 1, v248
    v_add_u32 v208, 257, v208
    v_mul_u32_u24 v209, 7282, v208
    v_lshrrev_b32 v209, 16, v209
    v_mul_u32_u24 v210, 3450, v209
    v_lshrrev_b32 v210, 16, v210
    v_add_u32 v208, v208, v210
    v_mul_u32_u24 v209, 11, v209
    v_add_u32 v208, v208, v209
    v_lshl_add_u32 v221, v208, 2, s41
    v_lshlrev_b32 v208, 1, v248
    v_add_u32 v208, 384, v208
    v_mul_u32_u24 v209, 7282, v208
    v_lshrrev_b32 v209, 16, v209
    v_mul_u32_u24 v210, 3450, v209
    v_lshrrev_b32 v210, 16, v210
    v_add_u32 v208, v208, v210
    v_mul_u32_u24 v209, 11, v209
    v_add_u32 v208, v208, v209
    v_lshl_add_u32 v222, v208, 2, s41
    v_lshlrev_b32 v208, 1, v248
    v_add_u32 v208, 385, v208
    v_mul_u32_u24 v209, 7282, v208
    v_lshrrev_b32 v209, 16, v209
    v_mul_u32_u24 v210, 3450, v209
    v_lshrrev_b32 v210, 16, v210
    v_add_u32 v208, v208, v210
    v_mul_u32_u24 v209, 11, v209
    buffer_load_dwordx4 v129, s[8:11], s33 offen lds
    s_add_u32 m0, m0, 0x400
    v_add_u32 v208, v208, v209
    v_lshl_add_u32 v223, v208, 2, s41
    v_lshlrev_b32 v208, 1, v248
    v_add_u32 v208, 512, v208
    v_mul_u32_u24 v209, 7282, v208
    v_lshrrev_b32 v209, 16, v209
    v_mul_u32_u24 v210, 3450, v209
    v_lshrrev_b32 v210, 16, v210
    v_add_u32 v208, v208, v210
    v_mul_u32_u24 v209, 11, v209
    v_add_u32 v208, v208, v209
    v_lshl_add_u32 v224, v208, 2, s41
    v_lshlrev_b32 v208, 1, v248
    v_add_u32 v208, 513, v208
    v_mul_u32_u24 v209, 7282, v208
    v_lshrrev_b32 v209, 16, v209
    v_mul_u32_u24 v210, 3450, v209
    v_lshrrev_b32 v210, 16, v210
    v_add_u32 v208, v208, v210
    v_mul_u32_u24 v209, 11, v209
    v_add_u32 v208, v208, v209
    v_lshl_add_u32 v225, v208, 2, s41
    v_lshlrev_b32 v208, 1, v248
    v_add_u32 v208, 640, v208
    v_mul_u32_u24 v209, 7282, v208
    v_lshrrev_b32 v209, 16, v209
    v_mul_u32_u24 v210, 3450, v209
    v_lshrrev_b32 v210, 16, v210
    v_add_u32 v208, v208, v210
    v_mul_u32_u24 v209, 11, v209
    v_add_u32 v208, v208, v209
    v_lshl_add_u32 v226, v208, 2, s41
    v_lshlrev_b32 v208, 1, v248
    v_add_u32 v208, 641, v208
    v_mul_u32_u24 v209, 7282, v208
    v_lshrrev_b32 v209, 16, v209
    v_mul_u32_u24 v210, 3450, v209
    v_lshrrev_b32 v210, 16, v210
    v_add_u32 v208, v208, v210
    v_mul_u32_u24 v209, 11, v209
    v_add_u32 v208, v208, v209
    buffer_load_dwordx4 v130, s[8:11], s33 offen lds
    s_add_u32 m0, m0, 0x400
    v_lshl_add_u32 v227, v208, 2, s41
    v_lshlrev_b32 v208, 1, v248
    v_add_u32 v208, 768, v208
    v_mul_u32_u24 v209, 7282, v208
    v_lshrrev_b32 v209, 16, v209
    v_mul_u32_u24 v210, 3450, v209
    v_lshrrev_b32 v210, 16, v210
    v_add_u32 v208, v208, v210
    v_mul_u32_u24 v209, 11, v209
    v_add_u32 v208, v208, v209
    v_lshl_add_u32 v228, v208, 2, s41
    v_lshlrev_b32 v208, 1, v248
    v_add_u32 v208, 769, v208
    v_mul_u32_u24 v209, 7282, v208
    v_lshrrev_b32 v209, 16, v209
    v_mul_u32_u24 v210, 3450, v209
    v_lshrrev_b32 v210, 16, v210
    v_add_u32 v208, v208, v210
    v_mul_u32_u24 v209, 11, v209
    v_add_u32 v208, v208, v209
    v_lshl_add_u32 v229, v208, 2, s41
    v_lshlrev_b32 v208, 1, v248
    v_add_u32 v208, 896, v208
    v_mul_u32_u24 v209, 7282, v208
    v_lshrrev_b32 v209, 16, v209
    v_mul_u32_u24 v210, 3450, v209
    v_lshrrev_b32 v210, 16, v210
    v_add_u32 v208, v208, v210
    v_mul_u32_u24 v209, 11, v209
    v_add_u32 v208, v208, v209
    v_lshl_add_u32 v230, v208, 2, s41
    v_lshlrev_b32 v208, 1, v248
    v_add_u32 v208, 897, v208
    v_mul_u32_u24 v209, 7282, v208
    v_lshrrev_b32 v209, 16, v209
    v_mul_u32_u24 v210, 3450, v209
    v_lshrrev_b32 v210, 16, v210
    v_add_u32 v208, v208, v210
    v_mul_u32_u24 v209, 11, v209
    v_add_u32 v208, v208, v209
    v_lshl_add_u32 v231, v208, 2, s41
    v_lshlrev_b32 v208, 1, v248
    buffer_load_dwordx4 v131, s[8:11], s33 offen lds
    s_add_u32 m0, m0, 0x400
    v_add_u32 v208, 1024, v208
    v_mul_u32_u24 v209, 7282, v208
    v_lshrrev_b32 v209, 16, v209
    v_mul_u32_u24 v210, 3450, v209
    v_lshrrev_b32 v210, 16, v210
    v_add_u32 v208, v208, v210
    v_mul_u32_u24 v209, 11, v209
    v_add_u32 v208, v208, v209
    v_lshl_add_u32 v232, v208, 2, s41
    v_lshlrev_b32 v208, 1, v248
    v_add_u32 v208, 1025, v208
    v_mul_u32_u24 v209, 7282, v208
    v_lshrrev_b32 v209, 16, v209
    v_mul_u32_u24 v210, 3450, v209
    v_lshrrev_b32 v210, 16, v210
    v_add_u32 v208, v208, v210
    v_mul_u32_u24 v209, 11, v209
    v_add_u32 v208, v208, v209
    v_lshl_add_u32 v233, v208, 2, s41
    v_lshlrev_b32 v208, 1, v248
    v_add_u32 v208, 1152, v208
    v_mul_u32_u24 v209, 7282, v208
    v_lshrrev_b32 v209, 16, v209
    v_mul_u32_u24 v210, 3450, v209
    v_lshrrev_b32 v210, 16, v210
    v_add_u32 v208, v208, v210
    v_mul_u32_u24 v209, 11, v209
    v_add_u32 v208, v208, v209
    v_lshl_add_u32 v234, v208, 2, s41
    v_lshlrev_b32 v208, 1, v248
    v_add_u32 v208, 1153, v208
    v_mul_u32_u24 v209, 7282, v208
    v_lshrrev_b32 v209, 16, v209
    v_mul_u32_u24 v210, 3450, v209
    v_lshrrev_b32 v210, 16, v210
    v_add_u32 v208, v208, v210
    v_mul_u32_u24 v209, 11, v209
    v_add_u32 v208, v208, v209
    v_lshl_add_u32 v235, v208, 2, s41
    v_lshlrev_b32 v208, 1, v248
    v_add_u32 v208, 1280, v208
    s_mov_b32 exec_hi, 0
    buffer_load_dwordx4 v132, s[8:11], s33 offen lds
    s_mov_b32 exec_hi, -1
    v_mul_u32_u24 v209, 7282, v208
    v_lshrrev_b32 v209, 16, v209
    v_mul_u32_u24 v210, 3450, v209
    v_lshrrev_b32 v210, 16, v210
    v_add_u32 v208, v208, v210
    v_mul_u32_u24 v209, 11, v209
    v_add_u32 v208, v208, v209
    v_lshl_add_u32 v236, v208, 2, s41
    v_lshlrev_b32 v208, 1, v248
    v_add_u32 v208, 1281, v208
    v_mul_u32_u24 v209, 7282, v208
    v_lshrrev_b32 v209, 16, v209
    v_mul_u32_u24 v210, 3450, v209
    v_lshrrev_b32 v210, 16, v210
    v_add_u32 v208, v208, v210
    v_mul_u32_u24 v209, 11, v209
    v_add_u32 v208, v208, v209
    v_lshl_add_u32 v237, v208, 2, s41
    v_and_b32 v208, 31, v248
    v_lshrrev_b32 v209, 3, v208
    v_and_b32 v210, 3, v208
    v_lshl_add_u32 v209, v209, 2, v210
    v_bfe_u32 v210, v208, 2, 1
    v_mad_u32_u24 v210, v210, 9, v209
    v_cmp_gt_u32 vcc, 9, v209
    v_mov_b32 v211, 18
    s_nop 0
    v_cndmask_b32 v210, v211, v210, vcc
    v_mul_u32_u24 v238, 80, v210
    v_lshrrev_b32 v211, 5, v248
    v_lshl_add_u32 v238, v211, 4, v238
    v_add_u32 v238, s41, v238
    v_bfe_u32 v208, v248, 4, 1
    v_mul_u32_u24 v239, 18432, v208
    v_lshl_add_u32 v239, v249, 4, v239
    v_lshl_add_u32 v239, v211, 8, v239
    s_mul_i32 s25, s20, 4608
    s_add_u32 s25, s25, 49152
    v_add_u32 v239, s25, v239
    v_xor_b32 v208, s20, v250
    v_and_b32 v208, 1, v208
    v_lshl_add_u32 v208, v208, 4, v249
    v_mul_u32_u24 v246, 1152, v208
    v_lshrrev_b32 v208, 1, v250
    v_lshl_add_u32 v246, v208, 4, v246
    s_cmp_eq_u32 s31, 2
    s_cbranch_scc1 L_q
L_kv:
    v_lshlrev_b32 v200, 4, v250
    v_lshlrev_b32 v201, 2, v249
    v_add_u32 v202, 2016, v201
    v_cndmask_b32 v202, v202, v201, s[48:49]
    s_mov_b32 s35, 7
    s_waitcnt vmcnt(9)
.p2align 3
L_kv_a:
    s_barrier
    ds_read_b128 v[108:111], v133 offset:0
    ds_read_b128 v[112:115], v133 offset:2048
    ds_read_b64_tr_b16 v[72:73], v135 offset:0
    ds_read_b64_tr_b16 v[74:75], v135 offset:2304
    ds_read_b64_tr_b16 v[76:77], v135 offset:32
    ds_read_b64_tr_b16 v[78:79], v135 offset:2336
    ds_read_b64_tr_b16 v[80:81], v135 offset:64
    ds_read_b64_tr_b16 v[82:83], v135 offset:2368
    v_mfma_f32_16x16x32_bf16 v[48:51], v[116:119], v[96:99], v[48:51]
    ds_read_b64_tr_b16 v[84:85], v135 offset:96
    ds_read_b64_tr_b16 v[86:87], v135 offset:2400
    v_mfma_f32_16x16x32_bf16 v[52:55], v[120:123], v[96:99], v[52:55]
    s_lshl_b32 s32, s37, 7
    s_add_u32 s32, s32, s38
    s_mul_i32 s33, s37, 221184
    s_add_u32 s33, s33, s39
    s_mov_b32 m0, s34
    s_add_u32 s37, s37, 1
    s_cmp_eq_u32 s37, 9
    s_cselect_b32 s37, 0, s37
    s_add_u32 s34, s34, 34816
    s_sub_u32 s24, s34, 139264
    s_cmp_ge_u32 s34, 139264
    s_cselect_b32 s34, s24, s34
    v_mfma_f32_16x16x32_bf16 v[56:59], v[116:119], v[100:103], v[56:59]
    ds_read_b64_tr_b16 v[88:89], v135 offset:128
    ds_read_b64_tr_b16 v[90:91], v135 offset:2432
    v_mfma_f32_16x16x32_bf16 v[60:63], v[120:123], v[100:103], v[60:63]
    buffer_load_dwordx4 v124, s[4:7], s32 offen lds
    s_add_u32 m0, m0, 0x400
    v_mfma_f32_16x16x32_bf16 v[64:67], v[116:119], v[104:107], v[64:67]
    ds_read_b64_tr_b16 v[92:93], v135 offset:160
    ds_read_b64_tr_b16 v[94:95], v135 offset:2464
    v_mfma_f32_16x16x32_bf16 v[68:71], v[120:123], v[104:107], v[68:71]
    s_waitcnt lgkmcnt(10)
    v_mfma_f32_16x16x32_bf16 v[0:3], v[108:111], v[72:75], v[0:3]
    ds_read_b64_tr_b16 v[96:97], v135 offset:192
    ds_read_b64_tr_b16 v[98:99], v135 offset:2496
    v_mfma_f32_16x16x32_bf16 v[4:7], v[112:115], v[72:75], v[4:7]
    buffer_load_dwordx4 v125, s[4:7], s32 offen lds
    s_add_u32 m0, m0, 0x400
    s_waitcnt lgkmcnt(10)
    v_mfma_f32_16x16x32_bf16 v[8:11], v[108:111], v[76:79], v[8:11]
    ds_read_b64_tr_b16 v[100:101], v135 offset:224
    ds_read_b64_tr_b16 v[102:103], v135 offset:2528
    v_mfma_f32_16x16x32_bf16 v[12:15], v[112:115], v[76:79], v[12:15]
    s_waitcnt lgkmcnt(10)
    v_mfma_f32_16x16x32_bf16 v[16:19], v[108:111], v[80:83], v[16:19]
    ds_read_b64_tr_b16 v[104:105], v135 offset:256
    ds_read_b64_tr_b16 v[106:107], v135 offset:2560
    v_mfma_f32_16x16x32_bf16 v[20:23], v[112:115], v[80:83], v[20:23]
    buffer_load_dwordx4 v126, s[4:7], s32 offen lds
    s_add_u32 m0, m0, 0x400
    s_waitcnt lgkmcnt(10)
    v_mfma_f32_16x16x32_bf16 v[24:27], v[108:111], v[84:87], v[24:27]
    ds_read_b128 v[116:119], v134 offset:0
    ds_read_b128 v[120:123], v134 offset:2048
    v_mfma_f32_16x16x32_bf16 v[28:31], v[112:115], v[84:87], v[28:31]
    s_waitcnt lgkmcnt(10)
    v_mfma_f32_16x16x32_bf16 v[32:35], v[108:111], v[88:91], v[32:35]
    ds_read_b64_tr_b16 v[72:73], v135 offset:9216
    ds_read_b64_tr_b16 v[74:75], v135 offset:11520
    v_mfma_f32_16x16x32_bf16 v[36:39], v[112:115], v[88:91], v[36:39]
    buffer_load_dwordx4 v127, s[4:7], s32 offen lds
    s_add_u32 m0, m0, 0x400
    s_add_u32 m0, m0, s36
    s_waitcnt lgkmcnt(10)
    v_mfma_f32_16x16x32_bf16 v[40:43], v[108:111], v[92:95], v[40:43]
    ds_read_b64_tr_b16 v[76:77], v135 offset:9248
    ds_read_b64_tr_b16 v[78:79], v135 offset:11552
    v_mfma_f32_16x16x32_bf16 v[44:47], v[112:115], v[92:95], v[44:47]
    s_waitcnt lgkmcnt(10)
    v_mfma_f32_16x16x32_bf16 v[48:51], v[108:111], v[96:99], v[48:51]
    ds_read_b64_tr_b16 v[80:81], v135 offset:9280
    ds_read_b64_tr_b16 v[82:83], v135 offset:11584
    v_mfma_f32_16x16x32_bf16 v[52:55], v[112:115], v[96:99], v[52:55]
    buffer_load_dwordx4 v128, s[8:11], s33 offen lds
    s_add_u32 m0, m0, 0x400
    s_waitcnt lgkmcnt(10)
    v_mfma_f32_16x16x32_bf16 v[56:59], v[108:111], v[100:103], v[56:59]
    ds_read_b64_tr_b16 v[84:85], v135 offset:9312
    ds_read_b64_tr_b16 v[86:87], v135 offset:11616
    v_mfma_f32_16x16x32_bf16 v[60:63], v[112:115], v[100:103], v[60:63]
    s_waitcnt lgkmcnt(10)
    v_mfma_f32_16x16x32_bf16 v[64:67], v[108:111], v[104:107], v[64:67]
    ds_read_b64_tr_b16 v[88:89], v135 offset:9344
    ds_read_b64_tr_b16 v[90:91], v135 offset:11648
    v_mfma_f32_16x16x32_bf16 v[68:71], v[112:115], v[104:107], v[68:71]
    buffer_load_dwordx4 v129, s[8:11], s33 offen lds
    s_add_u32 m0, m0, 0x400
    s_waitcnt lgkmcnt(8)
    v_mfma_f32_16x16x32_bf16 v[0:3], v[116:119], v[72:75], v[0:3]
    ds_read_b64_tr_b16 v[92:93], v135 offset:9376
    ds_read_b64_tr_b16 v[94:95], v135 offset:11680
    v_mfma_f32_16x16x32_bf16 v[4:7], v[120:123], v[72:75], v[4:7]
    s_waitcnt lgkmcnt(8)
    v_mfma_f32_16x16x32_bf16 v[8:11], v[116:119], v[76:79], v[8:11]
    ds_read_b64_tr_b16 v[96:97], v135 offset:9408
    ds_read_b64_tr_b16 v[98:99], v135 offset:11712
    v_mfma_f32_16x16x32_bf16 v[12:15], v[120:123], v[76:79], v[12:15]
    buffer_load_dwordx4 v130, s[8:11], s33 offen lds
    s_add_u32 m0, m0, 0x400
    s_waitcnt lgkmcnt(8)
    v_mfma_f32_16x16x32_bf16 v[16:19], v[116:119], v[80:83], v[16:19]
    ds_read_b64_tr_b16 v[100:101], v135 offset:9440
    ds_read_b64_tr_b16 v[102:103], v135 offset:11744
    v_mfma_f32_16x16x32_bf16 v[20:23], v[120:123], v[80:83], v[20:23]
    s_waitcnt lgkmcnt(8)
    v_mfma_f32_16x16x32_bf16 v[24:27], v[116:119], v[84:87], v[24:27]
    ds_read_b64_tr_b16 v[104:105], v135 offset:9472
    ds_read_b64_tr_b16 v[106:107], v135 offset:11776
    v_mfma_f32_16x16x32_bf16 v[28:31], v[120:123], v[84:87], v[28:31]
    buffer_load_dwordx4 v131, s[8:11], s33 offen lds
    s_add_u32 m0, m0, 0x400
    s_waitcnt lgkmcnt(8)
    v_mfma_f32_16x16x32_bf16 v[32:35], v[116:119], v[88:91], v[32:35]
    v_mfma_f32_16x16x32_bf16 v[36:39], v[120:123], v[88:91], v[36:39]
    s_add_u32 s30, s30, 1
    s_and_b32 s30, s30, 3
    s_cmp_eq_u32 s30, 0
    s_cselect_b32 s25, 4294828032, 0
    s_add_u32 s25, s25, 34816
    s_waitcnt lgkmcnt(6)
    v_mfma_f32_16x16x32_bf16 v[40:43], v[116:119], v[92:95], v[40:43]
    v_mfma_f32_16x16x32_bf16 v[44:47], v[120:123], v[92:95], v[44:47]
    s_mov_b32 exec_hi, 0
    buffer_load_dwordx4 v132, s[8:11], s33 offen lds
    s_mov_b32 exec_hi, -1
    v_add_u32 v133, s25, v133
    v_add_u32 v134, s25, v134
    v_add_u32 v135, s25, v135
    s_sub_u32 s35, s35, 1
    s_cmp_lg_u32 s35, 0
    s_waitcnt vmcnt(9) lgkmcnt(0)
    s_cbranch_scc1 L_kv_a
    s_barrier
    ds_read_b128 v[108:111], v133 offset:0
    ds_read_b128 v[112:115], v133 offset:2048
    ds_read_b64_tr_b16 v[72:73], v135 offset:0
    ds_read_b64_tr_b16 v[74:75], v135 offset:2304
    ds_read_b64_tr_b16 v[76:77], v135 offset:32
    ds_read_b64_tr_b16 v[78:79], v135 offset:2336
    ds_read_b64_tr_b16 v[80:81], v135 offset:64
    ds_read_b64_tr_b16 v[82:83], v135 offset:2368
    v_mfma_f32_16x16x32_bf16 v[48:51], v[116:119], v[96:99], v[48:51]
    ds_read_b64_tr_b16 v[84:85], v135 offset:96
    ds_read_b64_tr_b16 v[86:87], v135 offset:2400
    v_mfma_f32_16x16x32_bf16 v[52:55], v[120:123], v[96:99], v[52:55]
    buffer_load_dword v204, v203, s[16:19], 0 offen sc1
    v_mfma_f32_16x16x32_bf16 v[56:59], v[116:119], v[100:103], v[56:59]
    ds_read_b64_tr_b16 v[88:89], v135 offset:128
    ds_read_b64_tr_b16 v[90:91], v135 offset:2432
    v_mfma_f32_16x16x32_bf16 v[60:63], v[120:123], v[100:103], v[60:63]
    v_mfma_f32_16x16x32_bf16 v[64:67], v[116:119], v[104:107], v[64:67]
    ds_read_b64_tr_b16 v[92:93], v135 offset:160
    ds_read_b64_tr_b16 v[94:95], v135 offset:2464
    v_mfma_f32_16x16x32_bf16 v[68:71], v[120:123], v[104:107], v[68:71]
    s_waitcnt lgkmcnt(10)
    v_mfma_f32_16x16x32_bf16 v[0:3], v[108:111], v[72:75], v[0:3]
    ds_read_b64_tr_b16 v[96:97], v135 offset:192
    ds_read_b64_tr_b16 v[98:99], v135 offset:2496
    v_mfma_f32_16x16x32_bf16 v[4:7], v[112:115], v[72:75], v[4:7]
    s_waitcnt lgkmcnt(10)
    v_mfma_f32_16x16x32_bf16 v[8:11], v[108:111], v[76:79], v[8:11]
    ds_read_b64_tr_b16 v[100:101], v135 offset:224
    ds_read_b64_tr_b16 v[102:103], v135 offset:2528
    v_mfma_f32_16x16x32_bf16 v[12:15], v[112:115], v[76:79], v[12:15]
    s_lshl_b32 s26, s28, 2
    s_add_u32 s26, s26, s20
    s_lshl_b32 s26, s26, 7
    s_add_u32 s32, s26, 131072
    s_add_u32 s33, s26, 139264
    s_mul_i32 s26, s29, 288
    s_add_u32 s34, s26, 99584
    s_waitcnt lgkmcnt(10)
    v_mfma_f32_16x16x32_bf16 v[16:19], v[108:111], v[80:83], v[16:19]
    ds_read_b64_tr_b16 v[104:105], v135 offset:256
    ds_read_b64_tr_b16 v[106:107], v135 offset:2560
    v_mfma_f32_16x16x32_bf16 v[20:23], v[112:115], v[80:83], v[20:23]
    s_waitcnt lgkmcnt(10)
    v_mfma_f32_16x16x32_bf16 v[24:27], v[108:111], v[84:87], v[24:27]
    ds_read_b128 v[116:119], v134 offset:0
    ds_read_b128 v[120:123], v134 offset:2048
    v_mfma_f32_16x16x32_bf16 v[28:31], v[112:115], v[84:87], v[28:31]
    s_waitcnt lgkmcnt(10)
    v_mfma_f32_16x16x32_bf16 v[32:35], v[108:111], v[88:91], v[32:35]
    ds_read_b64_tr_b16 v[72:73], v135 offset:9216
    ds_read_b64_tr_b16 v[74:75], v135 offset:11520
    v_mfma_f32_16x16x32_bf16 v[36:39], v[112:115], v[88:91], v[36:39]
    s_waitcnt lgkmcnt(10)
    v_mfma_f32_16x16x32_bf16 v[40:43], v[108:111], v[92:95], v[40:43]
    ds_read_b64_tr_b16 v[76:77], v135 offset:9248
    ds_read_b64_tr_b16 v[78:79], v135 offset:11552
    v_mfma_f32_16x16x32_bf16 v[44:47], v[112:115], v[92:95], v[44:47]
    s_mul_i32 s24, s22, 43
    s_lshr_b32 s24, s24, 8
    s_lshl_b32 s50, s21, 2
    s_add_u32 s50, s50, s24
    s_mul_i32 s24, s24, 6
    s_sub_u32 s51, s22, s24
    s_mul_i32 s24, s51, 6
    s_add_u32 s52, s24, s20
    s_and_b32 s25, s20, 1
    s_add_u32 s53, s24, s25
    s_add_u32 s53, s53, 4
    s_mul_i32 s54, s52, 18432
    s_add_u32 s54, s54, 7340032
    s_mul_i32 s55, s53, 18432
    s_add_u32 s55, s55, 7340032
    s_waitcnt lgkmcnt(10)
    v_mfma_f32_16x16x32_bf16 v[48:51], v[108:111], v[96:99], v[48:51]
    ds_read_b64_tr_b16 v[80:81], v135 offset:9280
    ds_read_b64_tr_b16 v[82:83], v135 offset:11584
    v_mfma_f32_16x16x32_bf16 v[52:55], v[112:115], v[96:99], v[52:55]
    s_waitcnt lgkmcnt(10)
    v_mfma_f32_16x16x32_bf16 v[56:59], v[108:111], v[100:103], v[56:59]
    ds_read_b64_tr_b16 v[84:85], v135 offset:9312
    ds_read_b64_tr_b16 v[86:87], v135 offset:11616
    v_mfma_f32_16x16x32_bf16 v[60:63], v[112:115], v[100:103], v[60:63]
    s_waitcnt lgkmcnt(10)
    v_mfma_f32_16x16x32_bf16 v[64:67], v[108:111], v[104:107], v[64:67]
    ds_read_b64_tr_b16 v[88:89], v135 offset:9344
    ds_read_b64_tr_b16 v[90:91], v135 offset:11648
    v_mfma_f32_16x16x32_bf16 v[68:71], v[112:115], v[104:107], v[68:71]
    s_waitcnt lgkmcnt(8)
    v_mfma_f32_16x16x32_bf16 v[0:3], v[116:119], v[72:75], v[0:3]
    ds_read_b64_tr_b16 v[92:93], v135 offset:9376
    ds_read_b64_tr_b16 v[94:95], v135 offset:11680
    v_mfma_f32_16x16x32_bf16 v[4:7], v[120:123], v[72:75], v[4:7]
    s_waitcnt lgkmcnt(8)
    v_mfma_f32_16x16x32_bf16 v[8:11], v[116:119], v[76:79], v[8:11]
    ds_read_b64_tr_b16 v[96:97], v135 offset:9408
    ds_read_b64_tr_b16 v[98:99], v135 offset:11712
    v_mfma_f32_16x16x32_bf16 v[12:15], v[120:123], v[76:79], v[12:15]
    s_waitcnt lgkmcnt(8)
    v_mfma_f32_16x16x32_bf16 v[16:19], v[116:119], v[80:83], v[16:19]
    ds_read_b64_tr_b16 v[100:101], v135 offset:9440
    ds_read_b64_tr_b16 v[102:103], v135 offset:11744
    v_mfma_f32_16x16x32_bf16 v[20:23], v[120:123], v[80:83], v[20:23]
    s_waitcnt lgkmcnt(8)
    v_mfma_f32_16x16x32_bf16 v[24:27], v[116:119], v[84:87], v[24:27]
    ds_read_b64_tr_b16 v[104:105], v135 offset:9472
    ds_read_b64_tr_b16 v[106:107], v135 offset:11776
    v_mfma_f32_16x16x32_bf16 v[28:31], v[120:123], v[84:87], v[28:31]
    s_waitcnt lgkmcnt(8)
    v_mfma_f32_16x16x32_bf16 v[32:35], v[116:119], v[88:91], v[32:35]
    v_mfma_f32_16x16x32_bf16 v[36:39], v[120:123], v[88:91], v[36:39]
    s_add_u32 s30, s30, 1
    s_and_b32 s30, s30, 3
    s_cmp_eq_u32 s30, 0
    s_cselect_b32 s25, 4294828032, 0
    s_add_u32 s25, s25, 34816
    s_waitcnt lgkmcnt(6)
    v_mfma_f32_16x16x32_bf16 v[40:43], v[116:119], v[92:95], v[40:43]
    v_mfma_f32_16x16x32_bf16 v[44:47], v[120:123], v[92:95], v[44:47]
    v_add_u32 v133, s25, v133
    v_add_u32 v134, s25, v134
    v_add_u32 v135, s25, v135
    s_waitcnt vmcnt(0)
    v_cmp_ne_u32 vcc, 1, v204
    s_nop 4
    s_cbranch_vccz L_kv_r0
    s_mov_b64 exec, 1
    s_mov_b32 s27, 0
L_poll1:
    buffer_load_dword v204, v203, s[16:19], 0 offen offset:0 sc1
    s_waitcnt vmcnt(0)
    v_cmp_ne_u32 vcc, 1, v204
    s_add_u32 s27, s27, 1
    s_nop 3
    s_cbranch_vccz L_poll1_done
    s_cmp_ge_u32 s27, 0x4000
    s_cbranch_scc1 L_poll1_done
    s_sleep 2
    s_branch L_poll1
L_poll1_done:
    s_mov_b64 exec, -1
L_kv_r0:
    s_waitcnt lgkmcnt(0)
    s_barrier
    ds_read_b128 v[108:111], v133 offset:0
    ds_read_b128 v[112:115], v133 offset:2048
    ds_read_b64_tr_b16 v[72:73], v135 offset:0
    ds_read_b64_tr_b16 v[74:75], v135 offset:2304
    ds_read_b64_tr_b16 v[76:77], v135 offset:32
    ds_read_b64_tr_b16 v[78:79], v135 offset:2336
    ds_read_b64_tr_b16 v[80:81], v135 offset:64
    ds_read_b64_tr_b16 v[82:83], v135 offset:2368
    v_mfma_f32_16x16x32_bf16 v[48:51], v[116:119], v[96:99], v[48:51]
    ds_read_b64_tr_b16 v[84:85], v135 offset:96
    ds_read_b64_tr_b16 v[86:87], v135 offset:2400
    v_mfma_f32_16x16x32_bf16 v[52:55], v[120:123], v[96:99], v[52:55]
    buffer_load_dwordx4 v[140:143], v200, s[12:15], s32 offen offset:0 sc1
    v_mfma_f32_16x16x32_bf16 v[56:59], v[116:119], v[100:103], v[56:59]
    ds_read_b64_tr_b16 v[88:89], v135 offset:128
    ds_read_b64_tr_b16 v[90:91], v135 offset:2432
    v_mfma_f32_16x16x32_bf16 v[60:63], v[120:123], v[100:103], v[60:63]
    buffer_load_dwordx4 v[148:151], v200, s[12:15], s33 offen offset:0 sc1
    v_mfma_f32_16x16x32_bf16 v[64:67], v[116:119], v[104:107], v[64:67]
    ds_read_b64_tr_b16 v[92:93], v135 offset:160
    ds_read_b64_tr_b16 v[94:95], v135 offset:2464
    v_mfma_f32_16x16x32_bf16 v[68:71], v[120:123], v[104:107], v[68:71]
    buffer_load_dwordx4 v[144:147], v200, s[12:15], s32 offen offset:64 sc1
    s_waitcnt lgkmcnt(10)
    v_mfma_f32_16x16x32_bf16 v[0:3], v[108:111], v[72:75], v[0:3]
    ds_read_b64_tr_b16 v[96:97], v135 offset:192
    ds_read_b64_tr_b16 v[98:99], v135 offset:2496
    v_mfma_f32_16x16x32_bf16 v[4:7], v[112:115], v[72:75], v[4:7]
    buffer_load_dwordx4 v[152:155], v200, s[12:15], s33 offen offset:64 sc1
    s_waitcnt lgkmcnt(10)
    v_mfma_f32_16x16x32_bf16 v[8:11], v[108:111], v[76:79], v[8:11]
    ds_read_b64_tr_b16 v[100:101], v135 offset:224
    ds_read_b64_tr_b16 v[102:103], v135 offset:2528
    v_mfma_f32_16x16x32_bf16 v[12:15], v[112:115], v[76:79], v[12:15]
    buffer_load_dword v160, v202, s[12:15], s34 offen offset:256 sc1
    s_waitcnt lgkmcnt(10)
    v_mfma_f32_16x16x32_bf16 v[16:19], v[108:111], v[80:83], v[16:19]
    ds_read_b64_tr_b16 v[104:105], v135 offset:256
    ds_read_b64_tr_b16 v[106:107], v135 offset:2560
    v_mfma_f32_16x16x32_bf16 v[20:23], v[112:115], v[80:83], v[20:23]
    buffer_load_dword v161, v201, s[12:15], s34 offen offset:2336 sc1
    s_waitcnt lgkmcnt(10)
    v_mfma_f32_16x16x32_bf16 v[24:27], v[108:111], v[84:87], v[24:27]
    ds_read_b128 v[116:119], v134 offset:0
    ds_read_b128 v[120:123], v134 offset:2048
    v_mfma_f32_16x16x32_bf16 v[28:31], v[112:115], v[84:87], v[28:31]
    buffer_load_dword v162, v201, s[12:15], s34 offen offset:2400 sc1
    s_waitcnt lgkmcnt(10)
    v_mfma_f32_16x16x32_bf16 v[32:35], v[108:111], v[88:91], v[32:35]
    ds_read_b64_tr_b16 v[72:73], v135 offset:9216
    ds_read_b64_tr_b16 v[74:75], v135 offset:11520
    v_mfma_f32_16x16x32_bf16 v[36:39], v[112:115], v[88:91], v[36:39]
    buffer_load_dword v163, v201, s[12:15], s34 offen offset:2464 sc1
    s_waitcnt lgkmcnt(10)
    v_mfma_f32_16x16x32_bf16 v[40:43], v[108:111], v[92:95], v[40:43]
    ds_read_b64_tr_b16 v[76:77], v135 offset:9248
    ds_read_b64_tr_b16 v[78:79], v135 offset:11552
    v_mfma_f32_16x16x32_bf16 v[44:47], v[112:115], v[92:95], v[44:47]
    buffer_load_dword v164, v201, s[12:15], s34 offen offset:2528 sc1
    s_waitcnt lgkmcnt(10)
    v_mfma_f32_16x16x32_bf16 v[48:51], v[108:111], v[96:99], v[48:51]
    ds_read_b64_tr_b16 v[80:81], v135 offset:9280
    ds_read_b64_tr_b16 v[82:83], v135 offset:11584
    v_mfma_f32_16x16x32_bf16 v[52:55], v[112:115], v[96:99], v[52:55]
    buffer_load_dword v156, v201, s[12:15], s34 offen offset:0 sc1
    s_waitcnt lgkmcnt(10)
    v_mfma_f32_16x16x32_bf16 v[56:59], v[108:111], v[100:103], v[56:59]
    ds_read_b64_tr_b16 v[84:85], v135 offset:9312
    ds_read_b64_tr_b16 v[86:87], v135 offset:11616
    v_mfma_f32_16x16x32_bf16 v[60:63], v[112:115], v[100:103], v[60:63]
    buffer_load_dword v157, v201, s[12:15], s34 offen offset:64 sc1
    s_waitcnt lgkmcnt(10)
    v_mfma_f32_16x16x32_bf16 v[64:67], v[108:111], v[104:107], v[64:67]
    ds_read_b64_tr_b16 v[88:89], v135 offset:9344
    ds_read_b64_tr_b16 v[90:91], v135 offset:11648
    v_mfma_f32_16x16x32_bf16 v[68:71], v[112:115], v[104:107], v[68:71]
    buffer_load_dword v158, v201, s[12:15], s34 offen offset:128 sc1
    s_waitcnt lgkmcnt(8)
    v_mfma_f32_16x16x32_bf16 v[0:3], v[116:119], v[72:75], v[0:3]
    ds_read_b64_tr_b16 v[92:93], v135 offset:9376
    ds_read_b64_tr_b16 v[94:95], v135 offset:11680
    v_mfma_f32_16x16x32_bf16 v[4:7], v[120:123], v[72:75], v[4:7]
    buffer_load_dword v159, v201, s[12:15], s34 offen offset:192 sc1
    s_waitcnt lgkmcnt(8)
    v_mfma_f32_16x16x32_bf16 v[8:11], v[116:119], v[76:79], v[8:11]
    ds_read_b64_tr_b16 v[96:97], v135 offset:9408
    ds_read_b64_tr_b16 v[98:99], v135 offset:11712
    v_mfma_f32_16x16x32_bf16 v[12:15], v[120:123], v[76:79], v[12:15]
    s_waitcnt lgkmcnt(8)
    v_mfma_f32_16x16x32_bf16 v[16:19], v[116:119], v[80:83], v[16:19]
    ds_read_b64_tr_b16 v[100:101], v135 offset:9440
    ds_read_b64_tr_b16 v[102:103], v135 offset:11744
    v_mfma_f32_16x16x32_bf16 v[20:23], v[120:123], v[80:83], v[20:23]
    buffer_load_dwordx4 a[72:75], v251, s[12:15], s54 offen offset:0 sc1
    s_waitcnt lgkmcnt(8)
    v_mfma_f32_16x16x32_bf16 v[24:27], v[116:119], v[84:87], v[24:27]
    ds_read_b64_tr_b16 v[104:105], v135 offset:9472
    ds_read_b64_tr_b16 v[106:107], v135 offset:11776
    v_mfma_f32_16x16x32_bf16 v[28:31], v[120:123], v[84:87], v[28:31]
    s_waitcnt lgkmcnt(8)
    v_mfma_f32_16x16x32_bf16 v[32:35], v[116:119], v[88:91], v[32:35]
    v_mfma_f32_16x16x32_bf16 v[36:39], v[120:123], v[88:91], v[36:39]
    buffer_load_dwordx4 a[76:79], v251, s[12:15], s54 offen offset:1024 sc1
    s_add_u32 s30, s30, 1
    s_and_b32 s30, s30, 3
    s_cmp_eq_u32 s30, 0
    s_cselect_b32 s25, 4294828032, 0
    s_add_u32 s25, s25, 34816
    s_waitcnt lgkmcnt(6)
    v_mfma_f32_16x16x32_bf16 v[40:43], v[116:119], v[92:95], v[40:43]
    v_mfma_f32_16x16x32_bf16 v[44:47], v[120:123], v[92:95], v[44:47]
    v_add_u32 v133, s25, v133
    v_add_u32 v134, s25, v134
    v_add_u32 v135, s25, v135
    s_waitcnt lgkmcnt(0)
    v_mfma_f32_16x16x32_bf16 v[48:51], v[116:119], v[96:99], v[48:51]
    v_mfma_f32_16x16x32_bf16 v[52:55], v[120:123], v[96:99], v[52:55]
    v_mfma_f32_16x16x32_bf16 v[56:59], v[116:119], v[100:103], v[56:59]
    v_mfma_f32_16x16x32_bf16 v[60:63], v[120:123], v[100:103], v[60:63]
    v_mfma_f32_16x16x32_bf16 v[64:67], v[116:119], v[104:107], v[64:67]
    v_mfma_f32_16x16x32_bf16 v[68:71], v[120:123], v[104:107], v[68:71]
    v_mov_b32 v213, s62
    v_cndmask_b32 v212, 0, v213, s[48:49]
    s_waitcnt vmcnt(2)
    v_pk_fma_f32 v[208:209], v[148:149], v[160:161], v[212:213] op_sel:[0,0,0] op_sel_hi:[1,0,0]
    v_pk_fma_f32 v[32:33], v[140:141], v[32:33], v[208:209]
    v_pk_fma_f32 v[210:211], v[150:151], v[160:161], v[212:213] op_sel:[0,0,0] op_sel_hi:[1,0,0]
    v_pk_fma_f32 v[34:35], v[142:143], v[34:35], v[210:211]
    v_pk_fma_f32 v[208:209], v[152:153], v[160:161], v[212:213] op_sel:[0,0,0] op_sel_hi:[1,0,0]
    v_pk_fma_f32 v[36:37], v[144:145], v[36:37], v[208:209]
    v_pk_fma_f32 v[210:211], v[154:155], v[160:161], v[212:213] op_sel:[0,0,0] op_sel_hi:[1,0,0]
    v_pk_fma_f32 v[38:39], v[146:147], v[38:39], v[210:211]
    v_cvt_pk_bf16_f32 v108, v32, v33
    buffer_load_dwordx4 a[80:83], v251, s[12:15], s54 offen offset:2048 sc1
    v_cvt_pk_bf16_f32 v109, v34, v35
    v_cvt_pk_bf16_f32 v110, v36, v37
    v_cvt_pk_bf16_f32 v111, v38, v39
    v_pk_mul_f32 v[208:209], v[148:149], v[160:161] op_sel:[0,1] op_sel_hi:[1,1]
    v_pk_fma_f32 v[40:41], v[140:141], v[40:41], v[208:209]
    v_pk_mul_f32 v[210:211], v[150:151], v[160:161] op_sel:[0,1] op_sel_hi:[1,1]
    v_pk_fma_f32 v[42:43], v[142:143], v[42:43], v[210:211]
    v_pk_mul_f32 v[208:209], v[152:153], v[160:161] op_sel:[0,1] op_sel_hi:[1,1]
    v_pk_fma_f32 v[44:45], v[144:145], v[44:45], v[208:209]
    v_pk_mul_f32 v[210:211], v[154:155], v[160:161] op_sel:[0,1] op_sel_hi:[1,1]
    v_pk_fma_f32 v[46:47], v[146:147], v[46:47], v[210:211]
    v_cvt_pk_bf16_f32 v92, v40, v41
    v_cvt_pk_bf16_f32 v93, v42, v43
    v_cvt_pk_bf16_f32 v94, v44, v45
    buffer_load_dwordx4 a[84:87], v251, s[12:15], s54 offen offset:3072 sc1
    s_add_u32 s54, s54, 4096
    v_cvt_pk_bf16_f32 v95, v46, v47
    v_pk_mul_f32 v[208:209], v[148:149], v[162:163] op_sel:[0,0] op_sel_hi:[1,0]
    v_pk_fma_f32 v[48:49], v[140:141], v[48:49], v[208:209]
    v_pk_mul_f32 v[210:211], v[150:151], v[162:163] op_sel:[0,0] op_sel_hi:[1,0]
    v_pk_fma_f32 v[50:51], v[142:143], v[50:51], v[210:211]
    v_pk_mul_f32 v[208:209], v[152:153], v[162:163] op_sel:[0,0] op_sel_hi:[1,0]
    v_pk_fma_f32 v[52:53], v[144:145], v[52:53], v[208:209]
    v_pk_mul_f32 v[210:211], v[154:155], v[162:163] op_sel:[0,0] op_sel_hi:[1,0]
    v_pk_fma_f32 v[54:55], v[146:147], v[54:55], v[210:211]
    v_cvt_pk_bf16_f32 v96, v48, v49
    v_cvt_pk_bf16_f32 v97, v50, v51
    v_cvt_pk_bf16_f32 v98, v52, v53
    v_cvt_pk_bf16_f32 v99, v54, v55
    v_pk_mul_f32 v[208:209], v[148:149], v[162:163] op_sel:[0,1] op_sel_hi:[1,1]
    v_pk_fma_f32 v[56:57], v[140:141], v[56:57], v[208:209]
    v_pk_mul_f32 v[210:211], v[150:151], v[162:163] op_sel:[0,1] op_sel_hi:[1,1]
    v_pk_fma_f32 v[58:59], v[142:143], v[58:59], v[210:211]
    v_pk_mul_f32 v[208:209], v[152:153], v[162:163] op_sel:[0,1] op_sel_hi:[1,1]
    v_pk_fma_f32 v[60:61], v[144:145], v[60:61], v[208:209]
    v_pk_mul_f32 v[210:211], v[154:155], v[162:163] op_sel:[0,1] op_sel_hi:[1,1]
    v_pk_fma_f32 v[62:63], v[146:147], v[62:63], v[210:211]
    v_cvt_pk_bf16_f32 v100, v56, v57
    v_cvt_pk_bf16_f32 v101, v58, v59
    buffer_load_dwordx4 a[88:91], v251, s[12:15], s54 offen offset:0 sc1
    v_cvt_pk_bf16_f32 v102, v60, v61
    v_cvt_pk_bf16_f32 v103, v62, v63
    v_pk_mul_f32 v[208:209], v[148:149], v[164:165] op_sel:[0,0] op_sel_hi:[1,0]
    v_pk_fma_f32 v[64:65], v[140:141], v[64:65], v[208:209]
    v_pk_mul_f32 v[210:211], v[150:151], v[164:165] op_sel:[0,0] op_sel_hi:[1,0]
    v_pk_fma_f32 v[66:67], v[142:143], v[66:67], v[210:211]
    v_pk_mul_f32 v[208:209], v[152:153], v[164:165] op_sel:[0,0] op_sel_hi:[1,0]
    v_pk_fma_f32 v[68:69], v[144:145], v[68:69], v[208:209]
    v_pk_mul_f32 v[210:211], v[154:155], v[164:165] op_sel:[0,0] op_sel_hi:[1,0]
    v_pk_fma_f32 v[70:71], v[146:147], v[70:71], v[210:211]
    v_cvt_pk_bf16_f32 v104, v64, v65
    v_cvt_pk_bf16_f32 v105, v66, v67
    v_cvt_pk_bf16_f32 v106, v68, v69
    v_cvt_pk_bf16_f32 v107, v70, v71
    v_cndmask_b32 v108, v108, v136, s[48:49]
    v_cndmask_b32 v109, v109, v136, s[48:49]
    v_cndmask_b32 v110, v110, v136, s[48:49]
    v_cndmask_b32 v111, v111, v136, s[48:49]
    v_pk_fma_f32 v[208:209], v[148:149], v[156:157], s[62:63] op_sel:[0,0,0] op_sel_hi:[1,0,0]
    v_pk_fma_f32 v[0:1], v[140:141], v[0:1], v[208:209]
    v_pk_fma_f32 v[210:211], v[150:151], v[156:157], s[62:63] op_sel:[0,0,0] op_sel_hi:[1,0,0]
    v_pk_fma_f32 v[2:3], v[142:143], v[2:3], v[210:211]
    v_pk_fma_f32 v[208:209], v[152:153], v[156:157], s[62:63] op_sel:[0,0,0] op_sel_hi:[1,0,0]
    v_pk_fma_f32 v[4:5], v[144:145], v[4:5], v[208:209]
    v_pk_fma_f32 v[210:211], v[154:155], v[156:157], s[62:63] op_sel:[0,0,0] op_sel_hi:[1,0,0]
    v_pk_fma_f32 v[6:7], v[146:147], v[6:7], v[210:211]
    v_pk_mul_f32 v[208:209], v[0:1], s[60:61]
    buffer_load_dwordx4 a[92:95], v251, s[12:15], s54 offen offset:1024 sc1
    v_max_f32 v0, s62, v0
    v_exp_f32 v208, v208 clamp
    v_exp_f32 v209, v209 clamp
    v_max_f32 v1, s62, v1
    v_pk_add_f32 v[0:1], v[0:1], v[208:209]
    v_pk_mul_f32 v[210:211], v[2:3], s[60:61]
    buffer_load_dwordx4 a[96:99], v251, s[12:15], s54 offen offset:2048 sc1
    v_max_f32 v2, s62, v2
    v_exp_f32 v210, v210 clamp
    v_exp_f32 v211, v211 clamp
    v_max_f32 v3, s62, v3
    v_pk_add_f32 v[2:3], v[2:3], v[210:211]
    v_pk_mul_f32 v[208:209], v[4:5], s[60:61]
    v_max_f32 v4, s62, v4
    v_exp_f32 v208, v208 clamp
    v_exp_f32 v209, v209 clamp
    v_max_f32 v5, s62, v5
    v_pk_add_f32 v[4:5], v[4:5], v[208:209]
    buffer_load_dwordx4 a[100:103], v251, s[12:15], s54 offen offset:3072 sc1
    s_add_u32 s54, s54, 4096
    v_pk_mul_f32 v[210:211], v[6:7], s[60:61]
    v_max_f32 v6, s62, v6
    v_exp_f32 v210, v210 clamp
    v_exp_f32 v211, v211 clamp
    v_max_f32 v7, s62, v7
    v_pk_add_f32 v[6:7], v[6:7], v[210:211]
    v_cvt_pk_bf16_f32 v72, v0, v1
    v_cvt_pk_bf16_f32 v73, v2, v3
    v_cvt_pk_bf16_f32 v74, v4, v5
    v_cvt_pk_bf16_f32 v75, v6, v7
    s_nop 1
    v_mfma_f32_16x16x32_bf16 v[168:171], v[72:75], v[108:111], 0
    v_mfma_f32_16x16x32_bf16 v[172:175], v[72:75], v[92:95], 0
    v_pk_fma_f32 v[208:209], v[148:149], v[156:157], s[62:63] op_sel:[0,1,0] op_sel_hi:[1,1,0]
    v_pk_fma_f32 v[8:9], v[140:141], v[8:9], v[208:209]
    v_pk_fma_f32 v[210:211], v[150:151], v[156:157], s[62:63] op_sel:[0,1,0] op_sel_hi:[1,1,0]
    v_pk_fma_f32 v[10:11], v[142:143], v[10:11], v[210:211]
    v_pk_fma_f32 v[208:209], v[152:153], v[156:157], s[62:63] op_sel:[0,1,0] op_sel_hi:[1,1,0]
    v_pk_fma_f32 v[12:13], v[144:145], v[12:13], v[208:209]
    v_pk_fma_f32 v[210:211], v[154:155], v[156:157], s[62:63] op_sel:[0,1,0] op_sel_hi:[1,1,0]
    v_pk_fma_f32 v[14:15], v[146:147], v[14:15], v[210:211]
    v_pk_mul_f32 v[208:209], v[8:9], s[60:61]
    buffer_load_dwordx4 a[104:107], v251, s[12:15], s54 offen offset:0 sc1
    v_max_f32 v8, s62, v8
    v_exp_f32 v208, v208 clamp
    v_exp_f32 v209, v209 clamp
    v_max_f32 v9, s62, v9
    v_pk_add_f32 v[8:9], v[8:9], v[208:209]
    v_pk_mul_f32 v[210:211], v[10:11], s[60:61]
    buffer_load_dwordx4 a[108:111], v251, s[12:15], s54 offen offset:1024 sc1
    v_max_f32 v10, s62, v10
    v_exp_f32 v210, v210 clamp
    v_exp_f32 v211, v211 clamp
    v_max_f32 v11, s62, v11
    v_pk_add_f32 v[10:11], v[10:11], v[210:211]
    v_pk_mul_f32 v[208:209], v[12:13], s[60:61]
    buffer_load_dwordx4 a[112:115], v251, s[12:15], s54 offen offset:2048 sc1
    v_max_f32 v12, s62, v12
    v_exp_f32 v208, v208 clamp
    v_exp_f32 v209, v209 clamp
    v_max_f32 v13, s62, v13
    v_pk_add_f32 v[12:13], v[12:13], v[208:209]
    v_pk_mul_f32 v[210:211], v[14:15], s[60:61]
    buffer_load_dwordx4 a[116:119], v251, s[12:15], s54 offen offset:3072 sc1
    s_add_u32 s54, s54, 4096
    v_max_f32 v14, s62, v14
    v_exp_f32 v210, v210 clamp
    v_exp_f32 v211, v211 clamp
    v_max_f32 v15, s62, v15
    v_pk_add_f32 v[14:15], v[14:15], v[210:211]
    v_cvt_pk_bf16_f32 v76, v8, v9
    v_cvt_pk_bf16_f32 v77, v10, v11
    v_cvt_pk_bf16_f32 v78, v12, v13
    v_cvt_pk_bf16_f32 v79, v14, v15
    ds_write_b128 v192, v[168:171] offset:0
    ds_write_b128 v192, v[172:175] offset:5376
    s_nop 1
    v_mfma_f32_16x16x32_bf16 v[176:179], v[76:79], v[108:111], 0
    v_mfma_f32_16x16x32_bf16 v[180:183], v[76:79], v[92:95], 0
    v_mfma_f32_16x16x32_bf16 v[184:187], v[76:79], v[96:99], 0
    v_pk_fma_f32 v[208:209], v[148:149], v[158:159], s[62:63] op_sel:[0,0,0] op_sel_hi:[1,0,0]
    v_pk_fma_f32 v[16:17], v[140:141], v[16:17], v[208:209]
    v_pk_fma_f32 v[210:211], v[150:151], v[158:159], s[62:63] op_sel:[0,0,0] op_sel_hi:[1,0,0]
    v_pk_fma_f32 v[18:19], v[142:143], v[18:19], v[210:211]
    v_pk_fma_f32 v[208:209], v[152:153], v[158:159], s[62:63] op_sel:[0,0,0] op_sel_hi:[1,0,0]
    v_pk_fma_f32 v[20:21], v[144:145], v[20:21], v[208:209]
    v_pk_fma_f32 v[210:211], v[154:155], v[158:159], s[62:63] op_sel:[0,0,0] op_sel_hi:[1,0,0]
    v_pk_fma_f32 v[22:23], v[146:147], v[22:23], v[210:211]
    v_pk_mul_f32 v[208:209], v[16:17], s[60:61]
    buffer_load_dwordx4 a[120:123], v251, s[12:15], s54 offen offset:0 sc1
    v_max_f32 v16, s62, v16
    v_exp_f32 v208, v208 clamp
    v_exp_f32 v209, v209 clamp
    v_max_f32 v17, s62, v17
    v_pk_add_f32 v[16:17], v[16:17], v[208:209]
    v_pk_mul_f32 v[210:211], v[18:19], s[60:61]
    buffer_load_dwordx4 a[124:127], v251, s[12:15], s54 offen offset:1024 sc1
    v_max_f32 v18, s62, v18
    v_exp_f32 v210, v210 clamp
    v_exp_f32 v211, v211 clamp
    v_max_f32 v19, s62, v19
    v_pk_add_f32 v[18:19], v[18:19], v[210:211]
    v_pk_mul_f32 v[208:209], v[20:21], s[60:61]
    buffer_load_dwordx4 a[128:131], v251, s[12:15], s54 offen offset:2048 sc1
    v_max_f32 v20, s62, v20
    v_exp_f32 v208, v208 clamp
    v_exp_f32 v209, v209 clamp
    v_max_f32 v21, s62, v21
    v_pk_add_f32 v[20:21], v[20:21], v[208:209]
    v_pk_mul_f32 v[210:211], v[22:23], s[60:61]
    buffer_load_dwordx4 a[132:135], v251, s[12:15], s54 offen offset:3072 sc1
    s_add_u32 s54, s54, 4096
    v_max_f32 v22, s62, v22
    v_exp_f32 v210, v210 clamp
    v_exp_f32 v211, v211 clamp
    v_max_f32 v23, s62, v23
    v_pk_add_f32 v[22:23], v[22:23], v[210:211]
    v_cvt_pk_bf16_f32 v80, v16, v17
    v_cvt_pk_bf16_f32 v81, v18, v19
    v_cvt_pk_bf16_f32 v82, v20, v21
    v_cvt_pk_bf16_f32 v83, v22, v23
    ds_write_b128 v192, v[176:179] offset:64
    ds_write_b128 v192, v[180:183] offset:5440
    ds_write_b128 v192, v[184:187] offset:10816
    s_nop 1
    v_mfma_f32_16x16x32_bf16 v[188:191], v[80:83], v[108:111], 0
    v_mfma_f32_16x16x32_bf16 v[168:171], v[80:83], v[92:95], 0
    v_mfma_f32_16x16x32_bf16 v[172:175], v[80:83], v[96:99], 0
    v_mfma_f32_16x16x32_bf16 v[176:179], v[80:83], v[100:103], 0
    v_pk_fma_f32 v[208:209], v[148:149], v[158:159], s[62:63] op_sel:[0,1,0] op_sel_hi:[1,1,0]
    v_pk_fma_f32 v[24:25], v[140:141], v[24:25], v[208:209]
    v_pk_fma_f32 v[210:211], v[150:151], v[158:159], s[62:63] op_sel:[0,1,0] op_sel_hi:[1,1,0]
    v_pk_fma_f32 v[26:27], v[142:143], v[26:27], v[210:211]
    v_pk_fma_f32 v[208:209], v[152:153], v[158:159], s[62:63] op_sel:[0,1,0] op_sel_hi:[1,1,0]
    v_pk_fma_f32 v[28:29], v[144:145], v[28:29], v[208:209]
    v_pk_fma_f32 v[210:211], v[154:155], v[158:159], s[62:63] op_sel:[0,1,0] op_sel_hi:[1,1,0]
    v_pk_fma_f32 v[30:31], v[146:147], v[30:31], v[210:211]
    v_pk_mul_f32 v[208:209], v[24:25], s[60:61]
    buffer_load_dwordx4 a[136:139], v251, s[12:15], s54 offen offset:0 sc1
    v_max_f32 v24, s62, v24
    v_exp_f32 v208, v208 clamp
    v_exp_f32 v209, v209 clamp
    v_max_f32 v25, s62, v25
    v_pk_add_f32 v[24:25], v[24:25], v[208:209]
    v_pk_mul_f32 v[210:211], v[26:27], s[60:61]
    buffer_load_dwordx4 a[140:143], v251, s[12:15], s54 offen offset:1024 sc1
    v_max_f32 v26, s62, v26
    v_exp_f32 v210, v210 clamp
    v_exp_f32 v211, v211 clamp
    v_max_f32 v27, s62, v27
    v_pk_add_f32 v[26:27], v[26:27], v[210:211]
    v_pk_mul_f32 v[208:209], v[28:29], s[60:61]
    buffer_load_dwordx4 a[144:147], v251, s[12:15], s55 offen offset:0 sc1
    v_max_f32 v28, s62, v28
    v_exp_f32 v208, v208 clamp
    v_exp_f32 v209, v209 clamp
    v_max_f32 v29, s62, v29
    v_pk_add_f32 v[28:29], v[28:29], v[208:209]
    v_pk_mul_f32 v[210:211], v[30:31], s[60:61]
    buffer_load_dwordx4 a[148:151], v251, s[12:15], s55 offen offset:1024 sc1
    v_max_f32 v30, s62, v30
    v_exp_f32 v210, v210 clamp
    v_exp_f32 v211, v211 clamp
    v_max_f32 v31, s62, v31
    v_pk_add_f32 v[30:31], v[30:31], v[210:211]
    v_cvt_pk_bf16_f32 v84, v24, v25
    v_cvt_pk_bf16_f32 v85, v26, v27
    v_cvt_pk_bf16_f32 v86, v28, v29
    v_cvt_pk_bf16_f32 v87, v30, v31
    ds_write_b128 v192, v[188:191] offset:128
    ds_write_b128 v192, v[168:171] offset:5504
    ds_write_b128 v192, v[172:175] offset:10880
    ds_write_b128 v192, v[176:179] offset:16256
    s_nop 1
    v_mfma_f32_16x16x32_bf16 v[180:183], v[84:87], v[108:111], 0
    v_mfma_f32_16x16x32_bf16 v[184:187], v[84:87], v[96:99], 0
    v_mfma_f32_16x16x32_bf16 v[188:191], v[84:87], v[100:103], 0
    v_mfma_f32_16x16x32_bf16 v[168:171], v[84:87], v[104:107], 0
    v_pk_mul_f32 v[208:209], v[32:33], s[60:61]
    buffer_load_dwordx4 a[152:155], v251, s[12:15], s55 offen offset:2048 sc1
    v_max_f32 v32, s62, v32
    v_exp_f32 v208, v208 clamp
    v_exp_f32 v209, v209 clamp
    v_max_f32 v33, s62, v33
    v_pk_add_f32 v[32:33], v[32:33], v[208:209]
    v_pk_mul_f32 v[210:211], v[34:35], s[60:61]
    buffer_load_dwordx4 a[156:159], v251, s[12:15], s55 offen offset:3072 sc1
    s_add_u32 s55, s55, 4096
    v_max_f32 v34, s62, v34
    v_exp_f32 v210, v210 clamp
    v_exp_f32 v211, v211 clamp
    v_max_f32 v35, s62, v35
    v_pk_add_f32 v[34:35], v[34:35], v[210:211]
    v_pk_mul_f32 v[208:209], v[36:37], s[60:61]
    buffer_load_dwordx4 a[160:163], v251, s[12:15], s55 offen offset:0 sc1
    v_max_f32 v36, s62, v36
    v_exp_f32 v208, v208 clamp
    v_exp_f32 v209, v209 clamp
    v_max_f32 v37, s62, v37
    v_pk_add_f32 v[36:37], v[36:37], v[208:209]
    v_pk_mul_f32 v[210:211], v[38:39], s[60:61]
    buffer_load_dwordx4 a[164:167], v251, s[12:15], s55 offen offset:1024 sc1
    v_max_f32 v38, s62, v38
    v_exp_f32 v210, v210 clamp
    v_exp_f32 v211, v211 clamp
    v_max_f32 v39, s62, v39
    v_pk_add_f32 v[38:39], v[38:39], v[210:211]
    v_cvt_pk_bf16_f32 v88, v32, v33
    v_cvt_pk_bf16_f32 v89, v34, v35
    v_cvt_pk_bf16_f32 v90, v36, v37
    v_cvt_pk_bf16_f32 v91, v38, v39
    ds_write_b128 v192, v[180:183] offset:192
    ds_write_b128 v192, v[184:187] offset:10944
    ds_write_b128 v192, v[188:191] offset:16320
    ds_write_b128 v192, v[168:171] offset:21696
    s_nop 1
    v_mfma_f32_16x16x32_bf16 v[172:175], v[88:91], v[108:111], 0
    v_mfma_f32_16x16x32_bf16 v[176:179], v[88:91], v[100:103], 0
    v_mfma_f32_16x16x32_bf16 v[180:183], v[88:91], v[104:107], 0
    s_lshl_b32 s24, s29, 2
    s_add_u32 s24, s24, s20
    s_mul_i32 s26, s24, 1368
    v_lshlrev_b32 v208, 2, v248
    s_nop 2
    ds_write_b128 v192, v[172:175] offset:256
    ds_write_b128 v192, v[176:179] offset:16384
    ds_write_b128 v192, v[180:183] offset:21760
    s_waitcnt lgkmcnt(0)
    s_barrier
    ds_read_b32 v0, v194 offset:0
    ds_read_b32 v1, v194 offset:26880
    ds_read_b32 v2, v194 offset:53760
    v_add_u32 v194, 53760, v194
    ds_read_b32 v3, v194 offset:26880
    ds_read_b32 v4, v195 offset:0
    ds_read_b32 v5, v195 offset:26880
    ds_read_b32 v6, v195 offset:53760
    v_add_u32 v195, 53760, v195
    ds_read_b32 v7, v195 offset:26880
    ds_read_b32 v8, v196 offset:0
    ds_read_b32 v9, v196 offset:26880
    ds_read_b32 v10, v196 offset:53760
    v_add_u32 v196, 53760, v196
    ds_read_b32 v11, v196 offset:26880
    s_waitcnt lgkmcnt(3)
    ds_read_b32 v12, v197 offset:0
    ds_read_b32 v13, v197 offset:26880
    ds_read_b32 v14, v197 offset:53760
    v_add_u32 v197, 53760, v197
    ds_read_b32 v15, v197 offset:26880
    ds_read_b32 v16, v198 offset:0
    ds_read_b32 v17, v198 offset:26880
    ds_read_b32 v18, v198 offset:53760
    v_add_u32 v198, 53760, v198
    ds_read_b32 v19, v198 offset:26880
    ds_read_b32 v20, v199 offset:0
    ds_read_b32 v21, v199 offset:26880
    ds_read_b32 v22, v199 offset:53760
    v_add_u32 v199, 53760, v199
    ds_read_b32 v23, v199 offset:26880
    s_waitcnt lgkmcnt(15)
    v_pk_add_f32 v[0:1], v[0:1], v[2:3]
    v_add_f32 v0, v0, v1
    buffer_atomic_add_f32 v0, v208, s[12:15], s26 offen offset:0
    s_waitcnt lgkmcnt(15)
    v_pk_add_f32 v[4:5], v[4:5], v[6:7]
    v_add_f32 v4, v4, v5
    buffer_atomic_add_f32 v4, v208, s[12:15], s26 offen offset:256
    s_waitcnt lgkmcnt(12)
    v_pk_add_f32 v[8:9], v[8:9], v[10:11]
    v_add_f32 v8, v8, v9
    buffer_atomic_add_f32 v8, v208, s[12:15], s26 offen offset:512
    s_waitcnt lgkmcnt(8)
    v_pk_add_f32 v[12:13], v[12:13], v[14:15]
    v_add_f32 v12, v12, v13
    buffer_atomic_add_f32 v12, v208, s[12:15], s26 offen offset:768
    s_waitcnt lgkmcnt(4)
    v_pk_add_f32 v[16:17], v[16:17], v[18:19]
    v_add_f32 v16, v16, v17
    buffer_atomic_add_f32 v16, v208, s[12:15], s26 offen offset:1024
    s_waitcnt lgkmcnt(0)
    v_pk_add_f32 v[20:21], v[20:21], v[22:23]
    v_add_f32 v20, v20, v21
    s_mov_b64 exec, 0x3fffff
    buffer_atomic_add_f32 v20, v208, s[12:15], s26 offen offset:1280
    s_mov_b64 exec, -1
    s_and_b32 s42, s22, 7
    s_lshl_b32 s42, s42, 7
    s_add_u32 s42, s42, 204800
    s_mov_b32 s45, 0xffff
    s_branch L_p2
L_q:
    v_lshlrev_b32 v200, 2, v249
    v_lshlrev_b32 v201, 4, v250
    s_mov_b32 s35, 7
    s_waitcnt vmcnt(9)
.p2align 3
L_q_a:
    s_barrier
    ds_read_b128 v[108:111], v133 offset:0
    ds_read_b128 v[112:115], v133 offset:2048
    ds_read_b64_tr_b16 v[72:73], v135 offset:0
    ds_read_b64_tr_b16 v[74:75], v135 offset:2304
    ds_read_b64_tr_b16 v[76:77], v135 offset:32
    ds_read_b64_tr_b16 v[78:79], v135 offset:2336
    ds_read_b64_tr_b16 v[80:81], v135 offset:64
    ds_read_b64_tr_b16 v[82:83], v135 offset:2368
    v_mfma_f32_16x16x32_bf16 v[48:51], v[96:99], v[116:119], v[48:51]
    ds_read_b64_tr_b16 v[84:85], v135 offset:96
    ds_read_b64_tr_b16 v[86:87], v135 offset:2400
    v_mfma_f32_16x16x32_bf16 v[52:55], v[96:99], v[120:123], v[52:55]
    s_lshl_b32 s32, s37, 7
    s_add_u32 s32, s32, s38
    s_mul_i32 s33, s37, 221184
    s_add_u32 s33, s33, s39
    s_mov_b32 m0, s34
    s_add_u32 s37, s37, 1
    s_cmp_eq_u32 s37, 9
    s_cselect_b32 s37, 0, s37
    s_add_u32 s34, s34, 34816
    s_sub_u32 s24, s34, 139264
    s_cmp_ge_u32 s34, 139264
    s_cselect_b32 s34, s24, s34
    v_mfma_f32_16x16x32_bf16 v[56:59], v[100:103], v[116:119], v[56:59]
    ds_read_b64_tr_b16 v[88:89], v135 offset:128
    ds_read_b64_tr_b16 v[90:91], v135 offset:2432
    v_mfma_f32_16x16x32_bf16 v[60:63], v[100:103], v[120:123], v[60:63]
    buffer_load_dwordx4 v124, s[4:7], s32 offen lds
    s_add_u32 m0, m0, 0x400
    v_mfma_f32_16x16x32_bf16 v[64:67], v[104:107], v[116:119], v[64:67]
    ds_read_b64_tr_b16 v[92:93], v135 offset:160
    ds_read_b64_tr_b16 v[94:95], v135 offset:2464
    v_mfma_f32_16x16x32_bf16 v[68:71], v[104:107], v[120:123], v[68:71]
    s_waitcnt lgkmcnt(10)
    v_mfma_f32_16x16x32_bf16 v[0:3], v[72:75], v[108:111], v[0:3]
    ds_read_b64_tr_b16 v[96:97], v135 offset:192
    ds_read_b64_tr_b16 v[98:99], v135 offset:2496
    v_mfma_f32_16x16x32_bf16 v[4:7], v[72:75], v[112:115], v[4:7]
    buffer_load_dwordx4 v125, s[4:7], s32 offen lds
    s_add_u32 m0, m0, 0x400
    s_waitcnt lgkmcnt(10)
    v_mfma_f32_16x16x32_bf16 v[8:11], v[76:79], v[108:111], v[8:11]
    ds_read_b64_tr_b16 v[100:101], v135 offset:224
    ds_read_b64_tr_b16 v[102:103], v135 offset:2528
    v_mfma_f32_16x16x32_bf16 v[12:15], v[76:79], v[112:115], v[12:15]
    s_waitcnt lgkmcnt(10)
    v_mfma_f32_16x16x32_bf16 v[16:19], v[80:83], v[108:111], v[16:19]
    ds_read_b64_tr_b16 v[104:105], v135 offset:256
    ds_read_b64_tr_b16 v[106:107], v135 offset:2560
    v_mfma_f32_16x16x32_bf16 v[20:23], v[80:83], v[112:115], v[20:23]
    buffer_load_dwordx4 v126, s[4:7], s32 offen lds
    s_add_u32 m0, m0, 0x400
    s_waitcnt lgkmcnt(10)
    v_mfma_f32_16x16x32_bf16 v[24:27], v[84:87], v[108:111], v[24:27]
    ds_read_b128 v[116:119], v134 offset:0
    ds_read_b128 v[120:123], v134 offset:2048
    v_mfma_f32_16x16x32_bf16 v[28:31], v[84:87], v[112:115], v[28:31]
    s_waitcnt lgkmcnt(10)
    v_mfma_f32_16x16x32_bf16 v[32:35], v[88:91], v[108:111], v[32:35]
    ds_read_b64_tr_b16 v[72:73], v135 offset:9216
    ds_read_b64_tr_b16 v[74:75], v135 offset:11520
    v_mfma_f32_16x16x32_bf16 v[36:39], v[88:91], v[112:115], v[36:39]
    buffer_load_dwordx4 v127, s[4:7], s32 offen lds
    s_add_u32 m0, m0, 0x400
    s_add_u32 m0, m0, s36
    s_waitcnt lgkmcnt(10)
    v_mfma_f32_16x16x32_bf16 v[40:43], v[92:95], v[108:111], v[40:43]
    ds_read_b64_tr_b16 v[76:77], v135 offset:9248
    ds_read_b64_tr_b16 v[78:79], v135 offset:11552
    v_mfma_f32_16x16x32_bf16 v[44:47], v[92:95], v[112:115], v[44:47]
    s_waitcnt lgkmcnt(10)
    v_mfma_f32_16x16x32_bf16 v[48:51], v[96:99], v[108:111], v[48:51]
    ds_read_b64_tr_b16 v[80:81], v135 offset:9280
    ds_read_b64_tr_b16 v[82:83], v135 offset:11584
    v_mfma_f32_16x16x32_bf16 v[52:55], v[96:99], v[112:115], v[52:55]
    buffer_load_dwordx4 v128, s[8:11], s33 offen lds
    s_add_u32 m0, m0, 0x400
    s_waitcnt lgkmcnt(10)
    v_mfma_f32_16x16x32_bf16 v[56:59], v[100:103], v[108:111], v[56:59]
    ds_read_b64_tr_b16 v[84:85], v135 offset:9312
    ds_read_b64_tr_b16 v[86:87], v135 offset:11616
    v_mfma_f32_16x16x32_bf16 v[60:63], v[100:103], v[112:115], v[60:63]
    s_waitcnt lgkmcnt(10)
    v_mfma_f32_16x16x32_bf16 v[64:67], v[104:107], v[108:111], v[64:67]
    ds_read_b64_tr_b16 v[88:89], v135 offset:9344
    ds_read_b64_tr_b16 v[90:91], v135 offset:11648
    v_mfma_f32_16x16x32_bf16 v[68:71], v[104:107], v[112:115], v[68:71]
    buffer_load_dwordx4 v129, s[8:11], s33 offen lds
    s_add_u32 m0, m0, 0x400
    s_waitcnt lgkmcnt(8)
    v_mfma_f32_16x16x32_bf16 v[0:3], v[72:75], v[116:119], v[0:3]
    ds_read_b64_tr_b16 v[92:93], v135 offset:9376
    ds_read_b64_tr_b16 v[94:95], v135 offset:11680
    v_mfma_f32_16x16x32_bf16 v[4:7], v[72:75], v[120:123], v[4:7]
    s_waitcnt lgkmcnt(8)
    v_mfma_f32_16x16x32_bf16 v[8:11], v[76:79], v[116:119], v[8:11]
    ds_read_b64_tr_b16 v[96:97], v135 offset:9408
    ds_read_b64_tr_b16 v[98:99], v135 offset:11712
    v_mfma_f32_16x16x32_bf16 v[12:15], v[76:79], v[120:123], v[12:15]
    buffer_load_dwordx4 v130, s[8:11], s33 offen lds
    s_add_u32 m0, m0, 0x400
    s_waitcnt lgkmcnt(8)
    v_mfma_f32_16x16x32_bf16 v[16:19], v[80:83], v[116:119], v[16:19]
    ds_read_b64_tr_b16 v[100:101], v135 offset:9440
    ds_read_b64_tr_b16 v[102:103], v135 offset:11744
    v_mfma_f32_16x16x32_bf16 v[20:23], v[80:83], v[120:123], v[20:23]
    s_waitcnt lgkmcnt(8)
    v_mfma_f32_16x16x32_bf16 v[24:27], v[84:87], v[116:119], v[24:27]
    ds_read_b64_tr_b16 v[104:105], v135 offset:9472
    ds_read_b64_tr_b16 v[106:107], v135 offset:11776
    v_mfma_f32_16x16x32_bf16 v[28:31], v[84:87], v[120:123], v[28:31]
    buffer_load_dwordx4 v131, s[8:11], s33 offen lds
    s_add_u32 m0, m0, 0x400
    s_waitcnt lgkmcnt(8)
    v_mfma_f32_16x16x32_bf16 v[32:35], v[88:91], v[116:119], v[32:35]
    v_mfma_f32_16x16x32_bf16 v[36:39], v[88:91], v[120:123], v[36:39]
    s_add_u32 s30, s30, 1
    s_and_b32 s30, s30, 3
    s_cmp_eq_u32 s30, 0
    s_cselect_b32 s25, 4294828032, 0
    s_add_u32 s25, s25, 34816
    s_waitcnt lgkmcnt(6)
    v_mfma_f32_16x16x32_bf16 v[40:43], v[92:95], v[116:119], v[40:43]
    v_mfma_f32_16x16x32_bf16 v[44:47], v[92:95], v[120:123], v[44:47]
    s_mov_b32 exec_hi, 0
    buffer_load_dwordx4 v132, s[8:11], s33 offen lds
    s_mov_b32 exec_hi, -1
    v_add_u32 v133, s25, v133
    v_add_u32 v134, s25, v134
    v_add_u32 v135, s25, v135
    s_sub_u32 s35, s35, 1
    s_cmp_lg_u32 s35, 0
    s_waitcnt vmcnt(9) lgkmcnt(0)
    s_cbranch_scc1 L_q_a
    s_barrier
    ds_read_b128 v[108:111], v133 offset:0
    ds_read_b128 v[112:115], v133 offset:2048
    ds_read_b64_tr_b16 v[72:73], v135 offset:0
    ds_read_b64_tr_b16 v[74:75], v135 offset:2304
    ds_read_b64_tr_b16 v[76:77], v135 offset:32
    ds_read_b64_tr_b16 v[78:79], v135 offset:2336
    ds_read_b64_tr_b16 v[80:81], v135 offset:64
    ds_read_b64_tr_b16 v[82:83], v135 offset:2368
    v_mfma_f32_16x16x32_bf16 v[48:51], v[96:99], v[116:119], v[48:51]
    ds_read_b64_tr_b16 v[84:85], v135 offset:96
    ds_read_b64_tr_b16 v[86:87], v135 offset:2400
    v_mfma_f32_16x16x32_bf16 v[52:55], v[96:99], v[120:123], v[52:55]
    buffer_load_dword v204, v203, s[16:19], 0 offen sc1
    v_mfma_f32_16x16x32_bf16 v[56:59], v[100:103], v[116:119], v[56:59]
    ds_read_b64_tr_b16 v[88:89], v135 offset:128
    ds_read_b64_tr_b16 v[90:91], v135 offset:2432
    v_mfma_f32_16x16x32_bf16 v[60:63], v[100:103], v[120:123], v[60:63]
    v_mfma_f32_16x16x32_bf16 v[64:67], v[104:107], v[116:119], v[64:67]
    ds_read_b64_tr_b16 v[92:93], v135 offset:160
    ds_read_b64_tr_b16 v[94:95], v135 offset:2464
    v_mfma_f32_16x16x32_bf16 v[68:71], v[104:107], v[120:123], v[68:71]
    s_waitcnt lgkmcnt(10)
    v_mfma_f32_16x16x32_bf16 v[0:3], v[72:75], v[108:111], v[0:3]
    ds_read_b64_tr_b16 v[96:97], v135 offset:192
    ds_read_b64_tr_b16 v[98:99], v135 offset:2496
    v_mfma_f32_16x16x32_bf16 v[4:7], v[72:75], v[112:115], v[4:7]
    s_waitcnt lgkmcnt(10)
    v_mfma_f32_16x16x32_bf16 v[8:11], v[76:79], v[108:111], v[8:11]
    ds_read_b64_tr_b16 v[100:101], v135 offset:224
    ds_read_b64_tr_b16 v[102:103], v135 offset:2528
    v_mfma_f32_16x16x32_bf16 v[12:15], v[76:79], v[112:115], v[12:15]
    s_lshl_b32 s26, s28, 2
    s_add_u32 s26, s26, s20
    s_lshl_b32 s26, s26, 7
    s_add_u32 s32, s26, 131072
    s_add_u32 s33, s26, 139264
    s_mul_i32 s26, s29, 576
    s_add_u32 s34, s26, 97280
    s_waitcnt lgkmcnt(10)
    v_mfma_f32_16x16x32_bf16 v[16:19], v[80:83], v[108:111], v[16:19]
    ds_read_b64_tr_b16 v[104:105], v135 offset:256
    ds_read_b64_tr_b16 v[106:107], v135 offset:2560
    v_mfma_f32_16x16x32_bf16 v[20:23], v[80:83], v[112:115], v[20:23]
    s_waitcnt lgkmcnt(10)
    v_mfma_f32_16x16x32_bf16 v[24:27], v[84:87], v[108:111], v[24:27]
    ds_read_b128 v[116:119], v134 offset:0
    ds_read_b128 v[120:123], v134 offset:2048
    v_mfma_f32_16x16x32_bf16 v[28:31], v[84:87], v[112:115], v[28:31]
    s_waitcnt lgkmcnt(10)
    v_mfma_f32_16x16x32_bf16 v[32:35], v[88:91], v[108:111], v[32:35]
    ds_read_b64_tr_b16 v[72:73], v135 offset:9216
    ds_read_b64_tr_b16 v[74:75], v135 offset:11520
    v_mfma_f32_16x16x32_bf16 v[36:39], v[88:91], v[112:115], v[36:39]
    s_waitcnt lgkmcnt(10)
    v_mfma_f32_16x16x32_bf16 v[40:43], v[92:95], v[108:111], v[40:43]
    ds_read_b64_tr_b16 v[76:77], v135 offset:9248
    ds_read_b64_tr_b16 v[78:79], v135 offset:11552
    v_mfma_f32_16x16x32_bf16 v[44:47], v[92:95], v[112:115], v[44:47]
    s_mul_i32 s24, s22, 43
    s_lshr_b32 s24, s24, 8
    s_lshl_b32 s50, s21, 2
    s_add_u32 s50, s50, s24
    s_mul_i32 s24, s24, 6
    s_sub_u32 s51, s22, s24
    s_mul_i32 s24, s51, 6
    s_add_u32 s52, s24, s20
    s_and_b32 s25, s20, 1
    s_add_u32 s53, s24, s25
    s_add_u32 s53, s53, 4
    s_mul_i32 s54, s52, 18432
    s_add_u32 s54, s54, 7340032
    s_mul_i32 s55, s53, 18432
    s_add_u32 s55, s55, 7340032
    s_waitcnt lgkmcnt(10)
    v_mfma_f32_16x16x32_bf16 v[48:51], v[96:99], v[108:111], v[48:51]
    ds_read_b64_tr_b16 v[80:81], v135 offset:9280
    ds_read_b64_tr_b16 v[82:83], v135 offset:11584
    v_mfma_f32_16x16x32_bf16 v[52:55], v[96:99], v[112:115], v[52:55]
    s_waitcnt lgkmcnt(10)
    v_mfma_f32_16x16x32_bf16 v[56:59], v[100:103], v[108:111], v[56:59]
    ds_read_b64_tr_b16 v[84:85], v135 offset:9312
    ds_read_b64_tr_b16 v[86:87], v135 offset:11616
    v_mfma_f32_16x16x32_bf16 v[60:63], v[100:103], v[112:115], v[60:63]
    s_waitcnt lgkmcnt(10)
    v_mfma_f32_16x16x32_bf16 v[64:67], v[104:107], v[108:111], v[64:67]
    ds_read_b64_tr_b16 v[88:89], v135 offset:9344
    ds_read_b64_tr_b16 v[90:91], v135 offset:11648
    v_mfma_f32_16x16x32_bf16 v[68:71], v[104:107], v[112:115], v[68:71]
    s_waitcnt lgkmcnt(8)
    v_mfma_f32_16x16x32_bf16 v[0:3], v[72:75], v[116:119], v[0:3]
    ds_read_b64_tr_b16 v[92:93], v135 offset:9376
    ds_read_b64_tr_b16 v[94:95], v135 offset:11680
    v_mfma_f32_16x16x32_bf16 v[4:7], v[72:75], v[120:123], v[4:7]
    s_waitcnt lgkmcnt(8)
    v_mfma_f32_16x16x32_bf16 v[8:11], v[76:79], v[116:119], v[8:11]
    ds_read_b64_tr_b16 v[96:97], v135 offset:9408
    ds_read_b64_tr_b16 v[98:99], v135 offset:11712
    v_mfma_f32_16x16x32_bf16 v[12:15], v[76:79], v[120:123], v[12:15]
    s_waitcnt lgkmcnt(8)
    v_mfma_f32_16x16x32_bf16 v[16:19], v[80:83], v[116:119], v[16:19]
    ds_read_b64_tr_b16 v[100:101], v135 offset:9440
    ds_read_b64_tr_b16 v[102:103], v135 offset:11744
    v_mfma_f32_16x16x32_bf16 v[20:23], v[80:83], v[120:123], v[20:23]
    s_waitcnt lgkmcnt(8)
    v_mfma_f32_16x16x32_bf16 v[24:27], v[84:87], v[116:119], v[24:27]
    ds_read_b64_tr_b16 v[104:105], v135 offset:9472
    ds_read_b64_tr_b16 v[106:107], v135 offset:11776
    v_mfma_f32_16x16x32_bf16 v[28:31], v[84:87], v[120:123], v[28:31]
    s_waitcnt lgkmcnt(8)
    v_mfma_f32_16x16x32_bf16 v[32:35], v[88:91], v[116:119], v[32:35]
    v_mfma_f32_16x16x32_bf16 v[36:39], v[88:91], v[120:123], v[36:39]
    s_add_u32 s30, s30, 1
    s_and_b32 s30, s30, 3
    s_cmp_eq_u32 s30, 0
    s_cselect_b32 s25, 4294828032, 0
    s_add_u32 s25, s25, 34816
    s_waitcnt lgkmcnt(6)
    v_mfma_f32_16x16x32_bf16 v[40:43], v[92:95], v[116:119], v[40:43]
    v_mfma_f32_16x16x32_bf16 v[44:47], v[92:95], v[120:123], v[44:47]
    v_add_u32 v133, s25, v133
    v_add_u32 v134, s25, v134
    v_add_u32 v135, s25, v135
    s_waitcnt vmcnt(0)
    v_cmp_ne_u32 vcc, 1, v204
    s_nop 4
    s_cbranch_vccz L_q_r0
    s_mov_b64 exec, 1
    s_mov_b32 s27, 0
L_poll2:
    buffer_load_dword v204, v203, s[16:19], 0 offen offset:0 sc1
    s_waitcnt vmcnt(0)
    v_cmp_ne_u32 vcc, 1, v204
    s_add_u32 s27, s27, 1
    s_nop 3
    s_cbranch_vccz L_poll2_done
    s_cmp_ge_u32 s27, 0x4000
    s_cbranch_scc1 L_poll2_done
    s_sleep 2
    s_branch L_poll2
L_poll2_done:
    s_mov_b64 exec, -1
L_q_r0:
    s_waitcnt lgkmcnt(0)
    s_barrier
    ds_read_b128 v[108:111], v133 offset:0
    ds_read_b128 v[112:115], v133 offset:2048
    ds_read_b64_tr_b16 v[72:73], v135 offset:0
    ds_read_b64_tr_b16 v[74:75], v135 offset:2304
    ds_read_b64_tr_b16 v[76:77], v135 offset:32
    ds_read_b64_tr_b16 v[78:79], v135 offset:2336
    ds_read_b64_tr_b16 v[80:81], v135 offset:64
    ds_read_b64_tr_b16 v[82:83], v135 offset:2368
    v_mfma_f32_16x16x32_bf16 v[48:51], v[96:99], v[116:119], v[48:51]
    ds_read_b64_tr_b16 v[84:85], v135 offset:96
    ds_read_b64_tr_b16 v[86:87], v135 offset:2400
    v_mfma_f32_16x16x32_bf16 v[52:55], v[96:99], v[120:123], v[52:55]
    buffer_load_dword v140, v200, s[12:15], s32 offen offset:0 sc1
    v_mfma_f32_16x16x32_bf16 v[56:59], v[100:103], v[116:119], v[56:59]
    ds_read_b64_tr_b16 v[88:89], v135 offset:128
    ds_read_b64_tr_b16 v[90:91], v135 offset:2432
    v_mfma_f32_16x16x32_bf16 v[60:63], v[100:103], v[120:123], v[60:63]
    buffer_load_dword v148, v200, s[12:15], s33 offen offset:0 sc1
    v_mfma_f32_16x16x32_bf16 v[64:67], v[104:107], v[116:119], v[64:67]
    ds_read_b64_tr_b16 v[92:93], v135 offset:160
    ds_read_b64_tr_b16 v[94:95], v135 offset:2464
    v_mfma_f32_16x16x32_bf16 v[68:71], v[104:107], v[120:123], v[68:71]
    buffer_load_dword v142, v200, s[12:15], s32 offen offset:64 sc1
    s_waitcnt lgkmcnt(10)
    v_mfma_f32_16x16x32_bf16 v[0:3], v[72:75], v[108:111], v[0:3]
    ds_read_b64_tr_b16 v[96:97], v135 offset:192
    ds_read_b64_tr_b16 v[98:99], v135 offset:2496
    v_mfma_f32_16x16x32_bf16 v[4:7], v[72:75], v[112:115], v[4:7]
    buffer_load_dword v150, v200, s[12:15], s33 offen offset:64 sc1
    s_waitcnt lgkmcnt(10)
    v_mfma_f32_16x16x32_bf16 v[8:11], v[76:79], v[108:111], v[8:11]
    ds_read_b64_tr_b16 v[100:101], v135 offset:224
    ds_read_b64_tr_b16 v[102:103], v135 offset:2528
    v_mfma_f32_16x16x32_bf16 v[12:15], v[76:79], v[112:115], v[12:15]
    buffer_load_dwordx4 v[156:159], v201, s[12:15], s34 offen offset:0 sc1
    s_waitcnt lgkmcnt(10)
    v_mfma_f32_16x16x32_bf16 v[16:19], v[80:83], v[108:111], v[16:19]
    ds_read_b64_tr_b16 v[104:105], v135 offset:256
    ds_read_b64_tr_b16 v[106:107], v135 offset:2560
    v_mfma_f32_16x16x32_bf16 v[20:23], v[80:83], v[112:115], v[20:23]
    buffer_load_dwordx4 v[160:163], v201, s[12:15], s34 offen offset:64 sc1
    s_waitcnt lgkmcnt(10)
    v_mfma_f32_16x16x32_bf16 v[24:27], v[84:87], v[108:111], v[24:27]
    ds_read_b128 v[116:119], v134 offset:0
    ds_read_b128 v[120:123], v134 offset:2048
    v_mfma_f32_16x16x32_bf16 v[28:31], v[84:87], v[112:115], v[28:31]
    buffer_load_dwordx4 v[164:167], v201, s[12:15], s34 offen offset:128 sc1
    s_waitcnt lgkmcnt(10)
    v_mfma_f32_16x16x32_bf16 v[32:35], v[88:91], v[108:111], v[32:35]
    ds_read_b64_tr_b16 v[72:73], v135 offset:9216
    ds_read_b64_tr_b16 v[74:75], v135 offset:11520
    v_mfma_f32_16x16x32_bf16 v[36:39], v[88:91], v[112:115], v[36:39]
    buffer_load_dwordx4 v[168:171], v201, s[12:15], s34 offen offset:192 sc1
    s_waitcnt lgkmcnt(10)
    v_mfma_f32_16x16x32_bf16 v[40:43], v[92:95], v[108:111], v[40:43]
    ds_read_b64_tr_b16 v[76:77], v135 offset:9248
    ds_read_b64_tr_b16 v[78:79], v135 offset:11552
    v_mfma_f32_16x16x32_bf16 v[44:47], v[92:95], v[112:115], v[44:47]
    buffer_load_dwordx4 v[172:175], v201, s[12:15], s34 offen offset:256 sc1
    s_waitcnt lgkmcnt(10)
    v_mfma_f32_16x16x32_bf16 v[48:51], v[96:99], v[108:111], v[48:51]
    ds_read_b64_tr_b16 v[80:81], v135 offset:9280
    ds_read_b64_tr_b16 v[82:83], v135 offset:11584
    v_mfma_f32_16x16x32_bf16 v[52:55], v[96:99], v[112:115], v[52:55]
    buffer_load_dwordx4 v[176:179], v201, s[12:15], s34 offen offset:320 sc1
    s_waitcnt lgkmcnt(10)
    v_mfma_f32_16x16x32_bf16 v[56:59], v[100:103], v[108:111], v[56:59]
    ds_read_b64_tr_b16 v[84:85], v135 offset:9312
    ds_read_b64_tr_b16 v[86:87], v135 offset:11616
    v_mfma_f32_16x16x32_bf16 v[60:63], v[100:103], v[112:115], v[60:63]
    buffer_load_dwordx4 v[180:183], v201, s[12:15], s34 offen offset:384 sc1
    s_waitcnt lgkmcnt(10)
    v_mfma_f32_16x16x32_bf16 v[64:67], v[104:107], v[108:111], v[64:67]
    ds_read_b64_tr_b16 v[88:89], v135 offset:9344
    ds_read_b64_tr_b16 v[90:91], v135 offset:11648
    v_mfma_f32_16x16x32_bf16 v[68:71], v[104:107], v[112:115], v[68:71]
    buffer_load_dwordx4 v[184:187], v201, s[12:15], s34 offen offset:448 sc1
    s_waitcnt lgkmcnt(8)
    v_mfma_f32_16x16x32_bf16 v[0:3], v[72:75], v[116:119], v[0:3]
    ds_read_b64_tr_b16 v[92:93], v135 offset:9376
    ds_read_b64_tr_b16 v[94:95], v135 offset:11680
    v_mfma_f32_16x16x32_bf16 v[4:7], v[72:75], v[120:123], v[4:7]
    buffer_load_dwordx4 v[188:191], v201, s[12:15], s34 offen offset:512 sc1
    s_waitcnt lgkmcnt(8)
    v_mfma_f32_16x16x32_bf16 v[8:11], v[76:79], v[116:119], v[8:11]
    ds_read_b64_tr_b16 v[96:97], v135 offset:9408
    ds_read_b64_tr_b16 v[98:99], v135 offset:11712
    v_mfma_f32_16x16x32_bf16 v[12:15], v[76:79], v[120:123], v[12:15]
    s_waitcnt lgkmcnt(8)
    v_mfma_f32_16x16x32_bf16 v[16:19], v[80:83], v[116:119], v[16:19]
    ds_read_b64_tr_b16 v[100:101], v135 offset:9440
    ds_read_b64_tr_b16 v[102:103], v135 offset:11744
    v_mfma_f32_16x16x32_bf16 v[20:23], v[80:83], v[120:123], v[20:23]
    buffer_load_dwordx4 a[72:75], v251, s[12:15], s54 offen offset:0 sc1
    s_waitcnt lgkmcnt(8)
    v_mfma_f32_16x16x32_bf16 v[24:27], v[84:87], v[116:119], v[24:27]
    ds_read_b64_tr_b16 v[104:105], v135 offset:9472
    ds_read_b64_tr_b16 v[106:107], v135 offset:11776
    v_mfma_f32_16x16x32_bf16 v[28:31], v[84:87], v[120:123], v[28:31]
    s_waitcnt lgkmcnt(8)
    v_mfma_f32_16x16x32_bf16 v[32:35], v[88:91], v[116:119], v[32:35]
    v_mfma_f32_16x16x32_bf16 v[36:39], v[88:91], v[120:123], v[36:39]
    buffer_load_dwordx4 a[76:79], v251, s[12:15], s54 offen offset:1024 sc1
    s_add_u32 s30, s30, 1
    s_and_b32 s30, s30, 3
    s_cmp_eq_u32 s30, 0
    s_cselect_b32 s25, 4294828032, 0
    s_add_u32 s25, s25, 34816
    s_waitcnt lgkmcnt(6)
    v_mfma_f32_16x16x32_bf16 v[40:43], v[92:95], v[116:119], v[40:43]
    v_mfma_f32_16x16x32_bf16 v[44:47], v[92:95], v[120:123], v[44:47]
    v_add_u32 v133, s25, v133
    v_add_u32 v134, s25, v134
    v_add_u32 v135, s25, v135
    s_waitcnt lgkmcnt(0)
    v_mfma_f32_16x16x32_bf16 v[48:51], v[96:99], v[116:119], v[48:51]
    v_mfma_f32_16x16x32_bf16 v[52:55], v[96:99], v[120:123], v[52:55]
    v_mfma_f32_16x16x32_bf16 v[56:59], v[100:103], v[116:119], v[56:59]
    v_mfma_f32_16x16x32_bf16 v[60:63], v[100:103], v[120:123], v[60:63]
    v_mfma_f32_16x16x32_bf16 v[64:67], v[104:107], v[116:119], v[64:67]
    v_mfma_f32_16x16x32_bf16 v[68:71], v[104:107], v[120:123], v[68:71]
    s_lshl_b32 s24, s28, 2
    s_add_u32 s24, s24, s20
    s_mul_i32 s24, s24, 36864
    s_mul_i32 s25, s29, 9216
    s_add_u32 s24, s24, s25
    s_add_u32 s24, s24, 1048576
    s_waitcnt vmcnt(2)
    v_pk_fma_f32 v[208:209], v[156:157], v[148:149], s[62:63] op_sel_hi:[1,0,1]
    v_pk_fma_f32 v[0:1], v[0:1], v[140:141], v[208:209] op_sel_hi:[1,0,1]
    v_pk_fma_f32 v[210:211], v[158:159], v[148:149], s[62:63] op_sel_hi:[1,0,1]
    v_pk_fma_f32 v[2:3], v[2:3], v[140:141], v[210:211] op_sel_hi:[1,0,1]
    v_pk_fma_f32 v[208:209], v[156:157], v[150:151], s[62:63] op_sel_hi:[1,0,1]
    v_pk_fma_f32 v[4:5], v[4:5], v[142:143], v[208:209] op_sel_hi:[1,0,1]
    v_pk_fma_f32 v[210:211], v[158:159], v[150:151], s[62:63] op_sel_hi:[1,0,1]
    v_pk_fma_f32 v[6:7], v[6:7], v[142:143], v[210:211] op_sel_hi:[1,0,1]
    v_pk_mul_f32 v[208:209], v[0:1], s[60:61]
    v_max_f32 v0, s62, v0
    v_exp_f32 v208, v208 clamp
    v_exp_f32 v209, v209 clamp
    v_max_f32 v1, s62, v1
    v_pk_add_f32 v[0:1], v[0:1], v[208:209]
    v_pk_mul_f32 v[210:211], v[2:3], s[60:61]
    v_max_f32 v2, s62, v2
    v_exp_f32 v210, v210 clamp
    v_exp_f32 v211, v211 clamp
    v_max_f32 v3, s62, v3
    v_pk_add_f32 v[2:3], v[2:3], v[210:211]
    v_pk_mul_f32 v[208:209], v[4:5], s[60:61]
    v_max_f32 v4, s62, v4
    v_exp_f32 v208, v208 clamp
    v_exp_f32 v209, v209 clamp
    v_max_f32 v5, s62, v5
    v_pk_add_f32 v[4:5], v[4:5], v[208:209]
    v_pk_mul_f32 v[210:211], v[6:7], s[60:61]
    v_max_f32 v6, s62, v6
    v_exp_f32 v210, v210 clamp
    v_exp_f32 v211, v211 clamp
    v_max_f32 v7, s62, v7
    v_pk_add_f32 v[6:7], v[6:7], v[210:211]
    v_cvt_pk_bf16_f32 v72, v0, v1
    v_cvt_pk_bf16_f32 v73, v2, v3
    v_cvt_pk_bf16_f32 v74, v4, v5
    v_cvt_pk_bf16_f32 v75, v6, v7
    s_nop 1
    v_permlane16_swap_b32 v72, v74
    v_permlane16_swap_b32 v73, v75
    buffer_store_dwordx4 v[72:75], v251, s[12:15], s24 offen offset:0 sc1
    v_pk_fma_f32 v[208:209], v[160:161], v[148:149], s[62:63] op_sel_hi:[1,0,1]
    v_pk_fma_f32 v[8:9], v[8:9], v[140:141], v[208:209] op_sel_hi:[1,0,1]
    v_pk_fma_f32 v[210:211], v[162:163], v[148:149], s[62:63] op_sel_hi:[1,0,1]
    v_pk_fma_f32 v[10:11], v[10:11], v[140:141], v[210:211] op_sel_hi:[1,0,1]
    v_pk_fma_f32 v[208:209], v[160:161], v[150:151], s[62:63] op_sel_hi:[1,0,1]
    v_pk_fma_f32 v[12:13], v[12:13], v[142:143], v[208:209] op_sel_hi:[1,0,1]
    v_pk_fma_f32 v[210:211], v[162:163], v[150:151], s[62:63] op_sel_hi:[1,0,1]
    v_pk_fma_f32 v[14:15], v[14:15], v[142:143], v[210:211] op_sel_hi:[1,0,1]
    v_pk_mul_f32 v[208:209], v[8:9], s[60:61]
    v_max_f32 v8, s62, v8
    v_exp_f32 v208, v208 clamp
    v_exp_f32 v209, v209 clamp
    v_max_f32 v9, s62, v9
    v_pk_add_f32 v[8:9], v[8:9], v[208:209]
    v_pk_mul_f32 v[210:211], v[10:11], s[60:61]
    v_max_f32 v10, s62, v10
    v_exp_f32 v210, v210 clamp
    v_exp_f32 v211, v211 clamp
    v_max_f32 v11, s62, v11
    v_pk_add_f32 v[10:11], v[10:11], v[210:211]
    v_pk_mul_f32 v[208:209], v[12:13], s[60:61]
    v_max_f32 v12, s62, v12
    v_exp_f32 v208, v208 clamp
    v_exp_f32 v209, v209 clamp
    v_max_f32 v13, s62, v13
    v_pk_add_f32 v[12:13], v[12:13], v[208:209]
    v_pk_mul_f32 v[210:211], v[14:15], s[60:61]
    v_max_f32 v14, s62, v14
    v_exp_f32 v210, v210 clamp
    v_exp_f32 v211, v211 clamp
    v_max_f32 v15, s62, v15
    v_pk_add_f32 v[14:15], v[14:15], v[210:211]
    v_cvt_pk_bf16_f32 v76, v8, v9
    v_cvt_pk_bf16_f32 v77, v10, v11
    v_cvt_pk_bf16_f32 v78, v12, v13
    v_cvt_pk_bf16_f32 v79, v14, v15
    s_nop 1
    v_permlane16_swap_b32 v76, v78
    v_permlane16_swap_b32 v77, v79
    buffer_store_dwordx4 v[76:79], v251, s[12:15], s24 offen offset:1024 sc1
    v_pk_fma_f32 v[208:209], v[164:165], v[148:149], s[62:63] op_sel_hi:[1,0,1]
    v_pk_fma_f32 v[16:17], v[16:17], v[140:141], v[208:209] op_sel_hi:[1,0,1]
    v_pk_fma_f32 v[210:211], v[166:167], v[148:149], s[62:63] op_sel_hi:[1,0,1]
    v_pk_fma_f32 v[18:19], v[18:19], v[140:141], v[210:211] op_sel_hi:[1,0,1]
    v_pk_fma_f32 v[208:209], v[164:165], v[150:151], s[62:63] op_sel_hi:[1,0,1]
    v_pk_fma_f32 v[20:21], v[20:21], v[142:143], v[208:209] op_sel_hi:[1,0,1]
    v_pk_fma_f32 v[210:211], v[166:167], v[150:151], s[62:63] op_sel_hi:[1,0,1]
    v_pk_fma_f32 v[22:23], v[22:23], v[142:143], v[210:211] op_sel_hi:[1,0,1]
    v_pk_mul_f32 v[208:209], v[16:17], s[60:61]
    v_max_f32 v16, s62, v16
    v_exp_f32 v208, v208 clamp
    v_exp_f32 v209, v209 clamp
    v_max_f32 v17, s62, v17
    v_pk_add_f32 v[16:17], v[16:17], v[208:209]
    v_pk_mul_f32 v[210:211], v[18:19], s[60:61]
    v_max_f32 v18, s62, v18
    v_exp_f32 v210, v210 clamp
    v_exp_f32 v211, v211 clamp
    v_max_f32 v19, s62, v19
    v_pk_add_f32 v[18:19], v[18:19], v[210:211]
    v_pk_mul_f32 v[208:209], v[20:21], s[60:61]
    v_max_f32 v20, s62, v20
    v_exp_f32 v208, v208 clamp
    v_exp_f32 v209, v209 clamp
    v_max_f32 v21, s62, v21
    v_pk_add_f32 v[20:21], v[20:21], v[208:209]
    v_pk_mul_f32 v[210:211], v[22:23], s[60:61]
    v_max_f32 v22, s62, v22
    v_exp_f32 v210, v210 clamp
    v_exp_f32 v211, v211 clamp
    v_max_f32 v23, s62, v23
    v_pk_add_f32 v[22:23], v[22:23], v[210:211]
    v_cvt_pk_bf16_f32 v80, v16, v17
    v_cvt_pk_bf16_f32 v81, v18, v19
    v_cvt_pk_bf16_f32 v82, v20, v21
    v_cvt_pk_bf16_f32 v83, v22, v23
    s_nop 1
    v_permlane16_swap_b32 v80, v82
    v_permlane16_swap_b32 v81, v83
    buffer_store_dwordx4 v[80:83], v251, s[12:15], s24 offen offset:2048 sc1
    v_pk_fma_f32 v[208:209], v[168:169], v[148:149], s[62:63] op_sel_hi:[1,0,1]
    v_pk_fma_f32 v[24:25], v[24:25], v[140:141], v[208:209] op_sel_hi:[1,0,1]
    v_pk_fma_f32 v[210:211], v[170:171], v[148:149], s[62:63] op_sel_hi:[1,0,1]
    v_pk_fma_f32 v[26:27], v[26:27], v[140:141], v[210:211] op_sel_hi:[1,0,1]
    v_pk_fma_f32 v[208:209], v[168:169], v[150:151], s[62:63] op_sel_hi:[1,0,1]
    v_pk_fma_f32 v[28:29], v[28:29], v[142:143], v[208:209] op_sel_hi:[1,0,1]
    v_pk_fma_f32 v[210:211], v[170:171], v[150:151], s[62:63] op_sel_hi:[1,0,1]
    v_pk_fma_f32 v[30:31], v[30:31], v[142:143], v[210:211] op_sel_hi:[1,0,1]
    v_pk_mul_f32 v[208:209], v[24:25], s[60:61]
    v_max_f32 v24, s62, v24
    v_exp_f32 v208, v208 clamp
    v_exp_f32 v209, v209 clamp
    v_max_f32 v25, s62, v25
    v_pk_add_f32 v[24:25], v[24:25], v[208:209]
    v_pk_mul_f32 v[210:211], v[26:27], s[60:61]
    v_max_f32 v26, s62, v26
    v_exp_f32 v210, v210 clamp
    v_exp_f32 v211, v211 clamp
    v_max_f32 v27, s62, v27
    v_pk_add_f32 v[26:27], v[26:27], v[210:211]
    v_pk_mul_f32 v[208:209], v[28:29], s[60:61]
    v_max_f32 v28, s62, v28
    v_exp_f32 v208, v208 clamp
    v_exp_f32 v209, v209 clamp
    v_max_f32 v29, s62, v29
    v_pk_add_f32 v[28:29], v[28:29], v[208:209]
    v_pk_mul_f32 v[210:211], v[30:31], s[60:61]
    v_max_f32 v30, s62, v30
    v_exp_f32 v210, v210 clamp
    v_exp_f32 v211, v211 clamp
    v_max_f32 v31, s62, v31
    v_pk_add_f32 v[30:31], v[30:31], v[210:211]
    v_cvt_pk_bf16_f32 v84, v24, v25
    v_cvt_pk_bf16_f32 v85, v26, v27
    v_cvt_pk_bf16_f32 v86, v28, v29
    v_cvt_pk_bf16_f32 v87, v30, v31
    s_nop 1
    v_permlane16_swap_b32 v84, v86
    v_permlane16_swap_b32 v85, v87
    buffer_store_dwordx4 v[84:87], v251, s[12:15], s24 offen offset:3072 sc1
    s_add_u32 s24, s24, 4096
    v_pk_fma_f32 v[208:209], v[172:173], v[148:149], s[62:63] op_sel_hi:[1,0,1]
    v_pk_fma_f32 v[32:33], v[32:33], v[140:141], v[208:209] op_sel_hi:[1,0,1]
    v_pk_fma_f32 v[210:211], v[174:175], v[148:149], s[62:63] op_sel_hi:[1,0,1]
    v_pk_fma_f32 v[34:35], v[34:35], v[140:141], v[210:211] op_sel_hi:[1,0,1]
    v_pk_fma_f32 v[208:209], v[172:173], v[150:151], s[62:63] op_sel_hi:[1,0,1]
    v_pk_fma_f32 v[36:37], v[36:37], v[142:143], v[208:209] op_sel_hi:[1,0,1]
    v_pk_fma_f32 v[210:211], v[174:175], v[150:151], s[62:63] op_sel_hi:[1,0,1]
    v_pk_fma_f32 v[38:39], v[38:39], v[142:143], v[210:211] op_sel_hi:[1,0,1]
    v_pk_mul_f32 v[208:209], v[32:33], s[60:61]
    v_max_f32 v32, s62, v32
    v_exp_f32 v208, v208 clamp
    v_exp_f32 v209, v209 clamp
    v_max_f32 v33, s62, v33
    v_pk_add_f32 v[32:33], v[32:33], v[208:209]
    v_pk_mul_f32 v[210:211], v[34:35], s[60:61]
    v_max_f32 v34, s62, v34
    v_exp_f32 v210, v210 clamp
    v_exp_f32 v211, v211 clamp
    v_max_f32 v35, s62, v35
    v_pk_add_f32 v[34:35], v[34:35], v[210:211]
    v_pk_mul_f32 v[208:209], v[36:37], s[60:61]
    v_max_f32 v36, s62, v36
    v_exp_f32 v208, v208 clamp
    v_exp_f32 v209, v209 clamp
    v_max_f32 v37, s62, v37
    v_pk_add_f32 v[36:37], v[36:37], v[208:209]
    v_pk_mul_f32 v[210:211], v[38:39], s[60:61]
    v_max_f32 v38, s62, v38
    v_exp_f32 v210, v210 clamp
    v_exp_f32 v211, v211 clamp
    v_max_f32 v39, s62, v39
    v_pk_add_f32 v[38:39], v[38:39], v[210:211]
    v_cvt_pk_bf16_f32 v88, v32, v33
    v_cvt_pk_bf16_f32 v89, v34, v35
    v_cvt_pk_bf16_f32 v90, v36, v37
    v_cvt_pk_bf16_f32 v91, v38, v39
    s_nop 1
    v_permlane16_swap_b32 v88, v90
    v_permlane16_swap_b32 v89, v91
    buffer_store_dwordx4 v[88:91], v251, s[12:15], s24 offen offset:0 sc1
    v_pk_fma_f32 v[208:209], v[176:177], v[148:149], s[62:63] op_sel_hi:[1,0,1]
    v_pk_fma_f32 v[40:41], v[40:41], v[140:141], v[208:209] op_sel_hi:[1,0,1]
    v_pk_fma_f32 v[210:211], v[178:179], v[148:149], s[62:63] op_sel_hi:[1,0,1]
    v_pk_fma_f32 v[42:43], v[42:43], v[140:141], v[210:211] op_sel_hi:[1,0,1]
    v_pk_fma_f32 v[208:209], v[176:177], v[150:151], s[62:63] op_sel_hi:[1,0,1]
    v_pk_fma_f32 v[44:45], v[44:45], v[142:143], v[208:209] op_sel_hi:[1,0,1]
    v_pk_fma_f32 v[210:211], v[178:179], v[150:151], s[62:63] op_sel_hi:[1,0,1]
    v_pk_fma_f32 v[46:47], v[46:47], v[142:143], v[210:211] op_sel_hi:[1,0,1]
    v_pk_mul_f32 v[208:209], v[40:41], s[60:61]
    v_max_f32 v40, s62, v40
    v_exp_f32 v208, v208 clamp
    v_exp_f32 v209, v209 clamp
    v_max_f32 v41, s62, v41
    v_pk_add_f32 v[40:41], v[40:41], v[208:209]
    v_pk_mul_f32 v[210:211], v[42:43], s[60:61]
    v_max_f32 v42, s62, v42
    v_exp_f32 v210, v210 clamp
    v_exp_f32 v211, v211 clamp
    v_max_f32 v43, s62, v43
    v_pk_add_f32 v[42:43], v[42:43], v[210:211]
    v_pk_mul_f32 v[208:209], v[44:45], s[60:61]
    v_max_f32 v44, s62, v44
    v_exp_f32 v208, v208 clamp
    v_exp_f32 v209, v209 clamp
    v_max_f32 v45, s62, v45
    v_pk_add_f32 v[44:45], v[44:45], v[208:209]
    v_pk_mul_f32 v[210:211], v[46:47], s[60:61]
    v_max_f32 v46, s62, v46
    v_exp_f32 v210, v210 clamp
    v_exp_f32 v211, v211 clamp
    v_max_f32 v47, s62, v47
    v_pk_add_f32 v[46:47], v[46:47], v[210:211]
    v_cvt_pk_bf16_f32 v92, v40, v41
    v_cvt_pk_bf16_f32 v93, v42, v43
    v_cvt_pk_bf16_f32 v94, v44, v45
    v_cvt_pk_bf16_f32 v95, v46, v47
    s_nop 1
    v_permlane16_swap_b32 v92, v94
    v_permlane16_swap_b32 v93, v95
    buffer_store_dwordx4 v[92:95], v251, s[12:15], s24 offen offset:1024 sc1
    v_pk_fma_f32 v[208:209], v[180:181], v[148:149], s[62:63] op_sel_hi:[1,0,1]
    v_pk_fma_f32 v[48:49], v[48:49], v[140:141], v[208:209] op_sel_hi:[1,0,1]
    v_pk_fma_f32 v[210:211], v[182:183], v[148:149], s[62:63] op_sel_hi:[1,0,1]
    v_pk_fma_f32 v[50:51], v[50:51], v[140:141], v[210:211] op_sel_hi:[1,0,1]
    v_pk_fma_f32 v[208:209], v[180:181], v[150:151], s[62:63] op_sel_hi:[1,0,1]
    v_pk_fma_f32 v[52:53], v[52:53], v[142:143], v[208:209] op_sel_hi:[1,0,1]
    v_pk_fma_f32 v[210:211], v[182:183], v[150:151], s[62:63] op_sel_hi:[1,0,1]
    v_pk_fma_f32 v[54:55], v[54:55], v[142:143], v[210:211] op_sel_hi:[1,0,1]
    v_pk_mul_f32 v[208:209], v[48:49], s[60:61]
    v_max_f32 v48, s62, v48
    v_exp_f32 v208, v208 clamp
    v_exp_f32 v209, v209 clamp
    v_max_f32 v49, s62, v49
    v_pk_add_f32 v[48:49], v[48:49], v[208:209]
    v_pk_mul_f32 v[210:211], v[50:51], s[60:61]
    v_max_f32 v50, s62, v50
    v_exp_f32 v210, v210 clamp
    v_exp_f32 v211, v211 clamp
    v_max_f32 v51, s62, v51
    v_pk_add_f32 v[50:51], v[50:51], v[210:211]
    v_pk_mul_f32 v[208:209], v[52:53], s[60:61]
    v_max_f32 v52, s62, v52
    v_exp_f32 v208, v208 clamp
    v_exp_f32 v209, v209 clamp
    v_max_f32 v53, s62, v53
    v_pk_add_f32 v[52:53], v[52:53], v[208:209]
    v_pk_mul_f32 v[210:211], v[54:55], s[60:61]
    v_max_f32 v54, s62, v54
    v_exp_f32 v210, v210 clamp
    v_exp_f32 v211, v211 clamp
    v_max_f32 v55, s62, v55
    v_pk_add_f32 v[54:55], v[54:55], v[210:211]
    v_cvt_pk_bf16_f32 v96, v48, v49
    v_cvt_pk_bf16_f32 v97, v50, v51
    v_cvt_pk_bf16_f32 v98, v52, v53
    v_cvt_pk_bf16_f32 v99, v54, v55
    s_nop 1
    v_permlane16_swap_b32 v96, v98
    v_permlane16_swap_b32 v97, v99
    buffer_store_dwordx4 v[96:99], v251, s[12:15], s24 offen offset:2048 sc1
    v_pk_fma_f32 v[208:209], v[184:185], v[148:149], s[62:63] op_sel_hi:[1,0,1]
    v_pk_fma_f32 v[56:57], v[56:57], v[140:141], v[208:209] op_sel_hi:[1,0,1]
    v_pk_fma_f32 v[210:211], v[186:187], v[148:149], s[62:63] op_sel_hi:[1,0,1]
    v_pk_fma_f32 v[58:59], v[58:59], v[140:141], v[210:211] op_sel_hi:[1,0,1]
    v_pk_fma_f32 v[208:209], v[184:185], v[150:151], s[62:63] op_sel_hi:[1,0,1]
    v_pk_fma_f32 v[60:61], v[60:61], v[142:143], v[208:209] op_sel_hi:[1,0,1]
    v_pk_fma_f32 v[210:211], v[186:187], v[150:151], s[62:63] op_sel_hi:[1,0,1]
    v_pk_fma_f32 v[62:63], v[62:63], v[142:143], v[210:211] op_sel_hi:[1,0,1]
    v_pk_mul_f32 v[208:209], v[56:57], s[60:61]
    v_max_f32 v56, s62, v56
    v_exp_f32 v208, v208 clamp
    v_exp_f32 v209, v209 clamp
    v_max_f32 v57, s62, v57
    v_pk_add_f32 v[56:57], v[56:57], v[208:209]
    v_pk_mul_f32 v[210:211], v[58:59], s[60:61]
    v_max_f32 v58, s62, v58
    v_exp_f32 v210, v210 clamp
    v_exp_f32 v211, v211 clamp
    v_max_f32 v59, s62, v59
    v_pk_add_f32 v[58:59], v[58:59], v[210:211]
    v_pk_mul_f32 v[208:209], v[60:61], s[60:61]
    v_max_f32 v60, s62, v60
    v_exp_f32 v208, v208 clamp
    v_exp_f32 v209, v209 clamp
    v_max_f32 v61, s62, v61
    v_pk_add_f32 v[60:61], v[60:61], v[208:209]
    v_pk_mul_f32 v[210:211], v[62:63], s[60:61]
    v_max_f32 v62, s62, v62
    v_exp_f32 v210, v210 clamp
    v_exp_f32 v211, v211 clamp
    v_max_f32 v63, s62, v63
    v_pk_add_f32 v[62:63], v[62:63], v[210:211]
    v_cvt_pk_bf16_f32 v100, v56, v57
    v_cvt_pk_bf16_f32 v101, v58, v59
    v_cvt_pk_bf16_f32 v102, v60, v61
    v_cvt_pk_bf16_f32 v103, v62, v63
    s_nop 1
    v_permlane16_swap_b32 v100, v102
    v_permlane16_swap_b32 v101, v103
    buffer_store_dwordx4 v[100:103], v251, s[12:15], s24 offen offset:3072 sc1
    s_add_u32 s24, s24, 4096
    v_pk_fma_f32 v[208:209], v[188:189], v[148:149], s[62:63] op_sel_hi:[1,0,1]
    v_pk_fma_f32 v[64:65], v[64:65], v[140:141], v[208:209] op_sel_hi:[1,0,1]
    v_pk_fma_f32 v[210:211], v[190:191], v[148:149], s[62:63] op_sel_hi:[1,0,1]
    v_pk_fma_f32 v[66:67], v[66:67], v[140:141], v[210:211] op_sel_hi:[1,0,1]
    v_pk_fma_f32 v[208:209], v[188:189], v[150:151], s[62:63] op_sel_hi:[1,0,1]
    v_pk_fma_f32 v[68:69], v[68:69], v[142:143], v[208:209] op_sel_hi:[1,0,1]
    v_pk_fma_f32 v[210:211], v[190:191], v[150:151], s[62:63] op_sel_hi:[1,0,1]
    v_pk_fma_f32 v[70:71], v[70:71], v[142:143], v[210:211] op_sel_hi:[1,0,1]
    v_pk_mul_f32 v[208:209], v[64:65], s[60:61]
    v_max_f32 v64, s62, v64
    v_exp_f32 v208, v208 clamp
    v_exp_f32 v209, v209 clamp
    v_max_f32 v65, s62, v65
    v_pk_add_f32 v[64:65], v[64:65], v[208:209]
    v_pk_mul_f32 v[210:211], v[66:67], s[60:61]
    v_max_f32 v66, s62, v66
    v_exp_f32 v210, v210 clamp
    v_exp_f32 v211, v211 clamp
    v_max_f32 v67, s62, v67
    v_pk_add_f32 v[66:67], v[66:67], v[210:211]
    v_pk_mul_f32 v[208:209], v[68:69], s[60:61]
    v_max_f32 v68, s62, v68
    v_exp_f32 v208, v208 clamp
    v_exp_f32 v209, v209 clamp
    v_max_f32 v69, s62, v69
    v_pk_add_f32 v[68:69], v[68:69], v[208:209]
    v_pk_mul_f32 v[210:211], v[70:71], s[60:61]
    v_max_f32 v70, s62, v70
    v_exp_f32 v210, v210 clamp
    v_exp_f32 v211, v211 clamp
    v_max_f32 v71, s62, v71
    v_pk_add_f32 v[70:71], v[70:71], v[210:211]
    v_cvt_pk_bf16_f32 v104, v64, v65
    v_cvt_pk_bf16_f32 v105, v66, v67
    v_cvt_pk_bf16_f32 v106, v68, v69
    v_cvt_pk_bf16_f32 v107, v70, v71
    s_nop 1
    v_permlane16_swap_b32 v104, v106
    v_permlane16_swap_b32 v105, v107
    buffer_store_dwordx4 v[104:107], v251, s[12:15], s24 offen offset:0 sc1
    s_lshl_b32 s42, s28, 9
    s_lshl_b32 s24, s29, 7
    s_add_u32 s42, s42, s24
    s_add_u32 s42, s42, 196608
    s_mov_b32 s45, 1
    s_branch L_p2
L_pack:
    s_and_b32 s24, s22, 7
    s_lshl_b32 s43, s24, 2
    s_add_u32 s43, s43, s20
    s_mul_i32 s34, s24, 3
    s_add_u32 s34, s34, s20
    s_lshl_b32 s44, s43, 3
    s_add_u32 s44, s44, s21
    s_mul_i32 s47, s20, 36864
    s_add_u32 s35, s34, 31
    s_cmp_eq_u32 s20, 3
    s_cselect_b32 s35, 54, s35
    s_add_u32 s36, s34, 30
    s_cmp_eq_u32 s20, 0
    s_cselect_b32 s36, 54, s36
    s_mov_b32 s37, s43
    s_mov_b32 s38, s21
    s_cmp_eq_u32 s43, 31
    s_cbranch_scc0 L_nospare
    s_mov_b32 s38, 7
    s_add_u32 s37, s21, 28
    s_add_u32 s25, s21, 49
    s_cmp_ge_u32 s21, 3
    s_cselect_b32 s37, s25, s37
L_nospare:
    s_cmp_eq_u32 s2, 255
    s_cselect_b32 s37, 54, s37
    v_mov_b32 v124, 0
    v_mov_b32 v116, s58
    v_mov_b32 v125, 0
    v_mov_b32 v117, s58
    v_mov_b32 v126, 0
    v_mov_b32 v118, s58
    v_mov_b32 v127, 0
    v_mov_b32 v119, s58
    v_mov_b32 v128, 1
    v_lshlrev_b32 v129, 2, v248
    v_lshrrev_b32 v0, 3, v248
    v_and_b32 v1, 7, v248
    v_lshlrev_b32 v1, 4, v1
    v_mul_u32_u24 v2, 1152, v0
    v_add_u32 v2, v2, v1
    v_mul_u32_u24 v3, 3456, v0
    v_add_u32 v3, v3, v1
    v_mul_u32_u24 v4, 9216, v0
    v_add_u32 v4, v4, v1
    s_waitcnt lgkmcnt(0)
    s_mov_b32 s4, s64
    s_mov_b32 s5, s65
    s_mov_b32 s6, 0x240000
    s_mov_b32 s7, 0x20000
    s_mov_b32 s12, s100
    s_mov_b32 s13, s101
    s_mov_b32 s14, 0x2800000
    s_mov_b32 s15, 0x20000
    s_cmp_lg_u32 s2, 255
    s_cbranch_scc1 L_noez
    s_mul_i32 s24, s20, 11264
    s_add_u32 s24, s24, 81920
    buffer_store_dwordx4 v[124:127], v251, s[12:15], s24 offen offset:0 sc1
    buffer_store_dwordx4 v[124:127], v251, s[12:15], s24 offen offset:1024 sc1
    buffer_store_dwordx4 v[124:127], v251, s[12:15], s24 offen offset:2048 sc1
    buffer_store_dwordx4 v[124:127], v251, s[12:15], s24 offen offset:3072 sc1
    s_add_u32 s24, s24, 4096
    buffer_store_dwordx4 v[124:127], v251, s[12:15], s24 offen offset:0 sc1
    buffer_store_dwordx4 v[124:127], v251, s[12:15], s24 offen offset:1024 sc1
    buffer_store_dwordx4 v[124:127], v251, s[12:15], s24 offen offset:2048 sc1
    buffer_store_dwordx4 v[124:127], v251, s[12:15], s24 offen offset:3072 sc1
    s_add_u32 s24, s24, 4096
    buffer_store_dwordx4 v[124:127], v251, s[12:15], s24 offen offset:0 sc1
    buffer_store_dwordx4 v[124:127], v251, s[12:15], s24 offen offset:1024 sc1
    buffer_store_dwordx4 v[124:127], v251, s[12:15], s24 offen offset:2048 sc1
    s_mov_b32 s16, s98
    s_mov_b32 s17, s99
    s_mov_b32 s18, 0x100
    s_mov_b32 s19, 0x20000
    s_waitcnt vmcnt(0)
    s_barrier
    s_mov_b64 exec, 1
    buffer_store_dword v128, v124, s[16:19], 0 offen offset:128 sc1
    s_mov_b64 exec, -1
L_noez:
    s_lshl_b32 s39, s21, 5
    s_add_u32 s39, s39, s43
    s_lshl_b32 s40, s43, 2
    s_lshr_b32 s24, s21, 1
    s_add_u32 s40, s40, s24
    s_and_b32 s27, s21, 1
    s_mul_i32 s24, s40, 171
    s_lshr_b32 s24, s24, 12
    s_mul_i32 s24, s24, 30
    s_mul_i32 s25, s27, 30
    s_add_u32 s24, s24, s25
    s_add_u32 s41, s24, s40
    s_mul_i32 s25, s27, 9
    s_add_u32 s25, s25, s40
    s_sub_u32 s25, s25, 72
    s_mul_i32 s24, s25, 171
    s_lshr_b32 s24, s24, 10
    s_mul_i32 s24, s24, 48
    s_add_u32 s24, s24, s25
    s_add_u32 s24, s24, 24
    s_cmp_lt_u32 s40, 72
    s_cselect_b32 s41, s41, s24
    s_mul_i32 s25, s27, 27
    s_add_u32 s25, s25, s40
    s_sub_u32 s25, s25, 81
    s_cmp_lt_u32 s40, 81
    s_cselect_b32 s41, s41, s25
    s_mul_i32 s24, s39, 9216
    buffer_load_dwordx4 v[132:135], v2, s[4:7], s24 offen offset:0
    buffer_load_dwordx4 v[136:139], v2, s[4:7], s24 offen offset:128
    buffer_load_dwordx4 v[140:143], v2, s[4:7], s24 offen offset:256
    buffer_load_dwordx4 v[144:147], v2, s[4:7], s24 offen offset:384
    buffer_load_dwordx4 v[148:151], v2, s[4:7], s24 offen offset:512
    buffer_load_dwordx4 v[152:155], v2, s[4:7], s24 offen offset:640
    buffer_load_dwordx4 v[156:159], v2, s[4:7], s24 offen offset:768
    buffer_load_dwordx4 v[160:163], v2, s[4:7], s24 offen offset:896
    buffer_load_dwordx4 v[164:167], v2, s[4:7], s24 offen offset:1024
    s_cmp_lt_u32 s40, 81
    s_cbranch_scc0 L_e1b
    s_add_u32 s25, s41, 0
    s_mul_i32 s31, s25, 171
    s_lshr_b32 s31, s31, 10
    s_mul_i32 s26, s31, 6
    s_sub_u32 s28, s25, s26
    s_mov_b32 s16, s66
    s_mov_b32 s17, s67
    s_mov_b32 s18, 0x1e6000
    s_mov_b32 s19, 0x20000
    s_lshl_b32 s45, s31, 7
    s_mul_i32 s24, s28, 331776
    s_add_u32 s45, s45, s24
    s_add_u32 m0, s47, 0
    s_nop 0
    buffer_load_dwordx4 v3, s[16:19], s45 offen lds
    s_add_u32 s45, s45, 27648
    s_add_u32 m0, m0, 0x400
    s_nop 0
    buffer_load_dwordx4 v3, s[16:19], s45 offen lds
    s_add_u32 s45, s45, 27648
    s_add_u32 m0, m0, 0x400
    s_nop 0
    buffer_load_dwordx4 v3, s[16:19], s45 offen lds
    s_add_u32 s45, s45, 27648
    s_add_u32 m0, m0, 0x400
    s_nop 0
    buffer_load_dwordx4 v3, s[16:19], s45 offen lds
    s_add_u32 s45, s45, 27648
    s_add_u32 m0, m0, 0x400
    s_nop 0
    buffer_load_dwordx4 v3, s[16:19], s45 offen lds
    s_add_u32 s45, s45, 27648
    s_add_u32 m0, m0, 0x400
    s_nop 0
    buffer_load_dwordx4 v3, s[16:19], s45 offen lds
    s_add_u32 s45, s45, 27648
    s_add_u32 m0, m0, 0x400
    s_nop 0
    buffer_load_dwordx4 v3, s[16:19], s45 offen lds
    s_add_u32 s45, s45, 27648
    s_add_u32 m0, m0, 0x400
    s_nop 0
    buffer_load_dwordx4 v3, s[16:19], s45 offen lds
    s_add_u32 s45, s45, 27648
    s_add_u32 m0, m0, 0x400
    s_nop 0
    buffer_load_dwordx4 v3, s[16:19], s45 offen lds
    s_add_u32 s45, s45, 27648
    s_add_u32 m0, m0, 0x400
    s_nop 0
    buffer_load_dwordx4 v3, s[16:19], s45 offen lds
    s_add_u32 s45, s45, 27648
    s_add_u32 m0, m0, 0x400
    s_nop 0
    buffer_load_dwordx4 v3, s[16:19], s45 offen lds
    s_add_u32 s45, s45, 27648
    s_add_u32 m0, m0, 0x400
    s_nop 0
    buffer_load_dwordx4 v3, s[16:19], s45 offen lds
    s_add_u32 s45, s45, 27648
    s_branch L_e1d
L_e1b:
    s_cmp_lt_u32 s40, 108
    s_cbranch_scc0 L_e1d
    s_add_u32 s25, s41, 0
    s_mul_i32 s31, s25, 171
    s_lshr_b32 s31, s31, 10
    s_mul_i32 s26, s31, 6
    s_sub_u32 s28, s25, s26
    s_mov_b32 s16, s68
    s_mov_b32 s17, s69
    s_mov_b32 s18, 0xa2000
    s_mov_b32 s19, 0x20000
    s_lshl_b32 s45, s31, 7
    s_mul_i32 s46, s28, 12
    s_add_u32 m0, s47, 0
    s_nop 0
    s_add_u32 s24, s46, 0
    s_mul_i32 s25, s24, 57
    s_lshr_b32 s25, s25, 10
    s_mul_i32 s26, s25, 18
    s_sub_u32 s24, s24, s26
    s_mul_i32 s25, s25, 16
    s_and_b32 s26, s24, 1
    s_add_u32 s25, s25, s26
    s_mul_i32 s25, s25, 9
    s_lshr_b32 s24, s24, 1
    s_lshl_b32 s24, s24, 3
    v_add_u32 v208, s24, v0
    v_mul_u32_u24 v209, 57, v208
    v_lshrrev_b32 v209, 9, v209
    v_mad_u32_u24 v208, v209, 9, v208
    v_add_u32 v208, s25, v208
    v_mul_u32_u24 v208, 1152, v208
    v_add_u32 v8, v208, v1
    buffer_load_dwordx4 v8, s[16:19], s45 offen lds
    s_add_u32 m0, m0, 0x400
    s_add_u32 s24, s46, 1
    s_mul_i32 s25, s24, 57
    s_lshr_b32 s25, s25, 10
    s_mul_i32 s26, s25, 18
    s_sub_u32 s24, s24, s26
    s_mul_i32 s25, s25, 16
    s_and_b32 s26, s24, 1
    s_add_u32 s25, s25, s26
    s_mul_i32 s25, s25, 9
    s_lshr_b32 s24, s24, 1
    s_lshl_b32 s24, s24, 3
    v_add_u32 v208, s24, v0
    v_mul_u32_u24 v209, 57, v208
    v_lshrrev_b32 v209, 9, v209
    v_mad_u32_u24 v208, v209, 9, v208
    v_add_u32 v208, s25, v208
    v_mul_u32_u24 v208, 1152, v208
    v_add_u32 v9, v208, v1
    buffer_load_dwordx4 v9, s[16:19], s45 offen lds
    s_add_u32 m0, m0, 0x400
    s_add_u32 s24, s46, 2
    s_mul_i32 s25, s24, 57
    s_lshr_b32 s25, s25, 10
    s_mul_i32 s26, s25, 18
    s_sub_u32 s24, s24, s26
    s_mul_i32 s25, s25, 16
    s_and_b32 s26, s24, 1
    s_add_u32 s25, s25, s26
    s_mul_i32 s25, s25, 9
    s_lshr_b32 s24, s24, 1
    s_lshl_b32 s24, s24, 3
    v_add_u32 v208, s24, v0
    v_mul_u32_u24 v209, 57, v208
    v_lshrrev_b32 v209, 9, v209
    v_mad_u32_u24 v208, v209, 9, v208
    v_add_u32 v208, s25, v208
    v_mul_u32_u24 v208, 1152, v208
    v_add_u32 v8, v208, v1
    buffer_load_dwordx4 v8, s[16:19], s45 offen lds
    s_add_u32 m0, m0, 0x400
    s_add_u32 s24, s46, 3
    s_mul_i32 s25, s24, 57
    s_lshr_b32 s25, s25, 10
    s_mul_i32 s26, s25, 18
    s_sub_u32 s24, s24, s26
    s_mul_i32 s25, s25, 16
    s_and_b32 s26, s24, 1
    s_add_u32 s25, s25, s26
    s_mul_i32 s25, s25, 9
    s_lshr_b32 s24, s24, 1
    s_lshl_b32 s24, s24, 3
    v_add_u32 v208, s24, v0
    v_mul_u32_u24 v209, 57, v208
    v_lshrrev_b32 v209, 9, v209
    v_mad_u32_u24 v208, v209, 9, v208
    v_add_u32 v208, s25, v208
    v_mul_u32_u24 v208, 1152, v208
    v_add_u32 v9, v208, v1
    buffer_load_dwordx4 v9, s[16:19], s45 offen lds
    s_add_u32 m0, m0, 0x400
    s_add_u32 s24, s46, 4
    s_mul_i32 s25, s24, 57
    s_lshr_b32 s25, s25, 10
    s_mul_i32 s26, s25, 18
    s_sub_u32 s24, s24, s26
    s_mul_i32 s25, s25, 16
    s_and_b32 s26, s24, 1
    s_add_u32 s25, s25, s26
    s_mul_i32 s25, s25, 9
    s_lshr_b32 s24, s24, 1
    s_lshl_b32 s24, s24, 3
    v_add_u32 v208, s24, v0
    v_mul_u32_u24 v209, 57, v208
    v_lshrrev_b32 v209, 9, v209
    v_mad_u32_u24 v208, v209, 9, v208
    v_add_u32 v208, s25, v208
    v_mul_u32_u24 v208, 1152, v208
    v_add_u32 v8, v208, v1
    buffer_load_dwordx4 v8, s[16:19], s45 offen lds
    s_add_u32 m0, m0, 0x400
    s_add_u32 s24, s46, 5
    s_mul_i32 s25, s24, 57
    s_lshr_b32 s25, s25, 10
    s_mul_i32 s26, s25, 18
    s_sub_u32 s24, s24, s26
    s_mul_i32 s25, s25, 16
    s_and_b32 s26, s24, 1
    s_add_u32 s25, s25, s26
    s_mul_i32 s25, s25, 9
    s_lshr_b32 s24, s24, 1
    s_lshl_b32 s24, s24, 3
    v_add_u32 v208, s24, v0
    v_mul_u32_u24 v209, 57, v208
    v_lshrrev_b32 v209, 9, v209
    v_mad_u32_u24 v208, v209, 9, v208
    v_add_u32 v208, s25, v208
    v_mul_u32_u24 v208, 1152, v208
    v_add_u32 v9, v208, v1
    buffer_load_dwordx4 v9, s[16:19], s45 offen lds
    s_add_u32 m0, m0, 0x400
    s_add_u32 s24, s46, 6
    s_mul_i32 s25, s24, 57
    s_lshr_b32 s25, s25, 10
    s_mul_i32 s26, s25, 18
    s_sub_u32 s24, s24, s26
    s_mul_i32 s25, s25, 16
    s_and_b32 s26, s24, 1
    s_add_u32 s25, s25, s26
    s_mul_i32 s25, s25, 9
    s_lshr_b32 s24, s24, 1
    s_lshl_b32 s24, s24, 3
    v_add_u32 v208, s24, v0
    v_mul_u32_u24 v209, 57, v208
    v_lshrrev_b32 v209, 9, v209
    v_mad_u32_u24 v208, v209, 9, v208
    v_add_u32 v208, s25, v208
    v_mul_u32_u24 v208, 1152, v208
    v_add_u32 v8, v208, v1
    buffer_load_dwordx4 v8, s[16:19], s45 offen lds
    s_add_u32 m0, m0, 0x400
    s_add_u32 s24, s46, 7
    s_mul_i32 s25, s24, 57
    s_lshr_b32 s25, s25, 10
    s_mul_i32 s26, s25, 18
    s_sub_u32 s24, s24, s26
    s_mul_i32 s25, s25, 16
    s_and_b32 s26, s24, 1
    s_add_u32 s25, s25, s26
    s_mul_i32 s25, s25, 9
    s_lshr_b32 s24, s24, 1
    s_lshl_b32 s24, s24, 3
    v_add_u32 v208, s24, v0
    v_mul_u32_u24 v209, 57, v208
    v_lshrrev_b32 v209, 9, v209
    v_mad_u32_u24 v208, v209, 9, v208
    v_add_u32 v208, s25, v208
    v_mul_u32_u24 v208, 1152, v208
    v_add_u32 v9, v208, v1
    buffer_load_dwordx4 v9, s[16:19], s45 offen lds
    s_add_u32 m0, m0, 0x400
    s_add_u32 s24, s46, 8
    s_mul_i32 s25, s24, 57
    s_lshr_b32 s25, s25, 10
    s_mul_i32 s26, s25, 18
    s_sub_u32 s24, s24, s26
    s_mul_i32 s25, s25, 16
    s_and_b32 s26, s24, 1
    s_add_u32 s25, s25, s26
    s_mul_i32 s25, s25, 9
    s_lshr_b32 s24, s24, 1
    s_lshl_b32 s24, s24, 3
    v_add_u32 v208, s24, v0
    v_mul_u32_u24 v209, 57, v208
    v_lshrrev_b32 v209, 9, v209
    v_mad_u32_u24 v208, v209, 9, v208
    v_add_u32 v208, s25, v208
    v_mul_u32_u24 v208, 1152, v208
    v_add_u32 v8, v208, v1
    buffer_load_dwordx4 v8, s[16:19], s45 offen lds
    s_add_u32 m0, m0, 0x400
    s_add_u32 s24, s46, 9
    s_mul_i32 s25, s24, 57
    s_lshr_b32 s25, s25, 10
    s_mul_i32 s26, s25, 18
    s_sub_u32 s24, s24, s26
    s_mul_i32 s25, s25, 16
    s_and_b32 s26, s24, 1
    s_add_u32 s25, s25, s26
    s_mul_i32 s25, s25, 9
    s_lshr_b32 s24, s24, 1
    s_lshl_b32 s24, s24, 3
    v_add_u32 v208, s24, v0
    v_mul_u32_u24 v209, 57, v208
    v_lshrrev_b32 v209, 9, v209
    v_mad_u32_u24 v208, v209, 9, v208
    v_add_u32 v208, s25, v208
    v_mul_u32_u24 v208, 1152, v208
    v_add_u32 v9, v208, v1
    buffer_load_dwordx4 v9, s[16:19], s45 offen lds
    s_add_u32 m0, m0, 0x400
    s_add_u32 s24, s46, 10
    s_mul_i32 s25, s24, 57
    s_lshr_b32 s25, s25, 10
    s_mul_i32 s26, s25, 18
    s_sub_u32 s24, s24, s26
    s_mul_i32 s25, s25, 16
    s_and_b32 s26, s24, 1
    s_add_u32 s25, s25, s26
    s_mul_i32 s25, s25, 9
    s_lshr_b32 s24, s24, 1
    s_lshl_b32 s24, s24, 3
    v_add_u32 v208, s24, v0
    v_mul_u32_u24 v209, 57, v208
    v_lshrrev_b32 v209, 9, v209
    v_mad_u32_u24 v208, v209, 9, v208
    v_add_u32 v208, s25, v208
    v_mul_u32_u24 v208, 1152, v208
    v_add_u32 v8, v208, v1
    buffer_load_dwordx4 v8, s[16:19], s45 offen lds
    s_add_u32 m0, m0, 0x400
    s_add_u32 s24, s46, 11
    s_mul_i32 s25, s24, 57
    s_lshr_b32 s25, s25, 10
    s_mul_i32 s26, s25, 18
    s_sub_u32 s24, s24, s26
    s_mul_i32 s25, s25, 16
    s_and_b32 s26, s24, 1
    s_add_u32 s25, s25, s26
    s_mul_i32 s25, s25, 9
    s_lshr_b32 s24, s24, 1
    s_lshl_b32 s24, s24, 3
    v_add_u32 v208, s24, v0
    v_mul_u32_u24 v209, 57, v208
    v_lshrrev_b32 v209, 9, v209
    v_mad_u32_u24 v208, v209, 9, v208
    v_add_u32 v208, s25, v208
    v_mul_u32_u24 v208, 1152, v208
    v_add_u32 v9, v208, v1
    buffer_load_dwordx4 v9, s[16:19], s45 offen lds
L_e1d:
    s_lshl_b32 s24, s44, 10
    s_add_u32 s25, s24, 81920
    s_cmp_lt_u32 s44, 80
    s_cselect_b32 s24, s24, s25
    s_cmp_lt_u32 s44, 152
    s_cselect_b32 s24, s24, 0x2800000
    buffer_store_dwordx4 v[124:127], v251, s[12:15], s24 offen sc1
    v_lshrrev_b32 v208, 2, v0
    v_and_b32 v209, 3, v0
    v_lshl_add_u32 v5, v208, 4, v209
    v_mul_u32_u24 v208, 144, v208
    v_add_u32 v6, v208, v209
    v_mul_u32_u24 v5, 1152, v5
    v_add_u32 v5, v5, v1
    v_mul_u32_u24 v6, 1152, v6
    v_add_u32 v6, v6, v1
    v_lshlrev_b32 v120, 3, v250
    v_lshrrev_b32 v208, 2, v249
    v_add_u32 v120, v120, v208
    v_lshlrev_b32 v120, 7, v120
    v_and_b32 v208, 3, v249
    v_lshl_add_u32 v120, v208, 3, v120
    v_add_u32 v120, s47, v120
    v_min_u32 v7, 23, v248
    v_lshlrev_b32 v7, 7, v7
    v_cmp_eq_u32 s[54:55], 1, v250
    v_cmp_eq_u32 s[56:57], 2, v250
    v_cmp_eq_u32 s[8:9], 3, v250
    s_cmp_lt_u32 s40, 108
    s_cbranch_scc0 L_xw3
    s_waitcnt vmcnt(13)
    s_branch L_xwd
L_xw3:
    s_waitcnt vmcnt(1)
L_xwd:
    v_dot2_f32_bf16 v212, v132, s58, 0
    v_dot2_f32_bf16 v214, v132, v132, 0
    v_dot2_f32_bf16 v213, v133, s58, 0
    v_dot2_f32_bf16 v215, v133, v133, 0
    v_dot2_f32_bf16 v212, v134, s58, v212
    v_dot2_f32_bf16 v214, v134, v134, v214
    v_dot2_f32_bf16 v213, v135, s58, v213
    v_dot2_f32_bf16 v215, v135, v135, v215
    v_dot2_f32_bf16 v212, v136, s58, v212
    v_dot2_f32_bf16 v214, v136, v136, v214
    v_dot2_f32_bf16 v213, v137, s58, v213
    v_dot2_f32_bf16 v215, v137, v137, v215
    v_dot2_f32_bf16 v212, v138, s58, v212
    v_dot2_f32_bf16 v214, v138, v138, v214
    v_dot2_f32_bf16 v213, v139, s58, v213
    v_dot2_f32_bf16 v215, v139, v139, v215
    v_dot2_f32_bf16 v212, v140, s58, v212
    v_dot2_f32_bf16 v214, v140, v140, v214
    v_dot2_f32_bf16 v213, v141, s58, v213
    v_dot2_f32_bf16 v215, v141, v141, v215
    v_dot2_f32_bf16 v212, v142, s58, v212
    v_dot2_f32_bf16 v214, v142, v142, v214
    v_dot2_f32_bf16 v213, v143, s58, v213
    v_dot2_f32_bf16 v215, v143, v143, v215
    v_dot2_f32_bf16 v212, v144, s58, v212
    v_dot2_f32_bf16 v214, v144, v144, v214
    v_dot2_f32_bf16 v213, v145, s58, v213
    v_dot2_f32_bf16 v215, v145, v145, v215
    v_dot2_f32_bf16 v212, v146, s58, v212
    v_dot2_f32_bf16 v214, v146, v146, v214
    v_dot2_f32_bf16 v213, v147, s58, v213
    v_dot2_f32_bf16 v215, v147, v147, v215
    v_dot2_f32_bf16 v212, v148, s58, v212
    v_dot2_f32_bf16 v214, v148, v148, v214
    v_dot2_f32_bf16 v213, v149, s58, v213
    v_dot2_f32_bf16 v215, v149, v149, v215
    v_dot2_f32_bf16 v212, v150, s58, v212
    v_dot2_f32_bf16 v214, v150, v150, v214
    v_dot2_f32_bf16 v213, v151, s58, v213
    v_dot2_f32_bf16 v215, v151, v151, v215
    v_dot2_f32_bf16 v212, v152, s58, v212
    v_dot2_f32_bf16 v214, v152, v152, v214
    v_dot2_f32_bf16 v213, v153, s58, v213
    v_dot2_f32_bf16 v215, v153, v153, v215
    v_dot2_f32_bf16 v212, v154, s58, v212
    v_dot2_f32_bf16 v214, v154, v154, v214
    v_dot2_f32_bf16 v213, v155, s58, v213
    v_dot2_f32_bf16 v215, v155, v155, v215
    v_dot2_f32_bf16 v212, v156, s58, v212
    v_dot2_f32_bf16 v214, v156, v156, v214
    v_dot2_f32_bf16 v213, v157, s58, v213
    v_dot2_f32_bf16 v215, v157, v157, v215
    v_dot2_f32_bf16 v212, v158, s58, v212
    v_dot2_f32_bf16 v214, v158, v158, v214
    v_dot2_f32_bf16 v213, v159, s58, v213
    v_dot2_f32_bf16 v215, v159, v159, v215
    v_dot2_f32_bf16 v212, v160, s58, v212
    v_dot2_f32_bf16 v214, v160, v160, v214
    v_dot2_f32_bf16 v213, v161, s58, v213
    v_dot2_f32_bf16 v215, v161, v161, v215
    v_dot2_f32_bf16 v212, v162, s58, v212
    v_dot2_f32_bf16 v214, v162, v162, v214
    v_dot2_f32_bf16 v213, v163, s58, v213
    v_dot2_f32_bf16 v215, v163, v163, v215
    v_dot2_f32_bf16 v212, v164, s58, v212
    v_dot2_f32_bf16 v214, v164, v164, v214
    v_dot2_f32_bf16 v213, v165, s58, v213
    v_dot2_f32_bf16 v215, v165, v165, v215
    v_dot2_f32_bf16 v212, v166, s58, v212
    v_dot2_f32_bf16 v214, v166, v166, v214
    v_dot2_f32_bf16 v213, v167, s58, v213
    v_dot2_f32_bf16 v215, v167, v167, v215
    s_nop 2
    v_add_f32 v212, v212, v213
    v_add_f32 v214, v214, v215
    s_nop 1
    v_add_f32_dpp v212, v212, v212 quad_perm:[1,0,3,2] row_mask:0xf bank_mask:0xf
    v_add_f32_dpp v214, v214, v214 quad_perm:[1,0,3,2] row_mask:0xf bank_mask:0xf
    s_nop 1
    v_add_f32_dpp v212, v212, v212 quad_perm:[2,3,0,1] row_mask:0xf bank_mask:0xf
    v_add_f32_dpp v214, v214, v214 quad_perm:[2,3,0,1] row_mask:0xf bank_mask:0xf
    s_nop 1
    v_add_f32_dpp v212, v212, v212 row_half_mirror row_mask:0xf bank_mask:0xf
    v_add_f32_dpp v214, v214, v214 row_half_mirror row_mask:0xf bank_mask:0xf
    v_mul_f32 v212, 0x3ae38e39, v212
    v_mul_f32 v214, 0x3ae38e39, v214
    v_fma_f32 v214, -v212, v212, v214
    v_max_f32 v214, 0, v214
    v_add_f32 v214, 0x3727c5ac, v214
    v_rsq_f32 v213, v214
    s_nop 0
    v_mul_f32 v215, v212, v213
    v_sub_f32 v215, 0, v215
    v_lshlrev_b32 v208, 2, v0
    s_lshl_b32 s24, s39, 5
    s_add_u32 s24, s24, 131072
    s_add_u32 s25, s24, 8192
    s_mov_b32 exec_lo, 0x01010101
    s_mov_b32 exec_hi, 0x01010101
    buffer_store_dword v213, v208, s[12:15], s24 offen sc1
    buffer_store_dword v215, v208, s[12:15], s25 offen sc1
    s_mov_b64 exec, -1
    s_mov_b32 s16, s98
    s_mov_b32 s17, s99
    s_mov_b32 s18, 0x100
    s_mov_b32 s19, 0x20000
    s_mov_b64 exec, 1
    s_mov_b32 s27, 0
L_poll3:
    buffer_load_dword v208, v124, s[16:19], 0 offen offset:128 sc1
    s_waitcnt vmcnt(0)
    v_cmp_ne_u32 vcc, 1, v208
    s_add_u32 s27, s27, 1
    s_nop 3
    s_cbranch_vccz L_poll3_done
    s_cmp_ge_u32 s27, 0x4000
    s_cbranch_scc1 L_poll3_done
    s_sleep 2
    s_branch L_poll3
L_poll3_done:
    s_mov_b64 exec, -1
    s_cmp_lt_u32 s40, 81
    s_cbranch_scc0 L_d1b
    s_lshl_b32 s24, s31, 8
    s_add_u32 s52, s24, 97280
    s_waitcnt vmcnt(0)
    ds_read_b64_tr_b16 v[52:53], v120 offset:0
    ds_read_b64_tr_b16 v[54:55], v120 offset:512
    ds_read_b64_tr_b16 v[56:57], v120 offset:32
    ds_read_b64_tr_b16 v[58:59], v120 offset:544
    ds_read_b64_tr_b16 v[60:61], v120 offset:64
    ds_read_b64_tr_b16 v[62:63], v120 offset:576
    ds_read_b64_tr_b16 v[64:65], v120 offset:96
    ds_read_b64_tr_b16 v[66:67], v120 offset:608
    ds_read_b64_tr_b16 v[68:69], v120 offset:4096
    ds_read_b64_tr_b16 v[70:71], v120 offset:4608
    ds_read_b64_tr_b16 v[72:73], v120 offset:4128
    ds_read_b64_tr_b16 v[74:75], v120 offset:4640
    s_waitcnt lgkmcnt(3)
    ds_read_b64_tr_b16 v[76:77], v120 offset:4160
    ds_read_b64_tr_b16 v[78:79], v120 offset:4672
    ds_read_b64_tr_b16 v[80:81], v120 offset:4192
    ds_read_b64_tr_b16 v[82:83], v120 offset:4704
    ds_read_b64_tr_b16 v[84:85], v120 offset:8192
    ds_read_b64_tr_b16 v[86:87], v120 offset:8704
    ds_read_b64_tr_b16 v[88:89], v120 offset:8224
    ds_read_b64_tr_b16 v[90:91], v120 offset:8736
    ds_read_b64_tr_b16 v[92:93], v120 offset:8256
    ds_read_b64_tr_b16 v[94:95], v120 offset:8768
    ds_read_b64_tr_b16 v[96:97], v120 offset:8288
    ds_read_b64_tr_b16 v[98:99], v120 offset:8800
    s_waitcnt lgkmcnt(15)
    v_mfma_f32_16x16x32_bf16 v[100:103], v[116:119], v[52:55], 0
    s_waitcnt lgkmcnt(15)
    v_mfma_f32_16x16x32_bf16 v[104:107], v[116:119], v[56:59], 0
    s_waitcnt lgkmcnt(15)
    v_mfma_f32_16x16x32_bf16 v[108:111], v[116:119], v[60:63], 0
    s_waitcnt lgkmcnt(15)
    v_mfma_f32_16x16x32_bf16 v[112:115], v[116:119], v[64:67], 0
    s_waitcnt lgkmcnt(14)
    v_mfma_f32_16x16x32_bf16 v[100:103], v[116:119], v[68:71], v[100:103]
    s_waitcnt lgkmcnt(12)
    v_mfma_f32_16x16x32_bf16 v[104:107], v[116:119], v[72:75], v[104:107]
    s_waitcnt lgkmcnt(10)
    v_mfma_f32_16x16x32_bf16 v[108:111], v[116:119], v[76:79], v[108:111]
    s_waitcnt lgkmcnt(8)
    v_mfma_f32_16x16x32_bf16 v[112:115], v[116:119], v[80:83], v[112:115]
    s_waitcnt lgkmcnt(6)
    v_mfma_f32_16x16x32_bf16 v[100:103], v[116:119], v[84:87], v[100:103]
    s_waitcnt lgkmcnt(4)
    v_mfma_f32_16x16x32_bf16 v[104:107], v[116:119], v[88:91], v[104:107]
    s_waitcnt lgkmcnt(2)
    v_mfma_f32_16x16x32_bf16 v[108:111], v[116:119], v[92:95], v[108:111]
    s_waitcnt lgkmcnt(0)
    v_mfma_f32_16x16x32_bf16 v[112:115], v[116:119], v[96:99], v[112:115]
    s_nop 7
    v_cndmask_b32 v130, v100, v104, s[54:55]
    v_cndmask_b32 v130, v130, v108, s[56:57]
    v_cndmask_b32 v130, v130, v112, s[8:9]
    buffer_atomic_add_f32 v130, v129, s[12:15], s52 offen
    s_branch L_d1d
L_d1b:
    s_cmp_lt_u32 s40, 108
    s_cbranch_scc0 L_d1d
    s_lshl_b32 s24, s31, 2
    s_add_u32 s24, s24, 0
    s_mul_i32 s24, s24, 18
    s_add_u32 s24, s24, 7168
    s_mul_i32 s26, s28, 3
    s_add_u32 s24, s24, s26
    s_lshl_b32 s48, s24, 10
    s_lshl_b32 s24, s31, 2
    s_add_u32 s24, s24, 1
    s_mul_i32 s24, s24, 18
    s_add_u32 s24, s24, 7168
    s_mul_i32 s26, s28, 3
    s_add_u32 s24, s24, s26
    s_lshl_b32 s49, s24, 10
    s_lshl_b32 s24, s31, 2
    s_add_u32 s24, s24, 2
    s_mul_i32 s24, s24, 18
    s_add_u32 s24, s24, 7168
    s_mul_i32 s26, s28, 3
    s_add_u32 s24, s24, s26
    s_lshl_b32 s50, s24, 10
    s_lshl_b32 s24, s31, 2
    s_add_u32 s24, s24, 3
    s_mul_i32 s24, s24, 18
    s_add_u32 s24, s24, 7168
    s_mul_i32 s26, s28, 3
    s_add_u32 s24, s24, s26
    s_lshl_b32 s51, s24, 10
    s_waitcnt vmcnt(0)
    ds_read_b64_tr_b16 v[52:53], v120 offset:0
    ds_read_b64_tr_b16 v[54:55], v120 offset:512
    ds_read_b64_tr_b16 v[56:57], v120 offset:32
    ds_read_b64_tr_b16 v[58:59], v120 offset:544
    ds_read_b64_tr_b16 v[60:61], v120 offset:64
    ds_read_b64_tr_b16 v[62:63], v120 offset:576
    ds_read_b64_tr_b16 v[64:65], v120 offset:96
    ds_read_b64_tr_b16 v[66:67], v120 offset:608
    ds_read_b64_tr_b16 v[68:69], v120 offset:4096
    ds_read_b64_tr_b16 v[70:71], v120 offset:4608
    ds_read_b64_tr_b16 v[72:73], v120 offset:4128
    ds_read_b64_tr_b16 v[74:75], v120 offset:4640
    s_waitcnt lgkmcnt(3)
    ds_read_b64_tr_b16 v[76:77], v120 offset:4160
    ds_read_b64_tr_b16 v[78:79], v120 offset:4672
    ds_read_b64_tr_b16 v[80:81], v120 offset:4192
    ds_read_b64_tr_b16 v[82:83], v120 offset:4704
    ds_read_b64_tr_b16 v[84:85], v120 offset:8192
    ds_read_b64_tr_b16 v[86:87], v120 offset:8704
    ds_read_b64_tr_b16 v[88:89], v120 offset:8224
    ds_read_b64_tr_b16 v[90:91], v120 offset:8736
    ds_read_b64_tr_b16 v[92:93], v120 offset:8256
    ds_read_b64_tr_b16 v[94:95], v120 offset:8768
    ds_read_b64_tr_b16 v[96:97], v120 offset:8288
    ds_read_b64_tr_b16 v[98:99], v120 offset:8800
    s_waitcnt lgkmcnt(15)
    buffer_store_dwordx4 v[52:55], v251, s[12:15], s48 offen offset:0 sc1
    s_waitcnt lgkmcnt(15)
    buffer_store_dwordx4 v[56:59], v251, s[12:15], s49 offen offset:0 sc1
    s_waitcnt lgkmcnt(15)
    buffer_store_dwordx4 v[60:63], v251, s[12:15], s50 offen offset:0 sc1
    s_waitcnt lgkmcnt(15)
    buffer_store_dwordx4 v[64:67], v251, s[12:15], s51 offen offset:0 sc1
    s_waitcnt lgkmcnt(14)
    buffer_store_dwordx4 v[68:71], v251, s[12:15], s48 offen offset:1024 sc1
    s_waitcnt lgkmcnt(12)
    buffer_store_dwordx4 v[72:75], v251, s[12:15], s49 offen offset:1024 sc1
    s_waitcnt lgkmcnt(10)
    buffer_store_dwordx4 v[76:79], v251, s[12:15], s50 offen offset:1024 sc1
    s_waitcnt lgkmcnt(8)
    buffer_store_dwordx4 v[80:83], v251, s[12:15], s51 offen offset:1024 sc1
    s_waitcnt lgkmcnt(6)
    buffer_store_dwordx4 v[84:87], v251, s[12:15], s48 offen offset:2048 sc1
    s_waitcnt lgkmcnt(4)
    buffer_store_dwordx4 v[88:91], v251, s[12:15], s49 offen offset:2048 sc1
    s_waitcnt lgkmcnt(2)
    buffer_store_dwordx4 v[92:95], v251, s[12:15], s50 offen offset:2048 sc1
    s_waitcnt lgkmcnt(0)
    buffer_store_dwordx4 v[96:99], v251, s[12:15], s51 offen offset:2048 sc1
L_d1d:
    s_waitcnt vmcnt(0)
    s_lshl_b32 s24, s43, 7
    s_add_u32 s24, s24, 81920
    s_mov_b64 exec, 1
    buffer_atomic_add v128, v124, s[12:15], s24 offen
    s_mov_b64 exec, -1
    s_barrier
    s_cmp_ge_u32 s37, 54
    s_cbranch_scc1 L_pkidle
    s_add_u32 s25, s37, 0
    s_mul_i32 s32, s25, 171
    s_lshr_b32 s32, s32, 10
    s_mul_i32 s26, s32, 6
    s_sub_u32 s29, s25, s26
    s_mov_b32 s16, s72
    s_mov_b32 s17, s73
    s_mov_b32 s18, 0x510000
    s_mov_b32 s19, 0x20000
    s_lshl_b32 s45, s32, 7
    s_mul_i32 s24, s29, 884736
    s_add_u32 s45, s45, s24
    s_mul_i32 s24, s38, 1152
    s_add_u32 s45, s45, s24
    s_add_u32 m0, s47, 12288
    s_nop 0
    buffer_load_dwordx4 v4, s[16:19], s45 offen nt lds
    s_add_u32 s45, s45, 73728
    s_add_u32 m0, m0, 0x400
    s_nop 0
    buffer_load_dwordx4 v4, s[16:19], s45 offen nt lds
    s_add_u32 s45, s45, 73728
    s_add_u32 m0, m0, 0x400
    s_nop 0
    buffer_load_dwordx4 v4, s[16:19], s45 offen nt lds
    s_add_u32 s45, s45, 73728
    s_add_u32 m0, m0, 0x400
    s_nop 0
    buffer_load_dwordx4 v4, s[16:19], s45 offen nt lds
    s_add_u32 s45, s45, 73728
    s_add_u32 m0, m0, 0x400
    s_nop 0
    buffer_load_dwordx4 v4, s[16:19], s45 offen nt lds
    s_add_u32 s45, s45, 73728
    s_add_u32 m0, m0, 0x400
    s_nop 0
    buffer_load_dwordx4 v4, s[16:19], s45 offen nt lds
    s_add_u32 s45, s45, 73728
    s_add_u32 m0, m0, 0x400
    s_nop 0
    buffer_load_dwordx4 v4, s[16:19], s45 offen nt lds
    s_add_u32 s45, s45, 73728
    s_add_u32 m0, m0, 0x400
    s_nop 0
    buffer_load_dwordx4 v4, s[16:19], s45 offen nt lds
    s_add_u32 s45, s45, 73728
    s_add_u32 m0, m0, 0x400
    s_nop 0
    buffer_load_dwordx4 v4, s[16:19], s45 offen nt lds
    s_add_u32 s45, s45, 73728
    s_add_u32 m0, m0, 0x400
    s_nop 0
    buffer_load_dwordx4 v4, s[16:19], s45 offen nt lds
    s_add_u32 s45, s45, 73728
    s_add_u32 m0, m0, 0x400
    s_nop 0
    buffer_load_dwordx4 v4, s[16:19], s45 offen nt lds
    s_add_u32 s45, s45, 73728
    s_add_u32 m0, m0, 0x400
    s_nop 0
    buffer_load_dwordx4 v4, s[16:19], s45 offen nt lds
    s_add_u32 s45, s45, 73728
    s_cmp_lt_u32 s35, 54
    s_cbranch_scc0 L_iBd
    s_add_u32 s25, s35, 0
    s_mul_i32 s33, s25, 171
    s_lshr_b32 s33, s33, 10
    s_mul_i32 s26, s33, 6
    s_sub_u32 s30, s25, s26
    s_mov_b32 s16, s72
    s_mov_b32 s17, s73
    s_mov_b32 s18, 0x510000
    s_mov_b32 s19, 0x20000
    s_lshl_b32 s45, s33, 7
    s_mul_i32 s24, s30, 884736
    s_add_u32 s45, s45, s24
    s_mul_i32 s24, s38, 1152
    s_add_u32 s45, s45, s24
    s_add_u32 m0, s47, 24576
    s_nop 0
    buffer_load_dwordx4 v4, s[16:19], s45 offen nt lds
    s_add_u32 s45, s45, 73728
    s_add_u32 m0, m0, 0x400
    s_nop 0
    buffer_load_dwordx4 v4, s[16:19], s45 offen nt lds
    s_add_u32 s45, s45, 73728
    s_add_u32 m0, m0, 0x400
    s_nop 0
    buffer_load_dwordx4 v4, s[16:19], s45 offen nt lds
    s_add_u32 s45, s45, 73728
    s_add_u32 m0, m0, 0x400
    s_nop 0
    buffer_load_dwordx4 v4, s[16:19], s45 offen nt lds
    s_add_u32 s45, s45, 73728
    s_add_u32 m0, m0, 0x400
    s_nop 0
    buffer_load_dwordx4 v4, s[16:19], s45 offen nt lds
    s_add_u32 s45, s45, 73728
    s_add_u32 m0, m0, 0x400
    s_nop 0
    buffer_load_dwordx4 v4, s[16:19], s45 offen nt lds
    s_add_u32 s45, s45, 73728
    s_add_u32 m0, m0, 0x400
    s_nop 0
    buffer_load_dwordx4 v4, s[16:19], s45 offen nt lds
    s_add_u32 s45, s45, 73728
    s_add_u32 m0, m0, 0x400
    s_nop 0
    buffer_load_dwordx4 v4, s[16:19], s45 offen nt lds
    s_add_u32 s45, s45, 73728
    s_add_u32 m0, m0, 0x400
    s_nop 0
    buffer_load_dwordx4 v4, s[16:19], s45 offen nt lds
    s_add_u32 s45, s45, 73728
    s_add_u32 m0, m0, 0x400
    s_nop 0
    buffer_load_dwordx4 v4, s[16:19], s45 offen nt lds
    s_add_u32 s45, s45, 73728
    s_add_u32 m0, m0, 0x400
    s_nop 0
    buffer_load_dwordx4 v4, s[16:19], s45 offen nt lds
    s_add_u32 s45, s45, 73728
    s_add_u32 m0, m0, 0x400
    s_nop 0
    buffer_load_dwordx4 v4, s[16:19], s45 offen nt lds
    s_add_u32 s45, s45, 73728
L_iBd:
    s_cmp_lt_u32 s35, 54
    s_cbranch_scc1 L_dA2
    s_waitcnt vmcnt(0)
L_dA2:
    s_lshl_b32 s24, s32, 2
    s_add_u32 s24, s24, 0
    s_mul_i32 s25, s24, 57
    s_lshr_b32 s25, s25, 9
    s_mul_i32 s26, s25, 9
    s_sub_u32 s26, s24, s26
    s_mul_i32 s25, s25, 18
    s_add_u32 s25, s25, s26
    s_mul_i32 s26, s38, 72
    s_add_u32 s25, s25, s26
    s_mul_i32 s24, s25, 18
    s_add_u32 s24, s24, 8192
    s_mul_i32 s26, s29, 3
    s_add_u32 s24, s24, s26
    s_lshl_b32 s64, s24, 10
    s_lshl_b32 s24, s32, 2
    s_add_u32 s24, s24, 1
    s_mul_i32 s25, s24, 57
    s_lshr_b32 s25, s25, 9
    s_mul_i32 s26, s25, 9
    s_sub_u32 s26, s24, s26
    s_mul_i32 s25, s25, 18
    s_add_u32 s25, s25, s26
    s_mul_i32 s26, s38, 72
    s_add_u32 s25, s25, s26
    s_mul_i32 s24, s25, 18
    s_add_u32 s24, s24, 8192
    s_mul_i32 s26, s29, 3
    s_add_u32 s24, s24, s26
    s_lshl_b32 s65, s24, 10
    s_lshl_b32 s24, s32, 2
    s_add_u32 s24, s24, 2
    s_mul_i32 s25, s24, 57
    s_lshr_b32 s25, s25, 9
    s_mul_i32 s26, s25, 9
    s_sub_u32 s26, s24, s26
    s_mul_i32 s25, s25, 18
    s_add_u32 s25, s25, s26
    s_mul_i32 s26, s38, 72
    s_add_u32 s25, s25, s26
    s_mul_i32 s24, s25, 18
    s_add_u32 s24, s24, 8192
    s_mul_i32 s26, s29, 3
    s_add_u32 s24, s24, s26
    s_lshl_b32 s66, s24, 10
    s_lshl_b32 s24, s32, 2
    s_add_u32 s24, s24, 3
    s_mul_i32 s25, s24, 57
    s_lshr_b32 s25, s25, 9
    s_mul_i32 s26, s25, 9
    s_sub_u32 s26, s24, s26
    s_mul_i32 s25, s25, 18
    s_add_u32 s25, s25, s26
    s_mul_i32 s26, s38, 72
    s_add_u32 s25, s25, s26
    s_mul_i32 s24, s25, 18
    s_add_u32 s24, s24, 8192
    s_mul_i32 s26, s29, 3
    s_add_u32 s24, s24, s26
    s_lshl_b32 s67, s24, 10
    s_mul_i32 s24, s38, 9
    s_add_u32 s24, s24, s32
    s_lshl_b32 s24, s24, 8
    s_add_u32 s52, s24, 104448
    s_waitcnt vmcnt(12)
    ds_read_b64_tr_b16 v[52:53], v120 offset:12288
    ds_read_b64_tr_b16 v[54:55], v120 offset:12800
    ds_read_b64_tr_b16 v[56:57], v120 offset:12320
    ds_read_b64_tr_b16 v[58:59], v120 offset:12832
    ds_read_b64_tr_b16 v[60:61], v120 offset:12352
    ds_read_b64_tr_b16 v[62:63], v120 offset:12864
    ds_read_b64_tr_b16 v[64:65], v120 offset:12384
    ds_read_b64_tr_b16 v[66:67], v120 offset:12896
    ds_read_b64_tr_b16 v[68:69], v120 offset:16384
    ds_read_b64_tr_b16 v[70:71], v120 offset:16896
    ds_read_b64_tr_b16 v[72:73], v120 offset:16416
    ds_read_b64_tr_b16 v[74:75], v120 offset:16928
    s_waitcnt lgkmcnt(3)
    ds_read_b64_tr_b16 v[76:77], v120 offset:16448
    ds_read_b64_tr_b16 v[78:79], v120 offset:16960
    ds_read_b64_tr_b16 v[80:81], v120 offset:16480
    ds_read_b64_tr_b16 v[82:83], v120 offset:16992
    ds_read_b64_tr_b16 v[84:85], v120 offset:20480
    ds_read_b64_tr_b16 v[86:87], v120 offset:20992
    ds_read_b64_tr_b16 v[88:89], v120 offset:20512
    ds_read_b64_tr_b16 v[90:91], v120 offset:21024
    ds_read_b64_tr_b16 v[92:93], v120 offset:20544
    ds_read_b64_tr_b16 v[94:95], v120 offset:21056
    ds_read_b64_tr_b16 v[96:97], v120 offset:20576
    ds_read_b64_tr_b16 v[98:99], v120 offset:21088
    s_waitcnt lgkmcnt(15)
    buffer_store_dwordx4 v[52:55], v251, s[12:15], s64 offen offset:0 sc1
    v_mfma_f32_16x16x32_bf16 v[100:103], v[116:119], v[52:55], 0
    s_waitcnt lgkmcnt(15)
    buffer_store_dwordx4 v[56:59], v251, s[12:15], s65 offen offset:0 sc1
    v_mfma_f32_16x16x32_bf16 v[104:107], v[116:119], v[56:59], 0
    s_waitcnt lgkmcnt(15)
    buffer_store_dwordx4 v[60:63], v251, s[12:15], s66 offen offset:0 sc1
    v_mfma_f32_16x16x32_bf16 v[108:111], v[116:119], v[60:63], 0
    s_waitcnt lgkmcnt(15)
    buffer_store_dwordx4 v[64:67], v251, s[12:15], s67 offen offset:0 sc1
    v_mfma_f32_16x16x32_bf16 v[112:115], v[116:119], v[64:67], 0
    s_waitcnt lgkmcnt(14)
    buffer_store_dwordx4 v[68:71], v251, s[12:15], s64 offen offset:1024 sc1
    v_mfma_f32_16x16x32_bf16 v[100:103], v[116:119], v[68:71], v[100:103]
    s_waitcnt lgkmcnt(12)
    buffer_store_dwordx4 v[72:75], v251, s[12:15], s65 offen offset:1024 sc1
    v_mfma_f32_16x16x32_bf16 v[104:107], v[116:119], v[72:75], v[104:107]
    s_waitcnt lgkmcnt(10)
    buffer_store_dwordx4 v[76:79], v251, s[12:15], s66 offen offset:1024 sc1
    v_mfma_f32_16x16x32_bf16 v[108:111], v[116:119], v[76:79], v[108:111]
    s_waitcnt lgkmcnt(8)
    buffer_store_dwordx4 v[80:83], v251, s[12:15], s67 offen offset:1024 sc1
    v_mfma_f32_16x16x32_bf16 v[112:115], v[116:119], v[80:83], v[112:115]
    s_waitcnt lgkmcnt(6)
    buffer_store_dwordx4 v[84:87], v251, s[12:15], s64 offen offset:2048 sc1
    v_mfma_f32_16x16x32_bf16 v[100:103], v[116:119], v[84:87], v[100:103]
    s_waitcnt lgkmcnt(4)
    buffer_store_dwordx4 v[88:91], v251, s[12:15], s65 offen offset:2048 sc1
    v_mfma_f32_16x16x32_bf16 v[104:107], v[116:119], v[88:91], v[104:107]
    s_waitcnt lgkmcnt(2)
    buffer_store_dwordx4 v[92:95], v251, s[12:15], s66 offen offset:2048 sc1
    v_mfma_f32_16x16x32_bf16 v[108:111], v[116:119], v[92:95], v[108:111]
    s_waitcnt lgkmcnt(0)
    buffer_store_dwordx4 v[96:99], v251, s[12:15], s67 offen offset:2048 sc1
    v_mfma_f32_16x16x32_bf16 v[112:115], v[116:119], v[96:99], v[112:115]
    s_nop 7
    v_cndmask_b32 v130, v100, v104, s[54:55]
    v_cndmask_b32 v130, v130, v108, s[56:57]
    v_cndmask_b32 v130, v130, v112, s[8:9]
    buffer_atomic_add_f32 v130, v129, s[12:15], s52 offen
    s_cmp_lt_u32 s35, 54
    s_cbranch_scc0 L_dBd
    s_lshl_b32 s24, s33, 2
    s_add_u32 s24, s24, 0
    s_mul_i32 s25, s24, 57
    s_lshr_b32 s25, s25, 9
    s_mul_i32 s26, s25, 9
    s_sub_u32 s26, s24, s26
    s_mul_i32 s25, s25, 18
    s_add_u32 s25, s25, s26
    s_mul_i32 s26, s38, 72
    s_add_u32 s25, s25, s26
    s_mul_i32 s24, s25, 18
    s_add_u32 s24, s24, 8192
    s_mul_i32 s26, s30, 3
    s_add_u32 s24, s24, s26
    s_lshl_b32 s68, s24, 10
    s_lshl_b32 s24, s33, 2
    s_add_u32 s24, s24, 1
    s_mul_i32 s25, s24, 57
    s_lshr_b32 s25, s25, 9
    s_mul_i32 s26, s25, 9
    s_sub_u32 s26, s24, s26
    s_mul_i32 s25, s25, 18
    s_add_u32 s25, s25, s26
    s_mul_i32 s26, s38, 72
    s_add_u32 s25, s25, s26
    s_mul_i32 s24, s25, 18
    s_add_u32 s24, s24, 8192
    s_mul_i32 s26, s30, 3
    s_add_u32 s24, s24, s26
    s_lshl_b32 s69, s24, 10
    s_lshl_b32 s24, s33, 2
    s_add_u32 s24, s24, 2
    s_mul_i32 s25, s24, 57
    s_lshr_b32 s25, s25, 9
    s_mul_i32 s26, s25, 9
    s_sub_u32 s26, s24, s26
    s_mul_i32 s25, s25, 18
    s_add_u32 s25, s25, s26
    s_mul_i32 s26, s38, 72
    s_add_u32 s25, s25, s26
    s_mul_i32 s24, s25, 18
    s_add_u32 s24, s24, 8192
    s_mul_i32 s26, s30, 3
    s_add_u32 s24, s24, s26
    s_lshl_b32 s70, s24, 10
    s_lshl_b32 s24, s33, 2
    s_add_u32 s24, s24, 3
    s_mul_i32 s25, s24, 57
    s_lshr_b32 s25, s25, 9
    s_mul_i32 s26, s25, 9
    s_sub_u32 s26, s24, s26
    s_mul_i32 s25, s25, 18
    s_add_u32 s25, s25, s26
    s_mul_i32 s26, s38, 72
    s_add_u32 s25, s25, s26
    s_mul_i32 s24, s25, 18
    s_add_u32 s24, s24, 8192
    s_mul_i32 s26, s30, 3
    s_add_u32 s24, s24, s26
    s_lshl_b32 s71, s24, 10
    s_mul_i32 s24, s38, 9
    s_add_u32 s24, s24, s33
    s_lshl_b32 s24, s24, 8
    s_add_u32 s53, s24, 104448
    s_waitcnt vmcnt(13)
    ds_read_b64_tr_b16 v[52:53], v120 offset:24576
    ds_read_b64_tr_b16 v[54:55], v120 offset:25088
    ds_read_b64_tr_b16 v[56:57], v120 offset:24608
    ds_read_b64_tr_b16 v[58:59], v120 offset:25120
    ds_read_b64_tr_b16 v[60:61], v120 offset:24640
    ds_read_b64_tr_b16 v[62:63], v120 offset:25152
    ds_read_b64_tr_b16 v[64:65], v120 offset:24672
    ds_read_b64_tr_b16 v[66:67], v120 offset:25184
    ds_read_b64_tr_b16 v[68:69], v120 offset:28672
    ds_read_b64_tr_b16 v[70:71], v120 offset:29184
    ds_read_b64_tr_b16 v[72:73], v120 offset:28704
    ds_read_b64_tr_b16 v[74:75], v120 offset:29216
    s_waitcnt lgkmcnt(3)
    ds_read_b64_tr_b16 v[76:77], v120 offset:28736
    ds_read_b64_tr_b16 v[78:79], v120 offset:29248
    ds_read_b64_tr_b16 v[80:81], v120 offset:28768
    ds_read_b64_tr_b16 v[82:83], v120 offset:29280
    ds_read_b64_tr_b16 v[84:85], v120 offset:32768
    ds_read_b64_tr_b16 v[86:87], v120 offset:33280
    ds_read_b64_tr_b16 v[88:89], v120 offset:32800
    ds_read_b64_tr_b16 v[90:91], v120 offset:33312
    ds_read_b64_tr_b16 v[92:93], v120 offset:32832
    ds_read_b64_tr_b16 v[94:95], v120 offset:33344
    ds_read_b64_tr_b16 v[96:97], v120 offset:32864
    ds_read_b64_tr_b16 v[98:99], v120 offset:33376
    s_waitcnt lgkmcnt(15)
    buffer_store_dwordx4 v[52:55], v251, s[12:15], s68 offen offset:0 sc1
    v_mfma_f32_16x16x32_bf16 v[100:103], v[116:119], v[52:55], 0
    s_waitcnt lgkmcnt(15)
    buffer_store_dwordx4 v[56:59], v251, s[12:15], s69 offen offset:0 sc1
    v_mfma_f32_16x16x32_bf16 v[104:107], v[116:119], v[56:59], 0
    s_waitcnt lgkmcnt(15)
    buffer_store_dwordx4 v[60:63], v251, s[12:15], s70 offen offset:0 sc1
    v_mfma_f32_16x16x32_bf16 v[108:111], v[116:119], v[60:63], 0
    s_waitcnt lgkmcnt(15)
    buffer_store_dwordx4 v[64:67], v251, s[12:15], s71 offen offset:0 sc1
    v_mfma_f32_16x16x32_bf16 v[112:115], v[116:119], v[64:67], 0
    s_waitcnt lgkmcnt(14)
    buffer_store_dwordx4 v[68:71], v251, s[12:15], s68 offen offset:1024 sc1
    v_mfma_f32_16x16x32_bf16 v[100:103], v[116:119], v[68:71], v[100:103]
    s_waitcnt lgkmcnt(12)
    buffer_store_dwordx4 v[72:75], v251, s[12:15], s69 offen offset:1024 sc1
    v_mfma_f32_16x16x32_bf16 v[104:107], v[116:119], v[72:75], v[104:107]
    s_waitcnt lgkmcnt(10)
    buffer_store_dwordx4 v[76:79], v251, s[12:15], s70 offen offset:1024 sc1
    v_mfma_f32_16x16x32_bf16 v[108:111], v[116:119], v[76:79], v[108:111]
    s_waitcnt lgkmcnt(8)
    buffer_store_dwordx4 v[80:83], v251, s[12:15], s71 offen offset:1024 sc1
    v_mfma_f32_16x16x32_bf16 v[112:115], v[116:119], v[80:83], v[112:115]
    s_waitcnt lgkmcnt(6)
    buffer_store_dwordx4 v[84:87], v251, s[12:15], s68 offen offset:2048 sc1
    v_mfma_f32_16x16x32_bf16 v[100:103], v[116:119], v[84:87], v[100:103]
    s_waitcnt lgkmcnt(4)
    buffer_store_dwordx4 v[88:91], v251, s[12:15], s69 offen offset:2048 sc1
    v_mfma_f32_16x16x32_bf16 v[104:107], v[116:119], v[88:91], v[104:107]
    s_waitcnt lgkmcnt(2)
    buffer_store_dwordx4 v[92:95], v251, s[12:15], s70 offen offset:2048 sc1
    v_mfma_f32_16x16x32_bf16 v[108:111], v[116:119], v[92:95], v[108:111]
    s_waitcnt lgkmcnt(0)
    buffer_store_dwordx4 v[96:99], v251, s[12:15], s71 offen offset:2048 sc1
    v_mfma_f32_16x16x32_bf16 v[112:115], v[116:119], v[96:99], v[112:115]
    s_nop 7
    v_cndmask_b32 v131, v100, v104, s[54:55]
    v_cndmask_b32 v131, v131, v108, s[56:57]
    v_cndmask_b32 v131, v131, v112, s[8:9]
    buffer_atomic_add_f32 v131, v129, s[12:15], s53 offen
L_dBd:
    s_add_u32 s25, s37, 0
    s_mul_i32 s31, s25, 171
    s_lshr_b32 s31, s31, 10
    s_mul_i32 s26, s31, 6
    s_sub_u32 s28, s25, s26
    s_mov_b32 s16, s76
    s_mov_b32 s17, s77
    s_mov_b32 s18, 0x510000
    s_mov_b32 s19, 0x20000
    s_lshl_b32 s46, s31, 7
    s_mul_i32 s24, s38, 663552
    s_add_u32 s46, s46, s24
    s_add_u32 m0, s47, 0
    s_nop 0
    s_mul_i32 s24, s28, 3
    s_add_u32 s24, s24, 0
    s_mul_i32 s25, s28, 144
    s_add_u32 s25, s25, 0
    s_mul_i32 s26, s24, 144
    s_sub_u32 s26, s26, 1632
    s_cmp_lt_u32 s24, 12
    s_cselect_b32 s25, s25, s26
    s_mul_i32 s26, s24, 288
    s_sub_u32 s26, s26, 4480
    s_cmp_lt_u32 s24, 16
    s_cselect_b32 s25, s25, s26
    s_cselect_b64 vcc, -1, 0
    s_mul_i32 s25, s25, 1152
    s_add_u32 s45, s25, s46
    v_cndmask_b32 v8, v6, v5, vcc
    buffer_load_dwordx4 v8, s[16:19], s45 offen nt lds
    s_add_u32 s45, s45, 4608
    s_add_u32 m0, m0, 0x400
    s_nop 0
    buffer_load_dwordx4 v8, s[16:19], s45 offen nt lds
    s_add_u32 s45, s45, 4608
    s_add_u32 m0, m0, 0x400
    s_nop 0
    buffer_load_dwordx4 v8, s[16:19], s45 offen nt lds
    s_add_u32 s45, s45, 4608
    s_add_u32 m0, m0, 0x400
    s_nop 0
    buffer_load_dwordx4 v8, s[16:19], s45 offen nt lds
    s_add_u32 s45, s45, 4608
    s_add_u32 m0, m0, 0x400
    s_nop 0
    s_mul_i32 s24, s28, 3
    s_add_u32 s24, s24, 1
    s_mul_i32 s25, s28, 144
    s_add_u32 s25, s25, 32
    s_mul_i32 s26, s24, 144
    s_sub_u32 s26, s26, 1632
    s_cmp_lt_u32 s24, 12
    s_cselect_b32 s25, s25, s26
    s_mul_i32 s26, s24, 288
    s_sub_u32 s26, s26, 4480
    s_cmp_lt_u32 s24, 16
    s_cselect_b32 s25, s25, s26
    s_cselect_b64 vcc, -1, 0
    s_mul_i32 s25, s25, 1152
    s_add_u32 s45, s25, s46
    v_cndmask_b32 v8, v6, v5, vcc
    buffer_load_dwordx4 v8, s[16:19], s45 offen nt lds
    s_add_u32 s45, s45, 4608
    s_add_u32 m0, m0, 0x400
    s_nop 0
    buffer_load_dwordx4 v8, s[16:19], s45 offen nt lds
    s_add_u32 s45, s45, 4608
    s_add_u32 m0, m0, 0x400
    s_nop 0
    s_waitcnt vmcnt(6)
    s_lshl_b32 s24, s43, 7
    s_add_u32 s24, s24, 88064
    s_mov_b64 exec, 1
    buffer_atomic_add v128, v124, s[12:15], s24 offen
    s_mov_b64 exec, -1
    s_cmp_lt_u32 s35, 54
    s_cbranch_scc0 L_tBd
L_tBd:
    buffer_load_dwordx4 v8, s[16:19], s45 offen nt lds
    s_add_u32 s45, s45, 4608
    s_add_u32 m0, m0, 0x400
    s_nop 0
    buffer_load_dwordx4 v8, s[16:19], s45 offen nt lds
    s_add_u32 s45, s45, 4608
    s_add_u32 m0, m0, 0x400
    s_nop 0
    s_mul_i32 s24, s28, 3
    s_add_u32 s24, s24, 2
    s_mul_i32 s25, s28, 144
    s_add_u32 s25, s25, 64
    s_mul_i32 s26, s24, 144
    s_sub_u32 s26, s26, 1632
    s_cmp_lt_u32 s24, 12
    s_cselect_b32 s25, s25, s26
    s_mul_i32 s26, s24, 288
    s_sub_u32 s26, s26, 4480
    s_cmp_lt_u32 s24, 16
    s_cselect_b32 s25, s25, s26
    s_cselect_b64 vcc, -1, 0
    s_mul_i32 s25, s25, 1152
    s_add_u32 s45, s25, s46
    v_cndmask_b32 v8, v6, v5, vcc
    buffer_load_dwordx4 v8, s[16:19], s45 offen nt lds
    s_add_u32 s45, s45, 4608
    s_add_u32 m0, m0, 0x400
    s_nop 0
    buffer_load_dwordx4 v8, s[16:19], s45 offen nt lds
    s_add_u32 s45, s45, 4608
    s_add_u32 m0, m0, 0x400
    s_nop 0
    buffer_load_dwordx4 v8, s[16:19], s45 offen nt lds
    s_add_u32 s45, s45, 4608
    s_add_u32 m0, m0, 0x400
    s_nop 0
    buffer_load_dwordx4 v8, s[16:19], s45 offen nt lds
    s_add_u32 s45, s45, 4608
    s_cmp_lt_u32 s36, 54
    s_cbranch_scc0 L_iCn
    s_add_u32 s25, s36, 0
    s_mul_i32 s32, s25, 171
    s_lshr_b32 s32, s32, 10
    s_mul_i32 s26, s32, 6
    s_sub_u32 s29, s25, s26
    s_mov_b32 s16, s76
    s_mov_b32 s17, s77
    s_mov_b32 s18, 0x510000
    s_mov_b32 s19, 0x20000
    s_lshl_b32 s46, s32, 7
    s_mul_i32 s24, s38, 663552
    s_add_u32 s46, s46, s24
    s_add_u32 m0, s47, 12288
    s_nop 0
    s_mul_i32 s24, s29, 3
    s_add_u32 s24, s24, 0
    s_mul_i32 s25, s29, 144
    s_add_u32 s25, s25, 0
    s_mul_i32 s26, s24, 144
    s_sub_u32 s26, s26, 1632
    s_cmp_lt_u32 s24, 12
    s_cselect_b32 s25, s25, s26
    s_mul_i32 s26, s24, 288
    s_sub_u32 s26, s26, 4480
    s_cmp_lt_u32 s24, 16
    s_cselect_b32 s25, s25, s26
    s_cselect_b64 vcc, -1, 0
    s_mul_i32 s25, s25, 1152
    s_add_u32 s45, s25, s46
    v_cndmask_b32 v8, v6, v5, vcc
    buffer_load_dwordx4 v8, s[16:19], s45 offen nt lds
    s_add_u32 s45, s45, 4608
    s_add_u32 m0, m0, 0x400
    s_nop 0
    buffer_load_dwordx4 v8, s[16:19], s45 offen nt lds
    s_add_u32 s45, s45, 4608
    s_add_u32 m0, m0, 0x400
    s_nop 0
    buffer_load_dwordx4 v8, s[16:19], s45 offen nt lds
    s_add_u32 s45, s45, 4608
    s_add_u32 m0, m0, 0x400
    s_nop 0
    buffer_load_dwordx4 v8, s[16:19], s45 offen nt lds
    s_add_u32 s45, s45, 4608
    s_add_u32 m0, m0, 0x400
    s_nop 0
    s_mul_i32 s24, s29, 3
    s_add_u32 s24, s24, 1
    s_mul_i32 s25, s29, 144
    s_add_u32 s25, s25, 32
    s_mul_i32 s26, s24, 144
    s_sub_u32 s26, s26, 1632
    s_cmp_lt_u32 s24, 12
    s_cselect_b32 s25, s25, s26
    s_mul_i32 s26, s24, 288
    s_sub_u32 s26, s26, 4480
    s_cmp_lt_u32 s24, 16
    s_cselect_b32 s25, s25, s26
    s_cselect_b64 vcc, -1, 0
    s_mul_i32 s25, s25, 1152
    s_add_u32 s45, s25, s46
    v_cndmask_b32 v8, v6, v5, vcc
    buffer_load_dwordx4 v8, s[16:19], s45 offen nt lds
    s_add_u32 s45, s45, 4608
    s_add_u32 m0, m0, 0x400
    s_nop 0
    buffer_load_dwordx4 v8, s[16:19], s45 offen nt lds
    s_add_u32 s45, s45, 4608
    s_add_u32 m0, m0, 0x400
    s_nop 0
    buffer_load_dwordx4 v8, s[16:19], s45 offen nt lds
    s_add_u32 s45, s45, 4608
    s_add_u32 m0, m0, 0x400
    s_nop 0
    buffer_load_dwordx4 v8, s[16:19], s45 offen nt lds
    s_add_u32 s45, s45, 4608
    s_add_u32 m0, m0, 0x400
    s_nop 0
    s_mul_i32 s24, s29, 3
    s_add_u32 s24, s24, 2
    s_mul_i32 s25, s29, 144
    s_add_u32 s25, s25, 64
    s_mul_i32 s26, s24, 144
    s_sub_u32 s26, s26, 1632
    s_cmp_lt_u32 s24, 12
    s_cselect_b32 s25, s25, s26
    s_mul_i32 s26, s24, 288
    s_sub_u32 s26, s26, 4480
    s_cmp_lt_u32 s24, 16
    s_cselect_b32 s25, s25, s26
    s_cselect_b64 vcc, -1, 0
    s_mul_i32 s25, s25, 1152
    s_add_u32 s45, s25, s46
    v_cndmask_b32 v8, v6, v5, vcc
    buffer_load_dwordx4 v8, s[16:19], s45 offen nt lds
    s_add_u32 s45, s45, 4608
    s_add_u32 m0, m0, 0x400
    s_nop 0
    buffer_load_dwordx4 v8, s[16:19], s45 offen nt lds
    s_add_u32 s45, s45, 4608
    s_add_u32 m0, m0, 0x400
    s_nop 0
    buffer_load_dwordx4 v8, s[16:19], s45 offen nt lds
    s_add_u32 s45, s45, 4608
    s_add_u32 m0, m0, 0x400
    s_nop 0
    buffer_load_dwordx4 v8, s[16:19], s45 offen nt lds
    s_add_u32 s45, s45, 4608
    s_branch L_iCd
L_iCn:
    s_waitcnt vmcnt(0)
L_iCd:
    s_lshl_b32 s24, s31, 2
    s_add_u32 s24, s24, 0
    s_mov_b32 s25, 0
    s_mov_b32 s26, s31
    s_sub_u32 s27, s26, s38
    s_add_u32 s27, s27, 7
    s_and_b32 s27, s27, 7
    s_add_u32 s27, s27, 10
    s_cmp_eq_u32 s26, 8
    s_cselect_b32 s26, 9, s27
    s_mul_i32 s25, s25, 18
    s_add_u32 s25, s25, s26
    s_mul_i32 s26, s38, 72
    s_add_u32 s25, s25, s26
    s_mul_i32 s24, s25, 18
    s_add_u32 s24, s24, 8192
    s_mul_i32 s26, s28, 3
    s_add_u32 s24, s24, s26
    s_lshl_b32 s48, s24, 10
    s_lshl_b32 s24, s31, 2
    s_add_u32 s24, s24, 1
    s_mov_b32 s25, 1
    s_mov_b32 s26, s31
    s_sub_u32 s27, s26, s38
    s_add_u32 s27, s27, 7
    s_and_b32 s27, s27, 7
    s_add_u32 s27, s27, 10
    s_cmp_eq_u32 s26, 8
    s_cselect_b32 s26, 9, s27
    s_mul_i32 s25, s25, 18
    s_add_u32 s25, s25, s26
    s_mul_i32 s26, s38, 72
    s_add_u32 s25, s25, s26
    s_mul_i32 s24, s25, 18
    s_add_u32 s24, s24, 8192
    s_mul_i32 s26, s28, 3
    s_add_u32 s24, s24, s26
    s_lshl_b32 s49, s24, 10
    s_lshl_b32 s24, s31, 2
    s_add_u32 s24, s24, 2
    s_mov_b32 s25, 2
    s_mov_b32 s26, s31
    s_sub_u32 s27, s26, s38
    s_add_u32 s27, s27, 7
    s_and_b32 s27, s27, 7
    s_add_u32 s27, s27, 10
    s_cmp_eq_u32 s26, 8
    s_cselect_b32 s26, 9, s27
    s_mul_i32 s25, s25, 18
    s_add_u32 s25, s25, s26
    s_mul_i32 s26, s38, 72
    s_add_u32 s25, s25, s26
    s_mul_i32 s24, s25, 18
    s_add_u32 s24, s24, 8192
    s_mul_i32 s26, s28, 3
    s_add_u32 s24, s24, s26
    s_lshl_b32 s50, s24, 10
    s_lshl_b32 s24, s31, 2
    s_add_u32 s24, s24, 3
    s_mov_b32 s25, 3
    s_mov_b32 s26, s31
    s_sub_u32 s27, s26, s38
    s_add_u32 s27, s27, 7
    s_and_b32 s27, s27, 7
    s_add_u32 s27, s27, 10
    s_cmp_eq_u32 s26, 8
    s_cselect_b32 s26, 9, s27
    s_mul_i32 s25, s25, 18
    s_add_u32 s25, s25, s26
    s_mul_i32 s26, s38, 72
    s_add_u32 s25, s25, s26
    s_mul_i32 s24, s25, 18
    s_add_u32 s24, s24, 8192
    s_mul_i32 s26, s28, 3
    s_add_u32 s24, s24, s26
    s_lshl_b32 s51, s24, 10
    s_waitcnt vmcnt(12)
    ds_read_b64_tr_b16 v[52:53], v120 offset:0
    ds_read_b64_tr_b16 v[54:55], v120 offset:512
    ds_read_b64_tr_b16 v[56:57], v120 offset:32
    ds_read_b64_tr_b16 v[58:59], v120 offset:544
    ds_read_b64_tr_b16 v[60:61], v120 offset:64
    ds_read_b64_tr_b16 v[62:63], v120 offset:576
    ds_read_b64_tr_b16 v[64:65], v120 offset:96
    ds_read_b64_tr_b16 v[66:67], v120 offset:608
    ds_read_b64_tr_b16 v[68:69], v120 offset:4096
    ds_read_b64_tr_b16 v[70:71], v120 offset:4608
    ds_read_b64_tr_b16 v[72:73], v120 offset:4128
    ds_read_b64_tr_b16 v[74:75], v120 offset:4640
    s_waitcnt lgkmcnt(3)
    ds_read_b64_tr_b16 v[76:77], v120 offset:4160
    ds_read_b64_tr_b16 v[78:79], v120 offset:4672
    ds_read_b64_tr_b16 v[80:81], v120 offset:4192
    ds_read_b64_tr_b16 v[82:83], v120 offset:4704
    ds_read_b64_tr_b16 v[84:85], v120 offset:8192
    ds_read_b64_tr_b16 v[86:87], v120 offset:8704
    ds_read_b64_tr_b16 v[88:89], v120 offset:8224
    ds_read_b64_tr_b16 v[90:91], v120 offset:8736
    ds_read_b64_tr_b16 v[92:93], v120 offset:8256
    ds_read_b64_tr_b16 v[94:95], v120 offset:8768
    ds_read_b64_tr_b16 v[96:97], v120 offset:8288
    ds_read_b64_tr_b16 v[98:99], v120 offset:8800
    s_waitcnt lgkmcnt(15)
    buffer_store_dwordx4 v[52:55], v251, s[12:15], s48 offen offset:0 sc1
    s_waitcnt lgkmcnt(15)
    buffer_store_dwordx4 v[56:59], v251, s[12:15], s49 offen offset:0 sc1
    s_waitcnt lgkmcnt(15)
    buffer_store_dwordx4 v[60:63], v251, s[12:15], s50 offen offset:0 sc1
    s_waitcnt lgkmcnt(15)
    buffer_store_dwordx4 v[64:67], v251, s[12:15], s51 offen offset:0 sc1
    s_waitcnt lgkmcnt(14)
    buffer_store_dwordx4 v[68:71], v251, s[12:15], s48 offen offset:1024 sc1
    s_waitcnt lgkmcnt(12)
    buffer_store_dwordx4 v[72:75], v251, s[12:15], s49 offen offset:1024 sc1
    s_waitcnt lgkmcnt(10)
    buffer_store_dwordx4 v[76:79], v251, s[12:15], s50 offen offset:1024 sc1
    s_waitcnt lgkmcnt(8)
    buffer_store_dwordx4 v[80:83], v251, s[12:15], s51 offen offset:1024 sc1
    s_waitcnt lgkmcnt(6)
    buffer_store_dwordx4 v[84:87], v251, s[12:15], s48 offen offset:2048 sc1
    s_waitcnt lgkmcnt(4)
    buffer_store_dwordx4 v[88:91], v251, s[12:15], s49 offen offset:2048 sc1
    s_waitcnt lgkmcnt(2)
    buffer_store_dwordx4 v[92:95], v251, s[12:15], s50 offen offset:2048 sc1
    s_waitcnt lgkmcnt(0)
    buffer_store_dwordx4 v[96:99], v251, s[12:15], s51 offen offset:2048 sc1
    s_cmp_lt_u32 s36, 54
    s_cbranch_scc0 L_dCd
    s_lshl_b32 s24, s32, 2
    s_add_u32 s24, s24, 0
    s_mov_b32 s25, 0
    s_mov_b32 s26, s32
    s_sub_u32 s27, s26, s38
    s_add_u32 s27, s27, 7
    s_and_b32 s27, s27, 7
    s_add_u32 s27, s27, 10
    s_cmp_eq_u32 s26, 8
    s_cselect_b32 s26, 9, s27
    s_mul_i32 s25, s25, 18
    s_add_u32 s25, s25, s26
    s_mul_i32 s26, s38, 72
    s_add_u32 s25, s25, s26
    s_mul_i32 s24, s25, 18
    s_add_u32 s24, s24, 8192
    s_mul_i32 s26, s29, 3
    s_add_u32 s24, s24, s26
    s_lshl_b32 s64, s24, 10
    s_lshl_b32 s24, s32, 2
    s_add_u32 s24, s24, 1
    s_mov_b32 s25, 1
    s_mov_b32 s26, s32
    s_sub_u32 s27, s26, s38
    s_add_u32 s27, s27, 7
    s_and_b32 s27, s27, 7
    s_add_u32 s27, s27, 10
    s_cmp_eq_u32 s26, 8
    s_cselect_b32 s26, 9, s27
    s_mul_i32 s25, s25, 18
    s_add_u32 s25, s25, s26
    s_mul_i32 s26, s38, 72
    s_add_u32 s25, s25, s26
    s_mul_i32 s24, s25, 18
    s_add_u32 s24, s24, 8192
    s_mul_i32 s26, s29, 3
    s_add_u32 s24, s24, s26
    s_lshl_b32 s65, s24, 10
    s_lshl_b32 s24, s32, 2
    s_add_u32 s24, s24, 2
    s_mov_b32 s25, 2
    s_mov_b32 s26, s32
    s_sub_u32 s27, s26, s38
    s_add_u32 s27, s27, 7
    s_and_b32 s27, s27, 7
    s_add_u32 s27, s27, 10
    s_cmp_eq_u32 s26, 8
    s_cselect_b32 s26, 9, s27
    s_mul_i32 s25, s25, 18
    s_add_u32 s25, s25, s26
    s_mul_i32 s26, s38, 72
    s_add_u32 s25, s25, s26
    s_mul_i32 s24, s25, 18
    s_add_u32 s24, s24, 8192
    s_mul_i32 s26, s29, 3
    s_add_u32 s24, s24, s26
    s_lshl_b32 s66, s24, 10
    s_lshl_b32 s24, s32, 2
    s_add_u32 s24, s24, 3
    s_mov_b32 s25, 3
    s_mov_b32 s26, s32
    s_sub_u32 s27, s26, s38
    s_add_u32 s27, s27, 7
    s_and_b32 s27, s27, 7
    s_add_u32 s27, s27, 10
    s_cmp_eq_u32 s26, 8
    s_cselect_b32 s26, 9, s27
    s_mul_i32 s25, s25, 18
    s_add_u32 s25, s25, s26
    s_mul_i32 s26, s38, 72
    s_add_u32 s25, s25, s26
    s_mul_i32 s24, s25, 18
    s_add_u32 s24, s24, 8192
    s_mul_i32 s26, s29, 3
    s_add_u32 s24, s24, s26
    s_lshl_b32 s67, s24, 10
    s_waitcnt vmcnt(12)
    ds_read_b64_tr_b16 v[52:53], v120 offset:12288
    ds_read_b64_tr_b16 v[54:55], v120 offset:12800
    ds_read_b64_tr_b16 v[56:57], v120 offset:12320
    ds_read_b64_tr_b16 v[58:59], v120 offset:12832
    ds_read_b64_tr_b16 v[60:61], v120 offset:12352
    ds_read_b64_tr_b16 v[62:63], v120 offset:12864
    ds_read_b64_tr_b16 v[64:65], v120 offset:12384
    ds_read_b64_tr_b16 v[66:67], v120 offset:12896
    ds_read_b64_tr_b16 v[68:69], v120 offset:16384
    ds_read_b64_tr_b16 v[70:71], v120 offset:16896
    ds_read_b64_tr_b16 v[72:73], v120 offset:16416
    ds_read_b64_tr_b16 v[74:75], v120 offset:16928
    s_waitcnt lgkmcnt(3)
    ds_read_b64_tr_b16 v[76:77], v120 offset:16448
    ds_read_b64_tr_b16 v[78:79], v120 offset:16960
    ds_read_b64_tr_b16 v[80:81], v120 offset:16480
    ds_read_b64_tr_b16 v[82:83], v120 offset:16992
    ds_read_b64_tr_b16 v[84:85], v120 offset:20480
    ds_read_b64_tr_b16 v[86:87], v120 offset:20992
    ds_read_b64_tr_b16 v[88:89], v120 offset:20512
    ds_read_b64_tr_b16 v[90:91], v120 offset:21024
    ds_read_b64_tr_b16 v[92:93], v120 offset:20544
    ds_read_b64_tr_b16 v[94:95], v120 offset:21056
    ds_read_b64_tr_b16 v[96:97], v120 offset:20576
    ds_read_b64_tr_b16 v[98:99], v120 offset:21088
    s_waitcnt lgkmcnt(15)
    buffer_store_dwordx4 v[52:55], v251, s[12:15], s64 offen offset:0 sc1
    s_waitcnt lgkmcnt(15)
    buffer_store_dwordx4 v[56:59], v251, s[12:15], s65 offen offset:0 sc1
    s_waitcnt lgkmcnt(15)
    buffer_store_dwordx4 v[60:63], v251, s[12:15], s66 offen offset:0 sc1
    s_waitcnt lgkmcnt(15)
    buffer_store_dwordx4 v[64:67], v251, s[12:15], s67 offen offset:0 sc1
    s_waitcnt lgkmcnt(14)
    buffer_store_dwordx4 v[68:71], v251, s[12:15], s64 offen offset:1024 sc1
    s_waitcnt lgkmcnt(12)
    buffer_store_dwordx4 v[72:75], v251, s[12:15], s65 offen offset:1024 sc1
    s_waitcnt lgkmcnt(10)
    buffer_store_dwordx4 v[76:79], v251, s[12:15], s66 offen offset:1024 sc1
    s_waitcnt lgkmcnt(8)
    buffer_store_dwordx4 v[80:83], v251, s[12:15], s67 offen offset:1024 sc1
    s_waitcnt lgkmcnt(6)
    buffer_store_dwordx4 v[84:87], v251, s[12:15], s64 offen offset:2048 sc1
    s_waitcnt lgkmcnt(4)
    buffer_store_dwordx4 v[88:91], v251, s[12:15], s65 offen offset:2048 sc1
    s_waitcnt lgkmcnt(2)
    buffer_store_dwordx4 v[92:95], v251, s[12:15], s66 offen offset:2048 sc1
    s_waitcnt lgkmcnt(0)
    buffer_store_dwordx4 v[96:99], v251, s[12:15], s67 offen offset:2048 sc1
L_dCd:
    s_waitcnt vmcnt(0)
    s_lshl_b32 s24, s43, 7
    s_add_u32 s24, s24, 92160
    s_mov_b64 exec, 1
    buffer_atomic_add v128, v124, s[12:15], s24 offen
    s_mov_b64 exec, -1
    s_cmp_lt_u32 s36, 54
    s_cbranch_scc0 L_tCd
L_tCd:
    s_branch L_pkdone
L_pkidle:
    s_lshl_b32 s24, s43, 7
    s_add_u32 s24, s24, 88064
    s_mov_b64 exec, 1
    buffer_atomic_add v128, v124, s[12:15], s24 offen
    s_mov_b64 exec, -1
    s_lshl_b32 s24, s43, 7
    s_add_u32 s24, s24, 92160
    s_mov_b64 exec, 1
    buffer_atomic_add v128, v124, s[12:15], s24 offen
    s_mov_b64 exec, -1
    s_cmp_lg_u32 s44, 255
    s_cbranch_scc1 L_pkm2
    s_mov_b32 s24, 81920
    v_lshlrev_b32 v209, 7, v248
    s_mov_b64 exec, 0xffffffff
    s_mov_b32 s27, 0
L_poll4:
    v_mov_b32 v208, 0
    buffer_atomic_add v208, v209, s[12:15], s24 offen offset:0 sc0
    s_waitcnt vmcnt(0)
    v_cmp_ne_u32 vcc, 8, v208
    s_add_u32 s27, s27, 1
    s_nop 3
    s_cbranch_vccz L_poll4_done
    s_cmp_ge_u32 s27, 0x4000
    s_cbranch_scc1 L_poll4_done
    s_nop 0
    s_branch L_poll4
L_poll4_done:
    s_mov_b64 exec, -1
    s_mov_b32 s16, s98
    s_mov_b32 s17, s99
    s_mov_b32 s18, 0x100
    s_mov_b32 s19, 0x20000
    s_mov_b64 exec, 1
    buffer_store_dword v128, v124, s[16:19], 0 offen sc1
    s_mov_b64 exec, -1
L_pkm2:
    s_cmp_lg_u32 s44, 247
    s_cbranch_scc1 L_pkdone
    s_mov_b32 s24, 88064
    v_lshlrev_b32 v209, 7, v248
    s_mov_b64 exec, 0xffffffff
    s_mov_b32 s27, 0
L_poll5:
    v_mov_b32 v208, 0
    buffer_atomic_add v208, v209, s[12:15], s24 offen offset:0 sc0
    s_waitcnt vmcnt(0)
    v_cmp_ne_u32 vcc, 8, v208
    s_add_u32 s27, s27, 1
    s_nop 3
    s_cbranch_vccz L_poll5_done
    s_cmp_ge_u32 s27, 0x4000
    s_cbranch_scc1 L_poll5_done
    s_nop 0
    s_branch L_poll5
L_poll5_done:
    s_mov_b64 exec, -1
    s_mov_b32 s24, 96768
    s_mov_b64 exec, 1
    buffer_store_dword v128, v124, s[12:15], s24 offen sc1
    s_mov_b64 exec, -1
L_pkdone:
    s_mov_b32 s63, 0
    s_branch L_p3
L_p2:
    v_mov_b32 v244, 0
    v_mov_b32 v245, 1
    s_mul_i32 s24, s22, 43
    s_lshr_b32 s24, s24, 8
    s_lshl_b32 s28, s21, 2
    s_add_u32 s28, s28, s24
    s_mul_i32 s24, s24, 6
    s_sub_u32 s29, s22, s24
    s_mul_i32 s24, s29, 6
    s_add_u32 s30, s24, s20
    s_and_b32 s25, s20, 1
    s_add_u32 s31, s24, s25
    s_add_u32 s31, s31, 4
    s_mul_i32 s34, s20, 10944
    s_add_u32 s34, s34, 0
    s_mul_i32 s35, s28, 73728
    s_mul_i32 s24, s20, 9216
    s_add_u32 s35, s35, s24
    s_add_u32 s35, s35, 1048576
    s_add_u32 s40, s35, 36864
    s_mul_i32 s39, s20, 12288
    s_lshr_b32 s43, s28, 1
    s_lshl_b32 s43, s43, 9
    s_add_u32 s43, s43, 196608
    v_lshlrev_b32 v241, 7, v248
    s_mov_b32 s44, 0
    s_waitcnt vmcnt(0) lgkmcnt(0)
L_qd:
    s_barrier
    s_cmp_lg_u32 s20, 0
    s_cbranch_scc1 L_noarr1
    v_lshlrev_b32 v242, 11, v248
    s_mov_b32 exec_lo, s45
    s_mov_b32 exec_hi, 0
    buffer_atomic_add v245, v242, s[12:15], s42 offen
    s_mov_b64 exec, -1
L_noarr1:
    s_cmp_lt_u32 s22, 16
    s_cbranch_scc1 L_nowq
    buffer_load_dwordx4 a[80:83], v251, s[12:15], s54 offen offset:2048 sc1
    buffer_load_dwordx4 a[84:87], v251, s[12:15], s54 offen offset:3072 sc1
    s_add_u32 s54, s54, 4096
    buffer_load_dwordx4 a[88:91], v251, s[12:15], s54 offen offset:0 sc1
    buffer_load_dwordx4 a[92:95], v251, s[12:15], s54 offen offset:1024 sc1
    buffer_load_dwordx4 a[96:99], v251, s[12:15], s54 offen offset:2048 sc1
    buffer_load_dwordx4 a[100:103], v251, s[12:15], s54 offen offset:3072 sc1
    s_add_u32 s54, s54, 4096
    buffer_load_dwordx4 a[104:107], v251, s[12:15], s54 offen offset:0 sc1
    buffer_load_dwordx4 a[108:111], v251, s[12:15], s54 offen offset:1024 sc1
    buffer_load_dwordx4 a[112:115], v251, s[12:15], s54 offen offset:2048 sc1
    buffer_load_dwordx4 a[116:119], v251, s[12:15], s54 offen offset:3072 sc1
    s_add_u32 s54, s54, 4096
    buffer_load_dwordx4 a[120:123], v251, s[12:15], s54 offen offset:0 sc1
    buffer_load_dwordx4 a[124:127], v251, s[12:15], s54 offen offset:1024 sc1
    buffer_load_dwordx4 a[128:131], v251, s[12:15], s54 offen offset:2048 sc1
    buffer_load_dwordx4 a[132:135], v251, s[12:15], s54 offen offset:3072 sc1
    s_add_u32 s54, s54, 4096
    buffer_load_dwordx4 a[136:139], v251, s[12:15], s54 offen offset:0 sc1
    buffer_load_dwordx4 a[140:143], v251, s[12:15], s54 offen offset:1024 sc1
    buffer_load_dwordx4 a[144:147], v251, s[12:15], s55 offen offset:0 sc1
    buffer_load_dwordx4 a[148:151], v251, s[12:15], s55 offen offset:1024 sc1
    buffer_load_dwordx4 a[152:155], v251, s[12:15], s55 offen offset:2048 sc1
    buffer_load_dwordx4 a[156:159], v251, s[12:15], s55 offen offset:3072 sc1
    s_add_u32 s55, s55, 4096
    buffer_load_dwordx4 a[160:163], v251, s[12:15], s55 offen offset:0 sc1
    buffer_load_dwordx4 a[164:167], v251, s[12:15], s55 offen offset:1024 sc1
L_nowq:
    s_cmp_eq_u32 s44, 1
    s_cbranch_scc1 L_qok
    s_mov_b64 exec, 0xf
    s_mov_b32 s27, 0
L_poll6:
    buffer_load_dword v240, v241, s[12:15], s43 offen offset:0 sc1
    s_waitcnt vmcnt(0)
    v_cmp_ne_u32 vcc, 1, v240
    s_add_u32 s27, s27, 1
    s_nop 3
    s_cbranch_vccz L_poll6_done
    s_cmp_ge_u32 s27, 0x4000
    s_cbranch_scc1 L_poll6_done
    s_sleep 2
    s_branch L_poll6
L_poll6_done:
    s_mov_b64 exec, -1
    buffer_load_dwordx4 a[0:3], v251, s[12:15], s35 offen offset:0 sc1
    buffer_load_dwordx4 a[36:39], v251, s[12:15], s40 offen offset:0 sc1
    buffer_load_dwordx4 a[4:7], v251, s[12:15], s35 offen offset:1024 sc1
    buffer_load_dwordx4 a[40:43], v251, s[12:15], s40 offen offset:1024 sc1
    buffer_load_dwordx4 a[8:11], v251, s[12:15], s35 offen offset:2048 sc1
    buffer_load_dwordx4 a[44:47], v251, s[12:15], s40 offen offset:2048 sc1
    buffer_load_dwordx4 a[12:15], v251, s[12:15], s35 offen offset:3072 sc1
    s_add_u32 s35, s35, 4096
    buffer_load_dwordx4 a[48:51], v251, s[12:15], s40 offen offset:3072 sc1
    s_add_u32 s40, s40, 4096
    buffer_load_dwordx4 a[16:19], v251, s[12:15], s35 offen offset:0 sc1
    buffer_load_dwordx4 a[52:55], v251, s[12:15], s40 offen offset:0 sc1
    buffer_load_dwordx4 a[20:23], v251, s[12:15], s35 offen offset:1024 sc1
    buffer_load_dwordx4 a[56:59], v251, s[12:15], s40 offen offset:1024 sc1
    buffer_load_dwordx4 a[24:27], v251, s[12:15], s35 offen offset:2048 sc1
    buffer_load_dwordx4 a[60:63], v251, s[12:15], s40 offen offset:2048 sc1
    buffer_load_dwordx4 a[28:31], v251, s[12:15], s35 offen offset:3072 sc1
    s_add_u32 s35, s35, 4096
    buffer_load_dwordx4 a[64:67], v251, s[12:15], s40 offen offset:3072 sc1
    s_add_u32 s40, s40, 4096
    buffer_load_dwordx4 a[32:35], v251, s[12:15], s35 offen offset:0 sc1
    buffer_load_dwordx4 a[68:71], v251, s[12:15], s40 offen offset:0 sc1
L_qok:
    v_add_u32 v4, s39, v251
    s_mul_i32 s26, s28, 73728
    v_mov_b32 v140, 0
    v_mov_b32 v141, 0
    v_mov_b32 v142, 0
    v_mov_b32 v143, 0
    ds_write_b128 v4, v[140:143] offset:0
    ds_write_b128 v4, v[140:143] offset:1024
    ds_write_b128 v4, v[140:143] offset:2048
    ds_write_b128 v4, v[140:143] offset:3072
    ds_write_b128 v4, v[140:143] offset:4096
    ds_write_b128 v4, v[140:143] offset:5120
    ds_write_b128 v4, v[140:143] offset:6144
    ds_write_b128 v4, v[140:143] offset:7168
    ds_write_b128 v4, v[140:143] offset:8192
    ds_write_b128 v4, v[140:143] offset:9216
    ds_write_b128 v4, v[140:143] offset:10240
    ds_write_b128 v4, v[140:143] offset:11264
    s_and_b32 s24, s2, 15
    s_lshl_b32 s24, s24, 11
    s_add_u32 s24, s24, 204800
    s_cmp_lg_u32 s20, 0
    s_cbranch_scc1 L_np1a
    s_mov_b64 exec, 0xff
    s_mov_b32 s27, 0
L_poll7:
    buffer_load_dword v240, v241, s[12:15], s24 offen offset:0 sc1
    s_waitcnt vmcnt(0)
    v_cmp_ne_u32 vcc, 16, v240
    s_add_u32 s27, s27, 1
    s_nop 3
    s_cbranch_vccz L_poll7_done
    s_cmp_ge_u32 s27, 0x4000
    s_cbranch_scc1 L_poll7_done
    s_sleep 3
    s_branch L_poll7
L_poll7_done:
    s_mov_b64 exec, -1
L_np1a:
    s_barrier
    buffer_load_dwordx4 v[8:11], v251, s[12:15], s34 offen offset:0 sc1
    buffer_load_dwordx4 v[12:15], v251, s[12:15], s34 offen offset:1024 sc1
    buffer_load_dwordx4 v[16:19], v251, s[12:15], s34 offen offset:2048 sc1
    buffer_load_dwordx4 v[20:23], v251, s[12:15], s34 offen offset:3072 sc1
    s_add_u32 s34, s34, 4096
    buffer_load_dwordx4 v[24:27], v251, s[12:15], s34 offen offset:0 sc1
    buffer_load_dwordx4 v[28:31], v251, s[12:15], s34 offen offset:1024 sc1
    buffer_load_dwordx4 v[32:35], v251, s[12:15], s34 offen offset:2048 sc1
    buffer_load_dwordx4 v[36:39], v251, s[12:15], s34 offen offset:3072 sc1
    s_add_u32 s34, s34, 4096
    buffer_load_dwordx4 v[40:43], v251, s[12:15], s34 offen offset:0 sc1
    buffer_load_dwordx4 v[44:47], v251, s[12:15], s34 offen offset:1024 sc1
    buffer_load_dwordx4 v[48:51], v251, s[12:15], s34 offen offset:2048 sc1
    s_waitcnt vmcnt(10)
    s_waitcnt lgkmcnt(0)
    v_cvt_pk_bf16_f32 v8, v8, v9
    v_cvt_pk_bf16_f32 v9, v10, v11
    ds_write_b32 v216, v8
    ds_write_b32 v217, v9
    s_waitcnt vmcnt(9)
    v_cvt_pk_bf16_f32 v12, v12, v13
    v_cvt_pk_bf16_f32 v13, v14, v15
    ds_write_b32 v218, v12
    ds_write_b32 v219, v13
    s_waitcnt vmcnt(8)
    v_cvt_pk_bf16_f32 v16, v16, v17
    v_cvt_pk_bf16_f32 v17, v18, v19
    ds_write_b32 v220, v16
    ds_write_b32 v221, v17
    s_waitcnt vmcnt(7)
    v_cvt_pk_bf16_f32 v20, v20, v21
    v_cvt_pk_bf16_f32 v21, v22, v23
    ds_write_b32 v222, v20
    ds_write_b32 v223, v21
    s_waitcnt vmcnt(6)
    v_cvt_pk_bf16_f32 v24, v24, v25
    v_cvt_pk_bf16_f32 v25, v26, v27
    ds_write_b32 v224, v24
    ds_write_b32 v225, v25
    s_waitcnt vmcnt(5)
    v_cvt_pk_bf16_f32 v28, v28, v29
    v_cvt_pk_bf16_f32 v29, v30, v31
    ds_write_b32 v226, v28
    ds_write_b32 v227, v29
    s_waitcnt vmcnt(4)
    v_cvt_pk_bf16_f32 v32, v32, v33
    v_cvt_pk_bf16_f32 v33, v34, v35
    ds_write_b32 v228, v32
    ds_write_b32 v229, v33
    s_waitcnt vmcnt(3)
    v_cvt_pk_bf16_f32 v36, v36, v37
    v_cvt_pk_bf16_f32 v37, v38, v39
    ds_write_b32 v230, v36
    ds_write_b32 v231, v37
    s_waitcnt vmcnt(2)
    v_cvt_pk_bf16_f32 v40, v40, v41
    v_cvt_pk_bf16_f32 v41, v42, v43
    ds_write_b32 v232, v40
    ds_write_b32 v233, v41
    s_waitcnt vmcnt(1)
    v_cvt_pk_bf16_f32 v44, v44, v45
    v_cvt_pk_bf16_f32 v45, v46, v47
    ds_write_b32 v234, v44
    ds_write_b32 v235, v45
    s_waitcnt vmcnt(0)
    v_cvt_pk_bf16_f32 v48, v48, v49
    v_cvt_pk_bf16_f32 v49, v50, v51
    s_mov_b32 exec_hi, 0xfff
    ds_write_b32 v236, v48
    ds_write_b32 v237, v49
    s_mov_b32 exec_hi, -1
    s_waitcnt lgkmcnt(0)
    ds_read_b128 v[168:171], v238 offset:0
    ds_read_b128 v[172:175], v238 offset:32
    ds_read_b128 v[176:179], v238 offset:1520
    ds_read_b128 v[180:183], v238 offset:1552
    ds_read_b128 v[184:187], v238 offset:3040
    ds_read_b128 v[188:191], v238 offset:3072
    ds_read_b128 v[192:195], v238 offset:4560
    ds_read_b128 v[196:199], v238 offset:4592
    ds_read_b128 v[200:203], v238 offset:6080
    ds_read_b128 v[204:207], v238 offset:6112
    ds_read_b128 v[208:211], v238 offset:7600
    ds_read_b128 v[212:215], v238 offset:7632
    ds_read_b128 v[216:219], v238 offset:9120
    ds_read_b128 v[220:223], v238 offset:9152
    s_waitcnt lgkmcnt(8)
    ds_read_b128 v[224:227], v238 offset:10640
    ds_read_b128 v[228:231], v238 offset:10672
    s_waitcnt lgkmcnt(0)
    v_mfma_f32_32x32x16_bf16 v[76:91], v[168:171], a[0:3], 0
    v_mfma_f32_32x32x16_bf16 v[92:107], v[168:171], a[36:39], 0
    v_mfma_f32_32x32x16_bf16 v[76:91], v[172:175], a[4:7], v[76:91]
    v_mfma_f32_32x32x16_bf16 v[92:107], v[172:175], a[40:43], v[92:107]
    buffer_load_dwordx4 a[168:171], v251, s[12:15], s55 offen offset:2048 sc1
    buffer_load_dwordx4 a[172:175], v251, s[12:15], s55 offen offset:3072 sc1
    s_add_u32 s55, s55, 4096
    buffer_load_dwordx4 a[176:179], v251, s[12:15], s55 offen offset:0 sc1
    s_nop 9
    v_mfma_f32_32x32x16_bf16 v[108:123], v[176:179], a[4:7], 0
    buffer_load_dwordx4 a[180:183], v251, s[12:15], s55 offen offset:1024 sc1
    buffer_load_dwordx4 a[184:187], v251, s[12:15], s55 offen offset:2048 sc1
    buffer_load_dwordx4 a[188:191], v251, s[12:15], s55 offen offset:3072 sc1
    s_add_u32 s55, s55, 4096
    v_mfma_f32_32x32x16_bf16 v[124:139], v[176:179], a[40:43], 0
    v_add_f32 v242, s62, v85
    v_add_f32 v243, s62, v101
    v_rcp_f32 v242, v242
    v_rcp_f32 v243, v243
    v_mul_f32 v76, v76, v242
    v_mul_f32 v77, v77, v242
    v_mul_f32 v78, v78, v242
    v_mul_f32 v79, v79, v242
    v_mfma_f32_32x32x16_bf16 v[108:123], v[180:183], a[8:11], v[108:123]
    v_mul_f32 v80, v80, v242
    v_mul_f32 v81, v81, v242
    v_mul_f32 v82, v82, v242
    v_mul_f32 v83, v83, v242
    v_mul_f32 v240, v84, v242
    v_cvt_pk_bf16_f32 v140, v76, v77
    v_cvt_pk_bf16_f32 v141, v78, v79
    v_cvt_pk_bf16_f32 v142, v80, v81
    v_cvt_pk_bf16_f32 v143, v82, v83
    ds_write_b128 v239, v[140:143] offset:0
    v_mfma_f32_32x32x16_bf16 v[124:139], v[180:183], a[44:47], v[124:139]
    v_mul_f32 v92, v92, v243
    v_mul_f32 v93, v93, v243
    v_mul_f32 v94, v94, v243
    v_mul_f32 v95, v95, v243
    v_mul_f32 v96, v96, v243
    v_mul_f32 v97, v97, v243
    v_mul_f32 v98, v98, v243
    v_mul_f32 v99, v99, v243
    v_mul_f32 v241, v100, v243
    v_cvt_pk_bf16_f32 v148, v92, v93
    v_cvt_pk_bf16_f32 v149, v94, v95
    v_cvt_pk_bf16_f32 v150, v96, v97
    v_cvt_pk_bf16_f32 v151, v98, v99
    ds_write_b128 v239, v[148:151] offset:36864
    v_mfma_f32_32x32x16_bf16 v[76:91], v[184:187], a[8:11], 0
    buffer_load_dwordx4 a[192:195], v251, s[12:15], s55 offen offset:0 sc1
    buffer_load_dwordx4 a[196:199], v251, s[12:15], s55 offen offset:1024 sc1
    buffer_load_dwordx4 a[200:203], v251, s[12:15], s55 offen offset:2048 sc1
    v_mfma_f32_32x32x16_bf16 v[92:107], v[184:187], a[44:47], 0
    v_add_f32 v242, s62, v117
    v_add_f32 v243, s62, v133
    v_rcp_f32 v242, v242
    v_rcp_f32 v243, v243
    v_mul_f32 v108, v108, v242
    v_mul_f32 v109, v109, v242
    v_mul_f32 v110, v110, v242
    v_mul_f32 v111, v111, v242
    v_mul_f32 v112, v112, v242
    v_mul_f32 v113, v113, v242
    v_mfma_f32_32x32x16_bf16 v[76:91], v[188:191], a[12:15], v[76:91]
    v_mul_f32 v114, v114, v242
    v_mul_f32 v115, v115, v242
    v_mul_f32 v116, v116, v242
    v_cvt_pk_bf16_f32 v144, v240, v108
    v_cvt_pk_bf16_f32 v145, v109, v110
    v_cvt_pk_bf16_f32 v146, v111, v112
    v_cvt_pk_bf16_f32 v147, v113, v114
    ds_write_b128 v239, v[144:147] offset:512
    v_cvt_pk_bf16_f32 v140, v115, v116
    v_mul_f32 v124, v124, v243
    v_mfma_f32_32x32x16_bf16 v[92:107], v[188:191], a[48:51], v[92:107]
    v_mul_f32 v125, v125, v243
    v_mul_f32 v126, v126, v243
    v_mul_f32 v127, v127, v243
    v_mul_f32 v128, v128, v243
    v_mul_f32 v129, v129, v243
    v_mul_f32 v130, v130, v243
    v_mul_f32 v131, v131, v243
    v_mul_f32 v132, v132, v243
    v_cvt_pk_bf16_f32 v152, v241, v124
    v_cvt_pk_bf16_f32 v153, v125, v126
    v_cvt_pk_bf16_f32 v154, v127, v128
    v_cvt_pk_bf16_f32 v155, v129, v130
    ds_write_b128 v239, v[152:155] offset:37376
    v_cvt_pk_bf16_f32 v148, v131, v132
    v_mfma_f32_32x32x16_bf16 v[108:123], v[192:195], a[12:15], 0
    buffer_load_dwordx4 a[204:207], v251, s[12:15], s55 offen offset:3072 sc1
    s_add_u32 s55, s55, 4096
    buffer_load_dwordx4 a[208:211], v251, s[12:15], s55 offen offset:0 sc1
    buffer_load_dwordx4 a[212:215], v251, s[12:15], s55 offen offset:1024 sc1
    v_mfma_f32_32x32x16_bf16 v[124:139], v[192:195], a[48:51], 0
    v_add_f32 v242, s62, v85
    v_add_f32 v243, s62, v101
    v_rcp_f32 v242, v242
    v_rcp_f32 v243, v243
    v_mul_f32 v76, v76, v242
    v_mul_f32 v77, v77, v242
    v_mul_f32 v78, v78, v242
    v_mul_f32 v79, v79, v242
    v_mfma_f32_32x32x16_bf16 v[108:123], v[196:199], a[16:19], v[108:123]
    v_mul_f32 v80, v80, v242
    v_mul_f32 v81, v81, v242
    v_mul_f32 v82, v82, v242
    v_mul_f32 v83, v83, v242
    v_mul_f32 v240, v84, v242
    v_cvt_pk_bf16_f32 v141, v76, v77
    v_cvt_pk_bf16_f32 v142, v78, v79
    v_cvt_pk_bf16_f32 v143, v80, v81
    ds_write_b128 v239, v[140:143] offset:1024
    v_cvt_pk_bf16_f32 v144, v82, v83
    v_mfma_f32_32x32x16_bf16 v[124:139], v[196:199], a[52:55], v[124:139]
    v_mul_f32 v92, v92, v243
    v_mul_f32 v93, v93, v243
    v_mul_f32 v94, v94, v243
    v_mul_f32 v95, v95, v243
    v_mul_f32 v96, v96, v243
    v_mul_f32 v97, v97, v243
    v_mul_f32 v98, v98, v243
    v_mul_f32 v99, v99, v243
    v_mul_f32 v241, v100, v243
    v_cvt_pk_bf16_f32 v149, v92, v93
    v_cvt_pk_bf16_f32 v150, v94, v95
    v_cvt_pk_bf16_f32 v151, v96, v97
    ds_write_b128 v239, v[148:151] offset:37888
    v_cvt_pk_bf16_f32 v152, v98, v99
    v_mfma_f32_32x32x16_bf16 v[76:91], v[200:203], a[16:19], 0
    s_xor_b32 s24, s20, 0
    s_lshr_b32 s24, s24, 1
    s_mul_i32 s24, s24, 36864
    s_add_u32 s24, s24, s26
    s_lshl_b32 s25, s30, 5
    s_add_u32 s24, s24, s25
    buffer_load_dwordx4 v[156:159], v246, s[4:7], s24 offen
    s_mov_b32 s24, 96768
    buffer_load_dword v247, v244, s[12:15], s24 offen sc1
    v_mfma_f32_32x32x16_bf16 v[92:107], v[200:203], a[52:55], 0
    v_add_f32 v242, s62, v117
    v_add_f32 v243, s62, v133
    v_rcp_f32 v242, v242
    v_rcp_f32 v243, v243
    v_mul_f32 v108, v108, v242
    v_mul_f32 v109, v109, v242
    v_mul_f32 v110, v110, v242
    v_mul_f32 v111, v111, v242
    v_mul_f32 v112, v112, v242
    v_mul_f32 v113, v113, v242
    v_mfma_f32_32x32x16_bf16 v[76:91], v[204:207], a[20:23], v[76:91]
    v_mul_f32 v114, v114, v242
    v_mul_f32 v115, v115, v242
    v_mul_f32 v116, v116, v242
    v_cvt_pk_bf16_f32 v145, v240, v108
    v_cvt_pk_bf16_f32 v146, v109, v110
    v_cvt_pk_bf16_f32 v147, v111, v112
    ds_write_b128 v239, v[144:147] offset:1536
    v_cvt_pk_bf16_f32 v140, v113, v114
    v_cvt_pk_bf16_f32 v141, v115, v116
    v_mul_f32 v124, v124, v243
    v_mfma_f32_32x32x16_bf16 v[92:107], v[204:207], a[56:59], v[92:107]
    v_mul_f32 v125, v125, v243
    v_mul_f32 v126, v126, v243
    v_mul_f32 v127, v127, v243
    v_mul_f32 v128, v128, v243
    v_mul_f32 v129, v129, v243
    v_mul_f32 v130, v130, v243
    v_mul_f32 v131, v131, v243
    v_mul_f32 v132, v132, v243
    v_cvt_pk_bf16_f32 v153, v241, v124
    v_cvt_pk_bf16_f32 v154, v125, v126
    v_cvt_pk_bf16_f32 v155, v127, v128
    ds_write_b128 v239, v[152:155] offset:38400
    v_cvt_pk_bf16_f32 v148, v129, v130
    v_cvt_pk_bf16_f32 v149, v131, v132
    v_mfma_f32_32x32x16_bf16 v[108:123], v[208:211], a[20:23], 0
    s_xor_b32 s24, s20, 2
    s_lshr_b32 s24, s24, 1
    s_mul_i32 s24, s24, 36864
    s_add_u32 s24, s24, s26
    s_lshl_b32 s25, s30, 5
    s_add_u32 s24, s24, s25
    buffer_load_dwordx4 v[160:163], v246, s[4:7], s24 offen
    v_mfma_f32_32x32x16_bf16 v[124:139], v[208:211], a[56:59], 0
    v_add_f32 v242, s62, v85
    v_add_f32 v243, s62, v101
    v_rcp_f32 v242, v242
    v_rcp_f32 v243, v243
    v_mul_f32 v76, v76, v242
    v_mul_f32 v77, v77, v242
    v_mul_f32 v78, v78, v242
    v_mul_f32 v79, v79, v242
    v_mfma_f32_32x32x16_bf16 v[108:123], v[212:215], a[24:27], v[108:123]
    v_mul_f32 v80, v80, v242
    v_mul_f32 v81, v81, v242
    v_mul_f32 v82, v82, v242
    v_mul_f32 v83, v83, v242
    v_mul_f32 v240, v84, v242
    v_cvt_pk_bf16_f32 v142, v76, v77
    v_cvt_pk_bf16_f32 v143, v78, v79
    ds_write_b128 v239, v[140:143] offset:2048
    v_cvt_pk_bf16_f32 v144, v80, v81
    v_cvt_pk_bf16_f32 v145, v82, v83
    v_mfma_f32_32x32x16_bf16 v[124:139], v[212:215], a[60:63], v[124:139]
    v_mul_f32 v92, v92, v243
    v_mul_f32 v93, v93, v243
    v_mul_f32 v94, v94, v243
    v_mul_f32 v95, v95, v243
    v_mul_f32 v96, v96, v243
    v_mul_f32 v97, v97, v243
    v_mul_f32 v98, v98, v243
    v_mul_f32 v99, v99, v243
    v_mul_f32 v241, v100, v243
    v_cvt_pk_bf16_f32 v150, v92, v93
    v_cvt_pk_bf16_f32 v151, v94, v95
    ds_write_b128 v239, v[148:151] offset:38912
    v_cvt_pk_bf16_f32 v152, v96, v97
    v_cvt_pk_bf16_f32 v153, v98, v99
    v_mfma_f32_32x32x16_bf16 v[76:91], v[216:219], a[24:27], 0
    s_xor_b32 s24, s20, 0
    s_lshr_b32 s24, s24, 1
    s_mul_i32 s24, s24, 36864
    s_add_u32 s24, s24, s26
    s_lshl_b32 s25, s31, 5
    s_add_u32 s24, s24, s25
    buffer_load_dwordx4 v[164:167], v246, s[4:7], s24 offen
    v_mfma_f32_32x32x16_bf16 v[92:107], v[216:219], a[60:63], 0
    v_add_f32 v242, s62, v117
    v_add_f32 v243, s62, v133
    v_rcp_f32 v242, v242
    v_rcp_f32 v243, v243
    v_mul_f32 v108, v108, v242
    v_mul_f32 v109, v109, v242
    v_mul_f32 v110, v110, v242
    v_mul_f32 v111, v111, v242
    v_mul_f32 v112, v112, v242
    v_mul_f32 v113, v113, v242
    v_mfma_f32_32x32x16_bf16 v[76:91], v[220:223], a[28:31], v[76:91]
    v_mul_f32 v114, v114, v242
    v_mul_f32 v115, v115, v242
    v_mul_f32 v116, v116, v242
    v_cvt_pk_bf16_f32 v146, v240, v108
    v_cvt_pk_bf16_f32 v147, v109, v110
    ds_write_b128 v239, v[144:147] offset:2560
    v_cvt_pk_bf16_f32 v140, v111, v112
    v_cvt_pk_bf16_f32 v141, v113, v114
    v_cvt_pk_bf16_f32 v142, v115, v116
    v_mul_f32 v124, v124, v243
    v_mfma_f32_32x32x16_bf16 v[92:107], v[220:223], a[64:67], v[92:107]
    v_mul_f32 v125, v125, v243
    v_mul_f32 v126, v126, v243
    v_mul_f32 v127, v127, v243
    v_mul_f32 v128, v128, v243
    v_mul_f32 v129, v129, v243
    v_mul_f32 v130, v130, v243
    v_mul_f32 v131, v131, v243
    v_mul_f32 v132, v132, v243
    v_cvt_pk_bf16_f32 v154, v241, v124
    v_cvt_pk_bf16_f32 v155, v125, v126
    ds_write_b128 v239, v[152:155] offset:39424
    v_cvt_pk_bf16_f32 v148, v127, v128
    v_cvt_pk_bf16_f32 v149, v129, v130
    v_cvt_pk_bf16_f32 v150, v131, v132
    v_mfma_f32_32x32x16_bf16 v[108:123], v[224:227], a[28:31], 0
    s_waitcnt vmcnt(2)
    v_readfirstlane_b32 s63, v247
    v_mfma_f32_32x32x16_bf16 v[124:139], v[224:227], a[64:67], 0
    v_add_f32 v242, s62, v85
    v_add_f32 v243, s62, v101
    v_rcp_f32 v242, v242
    v_rcp_f32 v243, v243
    v_mul_f32 v76, v76, v242
    v_mul_f32 v77, v77, v242
    v_mul_f32 v78, v78, v242
    v_mul_f32 v79, v79, v242
    v_mfma_f32_32x32x16_bf16 v[108:123], v[228:231], a[32:35], v[108:123]
    v_mul_f32 v80, v80, v242
    v_mul_f32 v81, v81, v242
    v_mul_f32 v82, v82, v242
    v_mul_f32 v83, v83, v242
    v_mul_f32 v240, v84, v242
    v_cvt_pk_bf16_f32 v143, v76, v77
    ds_write_b128 v239, v[140:143] offset:3072
    v_cvt_pk_bf16_f32 v144, v78, v79
    v_cvt_pk_bf16_f32 v145, v80, v81
    v_cvt_pk_bf16_f32 v146, v82, v83
    v_mfma_f32_32x32x16_bf16 v[124:139], v[228:231], a[68:71], v[124:139]
    v_mul_f32 v92, v92, v243
    v_mul_f32 v93, v93, v243
    v_mul_f32 v94, v94, v243
    v_mul_f32 v95, v95, v243
    v_mul_f32 v96, v96, v243
    v_mul_f32 v97, v97, v243
    v_mul_f32 v98, v98, v243
    v_mul_f32 v99, v99, v243
    v_mul_f32 v241, v100, v243
    v_cvt_pk_bf16_f32 v151, v92, v93
    ds_write_b128 v239, v[148:151] offset:39936
    v_cvt_pk_bf16_f32 v152, v94, v95
    v_cvt_pk_bf16_f32 v153, v96, v97
    v_cvt_pk_bf16_f32 v154, v98, v99
    v_add_f32 v242, s62, v117
    v_add_f32 v243, s62, v133
    v_rcp_f32 v242, v242
    v_rcp_f32 v243, v243
    v_mul_f32 v108, v108, v242
    v_mul_f32 v109, v109, v242
    v_mul_f32 v110, v110, v242
    v_mul_f32 v111, v111, v242
    v_mul_f32 v112, v112, v242
    v_mul_f32 v113, v113, v242
    v_mul_f32 v114, v114, v242
    v_mul_f32 v115, v115, v242
    v_mul_f32 v116, v116, v242
    v_cvt_pk_bf16_f32 v147, v240, v108
    ds_write_b128 v239, v[144:147] offset:3584
    v_cvt_pk_bf16_f32 v140, v109, v110
    v_cvt_pk_bf16_f32 v141, v111, v112
    v_cvt_pk_bf16_f32 v142, v113, v114
    v_cvt_pk_bf16_f32 v143, v115, v116
    ds_write_b128 v239, v[140:143] offset:4096
    v_mul_f32 v124, v124, v243
    v_mul_f32 v125, v125, v243
    v_mul_f32 v126, v126, v243
    v_mul_f32 v127, v127, v243
    v_mul_f32 v128, v128, v243
    v_mul_f32 v129, v129, v243
    v_mul_f32 v130, v130, v243
    v_mul_f32 v131, v131, v243
    v_mul_f32 v132, v132, v243
    v_cvt_pk_bf16_f32 v155, v241, v124
    ds_write_b128 v239, v[152:155] offset:40448
    v_cvt_pk_bf16_f32 v148, v125, v126
    v_cvt_pk_bf16_f32 v149, v127, v128
    v_cvt_pk_bf16_f32 v150, v129, v130
    v_cvt_pk_bf16_f32 v151, v131, v132
    ds_write_b128 v239, v[148:151] offset:40960
    s_xor_b32 s24, s20, 0
    s_mul_i32 s24, s24, 18432
    s_add_u32 s24, s24, 49152
    v_add_u32 v240, s24, v251
    s_xor_b32 s24, s20, 1
    s_mul_i32 s24, s24, 18432
    s_add_u32 s24, s24, 49152
    v_add_u32 v241, s24, v251
    s_xor_b32 s24, s20, 2
    s_mul_i32 s24, s24, 18432
    s_add_u32 s24, s24, 49152
    v_add_u32 v242, s24, v251
    s_xor_b32 s24, s20, 3
    s_mul_i32 s24, s24, 18432
    s_add_u32 s24, s24, 49152
    v_add_u32 v243, s24, v251
    s_waitcnt lgkmcnt(0)
    s_barrier
    ds_read_b128 v[168:171], v240 offset:0
    ds_read_b128 v[172:175], v241 offset:0
    ds_read_b128 v[176:179], v242 offset:0
    ds_read_b128 v[180:183], v243 offset:0
    ds_read_b128 v[184:187], v240 offset:1024
    ds_read_b128 v[188:191], v241 offset:1024
    ds_read_b128 v[192:195], v242 offset:1024
    ds_read_b128 v[196:199], v243 offset:1024
    s_lshr_b32 s24, s21, 2
    s_lshl_b32 s24, s24, 4
    s_lshr_b32 s25, s22, 1
    s_add_u32 s56, s24, s25
    s_and_b32 s24, s21, 3
    s_lshl_b32 s24, s24, 1
    s_and_b32 s25, s22, 1
    s_add_u32 s57, s24, s25
    s_lshl_b32 s25, s57, 2
    s_add_u32 s25, s25, s20
    s_mul_i32 s25, s25, 331776
    s_add_u32 s25, s25, 8388608
    s_add_u32 s16, s100, s25
    s_addc_u32 s17, s101, 0
    s_mov_b32 s18, 36864
    s_mov_b32 s19, 0x20000
    s_mov_b32 s40, 0
    s_mov_b32 s41, 4096
    s_mov_b32 s42, 8192
    s_mov_b32 s43, 12288
    s_mov_b32 s44, 16384
    s_mov_b32 s45, 20480
    s_mov_b32 s46, 24576
    s_mov_b32 s47, 28672
    s_mov_b32 s48, 32768
    s_cmp_eq_u32 s63, 1
    s_cselect_b32 s18, s18, 0
    s_waitcnt lgkmcnt(4)
    v_mfma_f32_16x16x32_bf16 v[216:219], a[72:75], v[168:171], 0
    ds_read_b128 v[200:203], v240 offset:2048
    v_mfma_f32_16x16x32_bf16 v[232:235], a[144:147], v[168:171], 0
    v_mfma_f32_16x16x32_bf16 v[220:223], a[72:75], v[172:175], 0
    ds_read_b128 v[204:207], v241 offset:2048
    v_mfma_f32_16x16x32_bf16 v[236:239], a[144:147], v[172:175], 0
    buffer_load_dwordx4 v[0:3], v251, s[16:19], s40 offen offset:0
    v_mfma_f32_16x16x32_bf16 v[224:227], a[72:75], v[176:179], 0
    ds_read_b128 v[208:211], v242 offset:2048
    v_mfma_f32_16x16x32_bf16 v[228:231], a[72:75], v[180:183], 0
    ds_read_b128 v[212:215], v243 offset:2048
    buffer_load_dwordx4 v[4:7], v251, s[16:19], s40 offen offset:1024
    s_waitcnt lgkmcnt(4)
    v_mfma_f32_16x16x32_bf16 v[216:219], a[76:79], v[184:187], v[216:219]
    ds_read_b128 v[168:171], v240 offset:3072
    v_mfma_f32_16x16x32_bf16 v[232:235], a[148:151], v[184:187], v[232:235]
    v_mfma_f32_16x16x32_bf16 v[220:223], a[76:79], v[188:191], v[220:223]
    ds_read_b128 v[172:175], v241 offset:3072
    v_mfma_f32_16x16x32_bf16 v[236:239], a[148:151], v[188:191], v[236:239]
    v_mfma_f32_16x16x32_bf16 v[224:227], a[76:79], v[192:195], v[224:227]
    ds_read_b128 v[176:179], v242 offset:3072
    v_mfma_f32_16x16x32_bf16 v[228:231], a[76:79], v[196:199], v[228:231]
    ds_read_b128 v[180:183], v243 offset:3072
    buffer_load_dwordx4 v[8:11], v251, s[16:19], s40 offen offset:2048
    s_waitcnt lgkmcnt(4)
    v_mfma_f32_16x16x32_bf16 v[216:219], a[80:83], v[200:203], v[216:219]
    ds_read_b128 v[184:187], v240 offset:4096
    v_mfma_f32_16x16x32_bf16 v[232:235], a[152:155], v[200:203], v[232:235]
    v_mfma_f32_16x16x32_bf16 v[220:223], a[80:83], v[204:207], v[220:223]
    ds_read_b128 v[188:191], v241 offset:4096
    v_mfma_f32_16x16x32_bf16 v[236:239], a[152:155], v[204:207], v[236:239]
    v_mfma_f32_16x16x32_bf16 v[224:227], a[80:83], v[208:211], v[224:227]
    ds_read_b128 v[192:195], v242 offset:4096
    v_mfma_f32_16x16x32_bf16 v[228:231], a[80:83], v[212:215], v[228:231]
    ds_read_b128 v[196:199], v243 offset:4096
    buffer_load_dwordx4 v[12:15], v251, s[16:19], s40 offen offset:3072
    s_waitcnt lgkmcnt(4)
    v_mfma_f32_16x16x32_bf16 v[216:219], a[84:87], v[168:171], v[216:219]
    ds_read_b128 v[200:203], v240 offset:5120
    v_mfma_f32_16x16x32_bf16 v[232:235], a[156:159], v[168:171], v[232:235]
    v_mfma_f32_16x16x32_bf16 v[220:223], a[84:87], v[172:175], v[220:223]
    ds_read_b128 v[204:207], v241 offset:5120
    v_mfma_f32_16x16x32_bf16 v[236:239], a[156:159], v[172:175], v[236:239]
    buffer_load_dwordx4 v[16:19], v251, s[16:19], s41 offen offset:0
    v_mfma_f32_16x16x32_bf16 v[224:227], a[84:87], v[176:179], v[224:227]
    ds_read_b128 v[208:211], v242 offset:5120
    v_mfma_f32_16x16x32_bf16 v[228:231], a[84:87], v[180:183], v[228:231]
    ds_read_b128 v[212:215], v243 offset:5120
    buffer_load_dwordx4 v[20:23], v251, s[16:19], s41 offen offset:1024
    s_waitcnt lgkmcnt(4)
    v_mfma_f32_16x16x32_bf16 v[216:219], a[88:91], v[184:187], v[216:219]
    ds_read_b128 v[168:171], v240 offset:6144
    v_mfma_f32_16x16x32_bf16 v[232:235], a[160:163], v[184:187], v[232:235]
    v_mfma_f32_16x16x32_bf16 v[220:223], a[88:91], v[188:191], v[220:223]
    ds_read_b128 v[172:175], v241 offset:6144
    v_mfma_f32_16x16x32_bf16 v[236:239], a[160:163], v[188:191], v[236:239]
    v_mfma_f32_16x16x32_bf16 v[224:227], a[88:91], v[192:195], v[224:227]
    ds_read_b128 v[176:179], v242 offset:6144
    v_mfma_f32_16x16x32_bf16 v[228:231], a[88:91], v[196:199], v[228:231]
    ds_read_b128 v[180:183], v243 offset:6144
    buffer_load_dwordx4 v[24:27], v251, s[16:19], s41 offen offset:2048
    s_waitcnt lgkmcnt(4)
    v_mfma_f32_16x16x32_bf16 v[216:219], a[92:95], v[200:203], v[216:219]
    ds_read_b128 v[184:187], v240 offset:7168
    v_mfma_f32_16x16x32_bf16 v[232:235], a[164:167], v[200:203], v[232:235]
    v_mfma_f32_16x16x32_bf16 v[220:223], a[92:95], v[204:207], v[220:223]
    ds_read_b128 v[188:191], v241 offset:7168
    v_mfma_f32_16x16x32_bf16 v[236:239], a[164:167], v[204:207], v[236:239]
    v_mfma_f32_16x16x32_bf16 v[224:227], a[92:95], v[208:211], v[224:227]
    ds_read_b128 v[192:195], v242 offset:7168
    v_mfma_f32_16x16x32_bf16 v[228:231], a[92:95], v[212:215], v[228:231]
    ds_read_b128 v[196:199], v243 offset:7168
    buffer_load_dwordx4 v[28:31], v251, s[16:19], s41 offen offset:3072
    s_waitcnt lgkmcnt(4)
    v_mfma_f32_16x16x32_bf16 v[216:219], a[96:99], v[168:171], v[216:219]
    ds_read_b128 v[200:203], v240 offset:8192
    v_mfma_f32_16x16x32_bf16 v[232:235], a[168:171], v[168:171], v[232:235]
    v_mfma_f32_16x16x32_bf16 v[220:223], a[96:99], v[172:175], v[220:223]
    ds_read_b128 v[204:207], v241 offset:8192
    v_mfma_f32_16x16x32_bf16 v[236:239], a[168:171], v[172:175], v[236:239]
    buffer_load_dwordx4 v[32:35], v251, s[16:19], s42 offen offset:0
    v_mfma_f32_16x16x32_bf16 v[224:227], a[96:99], v[176:179], v[224:227]
    ds_read_b128 v[208:211], v242 offset:8192
    v_mfma_f32_16x16x32_bf16 v[228:231], a[96:99], v[180:183], v[228:231]
    ds_read_b128 v[212:215], v243 offset:8192
    buffer_load_dwordx4 v[36:39], v251, s[16:19], s42 offen offset:1024
    s_waitcnt lgkmcnt(4)
    v_mfma_f32_16x16x32_bf16 v[216:219], a[100:103], v[184:187], v[216:219]
    ds_read_b128 v[168:171], v240 offset:9216
    v_mfma_f32_16x16x32_bf16 v[232:235], a[172:175], v[184:187], v[232:235]
    v_mfma_f32_16x16x32_bf16 v[220:223], a[100:103], v[188:191], v[220:223]
    ds_read_b128 v[172:175], v241 offset:9216
    v_mfma_f32_16x16x32_bf16 v[236:239], a[172:175], v[188:191], v[236:239]
    v_mfma_f32_16x16x32_bf16 v[224:227], a[100:103], v[192:195], v[224:227]
    ds_read_b128 v[176:179], v242 offset:9216
    v_mfma_f32_16x16x32_bf16 v[228:231], a[100:103], v[196:199], v[228:231]
    ds_read_b128 v[180:183], v243 offset:9216
    buffer_load_dwordx4 v[40:43], v251, s[16:19], s42 offen offset:2048
    s_waitcnt lgkmcnt(4)
    v_mfma_f32_16x16x32_bf16 v[216:219], a[104:107], v[200:203], v[216:219]
    ds_read_b128 v[184:187], v240 offset:10240
    v_mfma_f32_16x16x32_bf16 v[232:235], a[176:179], v[200:203], v[232:235]
    v_mfma_f32_16x16x32_bf16 v[220:223], a[104:107], v[204:207], v[220:223]
    ds_read_b128 v[188:191], v241 offset:10240
    v_mfma_f32_16x16x32_bf16 v[236:239], a[176:179], v[204:207], v[236:239]
    v_mfma_f32_16x16x32_bf16 v[224:227], a[104:107], v[208:211], v[224:227]
    ds_read_b128 v[192:195], v242 offset:10240
    v_mfma_f32_16x16x32_bf16 v[228:231], a[104:107], v[212:215], v[228:231]
    ds_read_b128 v[196:199], v243 offset:10240
    buffer_load_dwordx4 v[44:47], v251, s[16:19], s42 offen offset:3072
    s_waitcnt lgkmcnt(4)
    v_mfma_f32_16x16x32_bf16 v[216:219], a[108:111], v[168:171], v[216:219]
    ds_read_b128 v[200:203], v240 offset:11264
    v_mfma_f32_16x16x32_bf16 v[232:235], a[180:183], v[168:171], v[232:235]
    v_mfma_f32_16x16x32_bf16 v[220:223], a[108:111], v[172:175], v[220:223]
    ds_read_b128 v[204:207], v241 offset:11264
    v_mfma_f32_16x16x32_bf16 v[236:239], a[180:183], v[172:175], v[236:239]
    buffer_load_dwordx4 v[48:51], v251, s[16:19], s43 offen offset:0
    v_mfma_f32_16x16x32_bf16 v[224:227], a[108:111], v[176:179], v[224:227]
    ds_read_b128 v[208:211], v242 offset:11264
    v_mfma_f32_16x16x32_bf16 v[228:231], a[108:111], v[180:183], v[228:231]
    ds_read_b128 v[212:215], v243 offset:11264
    buffer_load_dwordx4 v[52:55], v251, s[16:19], s43 offen offset:1024
    s_waitcnt lgkmcnt(4)
    v_mfma_f32_16x16x32_bf16 v[216:219], a[112:115], v[184:187], v[216:219]
    ds_read_b128 v[168:171], v240 offset:12288
    v_mfma_f32_16x16x32_bf16 v[232:235], a[184:187], v[184:187], v[232:235]
    v_mfma_f32_16x16x32_bf16 v[220:223], a[112:115], v[188:191], v[220:223]
    ds_read_b128 v[172:175], v241 offset:12288
    v_mfma_f32_16x16x32_bf16 v[236:239], a[184:187], v[188:191], v[236:239]
    v_mfma_f32_16x16x32_bf16 v[224:227], a[112:115], v[192:195], v[224:227]
    ds_read_b128 v[176:179], v242 offset:12288
    v_mfma_f32_16x16x32_bf16 v[228:231], a[112:115], v[196:199], v[228:231]
    ds_read_b128 v[180:183], v243 offset:12288
    buffer_load_dwordx4 v[56:59], v251, s[16:19], s43 offen offset:2048
    s_waitcnt lgkmcnt(4)
    v_mfma_f32_16x16x32_bf16 v[216:219], a[116:119], v[200:203], v[216:219]
    ds_read_b128 v[184:187], v240 offset:13312
    v_mfma_f32_16x16x32_bf16 v[232:235], a[188:191], v[200:203], v[232:235]
    v_mfma_f32_16x16x32_bf16 v[220:223], a[116:119], v[204:207], v[220:223]
    ds_read_b128 v[188:191], v241 offset:13312
    v_mfma_f32_16x16x32_bf16 v[236:239], a[188:191], v[204:207], v[236:239]
    v_mfma_f32_16x16x32_bf16 v[224:227], a[116:119], v[208:211], v[224:227]
    ds_read_b128 v[192:195], v242 offset:13312
    v_mfma_f32_16x16x32_bf16 v[228:231], a[116:119], v[212:215], v[228:231]
    ds_read_b128 v[196:199], v243 offset:13312
    buffer_load_dwordx4 v[60:63], v251, s[16:19], s43 offen offset:3072
    s_waitcnt lgkmcnt(4)
    v_mfma_f32_16x16x32_bf16 v[216:219], a[120:123], v[168:171], v[216:219]
    ds_read_b128 v[200:203], v240 offset:14336
    v_mfma_f32_16x16x32_bf16 v[232:235], a[192:195], v[168:171], v[232:235]
    v_mfma_f32_16x16x32_bf16 v[220:223], a[120:123], v[172:175], v[220:223]
    ds_read_b128 v[204:207], v241 offset:14336
    v_mfma_f32_16x16x32_bf16 v[236:239], a[192:195], v[172:175], v[236:239]
    buffer_load_dwordx4 v[64:67], v251, s[16:19], s44 offen offset:0
    v_mfma_f32_16x16x32_bf16 v[224:227], a[120:123], v[176:179], v[224:227]
    ds_read_b128 v[208:211], v242 offset:14336
    v_mfma_f32_16x16x32_bf16 v[228:231], a[120:123], v[180:183], v[228:231]
    ds_read_b128 v[212:215], v243 offset:14336
    buffer_load_dwordx4 v[68:71], v251, s[16:19], s44 offen offset:1024
    s_waitcnt lgkmcnt(4)
    v_mfma_f32_16x16x32_bf16 v[216:219], a[124:127], v[184:187], v[216:219]
    ds_read_b128 v[168:171], v240 offset:15360
    v_mfma_f32_16x16x32_bf16 v[232:235], a[196:199], v[184:187], v[232:235]
    v_mfma_f32_16x16x32_bf16 v[220:223], a[124:127], v[188:191], v[220:223]
    ds_read_b128 v[172:175], v241 offset:15360
    v_mfma_f32_16x16x32_bf16 v[236:239], a[196:199], v[188:191], v[236:239]
    v_mfma_f32_16x16x32_bf16 v[224:227], a[124:127], v[192:195], v[224:227]
    ds_read_b128 v[176:179], v242 offset:15360
    v_mfma_f32_16x16x32_bf16 v[228:231], a[124:127], v[196:199], v[228:231]
    ds_read_b128 v[180:183], v243 offset:15360
    buffer_load_dwordx4 v[72:75], v251, s[16:19], s44 offen offset:2048
    s_waitcnt lgkmcnt(4)
    v_mfma_f32_16x16x32_bf16 v[216:219], a[128:131], v[200:203], v[216:219]
    ds_read_b128 v[184:187], v240 offset:16384
    v_mfma_f32_16x16x32_bf16 v[232:235], a[200:203], v[200:203], v[232:235]
    v_mfma_f32_16x16x32_bf16 v[220:223], a[128:131], v[204:207], v[220:223]
    ds_read_b128 v[188:191], v241 offset:16384
    v_mfma_f32_16x16x32_bf16 v[236:239], a[200:203], v[204:207], v[236:239]
    v_mfma_f32_16x16x32_bf16 v[224:227], a[128:131], v[208:211], v[224:227]
    ds_read_b128 v[192:195], v242 offset:16384
    v_mfma_f32_16x16x32_bf16 v[228:231], a[128:131], v[212:215], v[228:231]
    ds_read_b128 v[196:199], v243 offset:16384
    buffer_load_dwordx4 v[76:79], v251, s[16:19], s44 offen offset:3072
    s_waitcnt lgkmcnt(4)
    v_mfma_f32_16x16x32_bf16 v[216:219], a[132:135], v[168:171], v[216:219]
    ds_read_b128 v[200:203], v240 offset:17408
    v_mfma_f32_16x16x32_bf16 v[232:235], a[204:207], v[168:171], v[232:235]
    v_mfma_f32_16x16x32_bf16 v[220:223], a[132:135], v[172:175], v[220:223]
    ds_read_b128 v[204:207], v241 offset:17408
    v_mfma_f32_16x16x32_bf16 v[236:239], a[204:207], v[172:175], v[236:239]
    buffer_load_dwordx4 v[80:83], v251, s[16:19], s45 offen offset:0
    v_mfma_f32_16x16x32_bf16 v[224:227], a[132:135], v[176:179], v[224:227]
    ds_read_b128 v[208:211], v242 offset:17408
    v_mfma_f32_16x16x32_bf16 v[228:231], a[132:135], v[180:183], v[228:231]
    ds_read_b128 v[212:215], v243 offset:17408
    buffer_load_dwordx4 v[84:87], v251, s[16:19], s45 offen offset:1024
    s_waitcnt lgkmcnt(4)
    v_mfma_f32_16x16x32_bf16 v[216:219], a[136:139], v[184:187], v[216:219]
    v_mfma_f32_16x16x32_bf16 v[232:235], a[208:211], v[184:187], v[232:235]
    v_mfma_f32_16x16x32_bf16 v[220:223], a[136:139], v[188:191], v[220:223]
    v_mfma_f32_16x16x32_bf16 v[236:239], a[208:211], v[188:191], v[236:239]
    v_mfma_f32_16x16x32_bf16 v[224:227], a[136:139], v[192:195], v[224:227]
    v_mfma_f32_16x16x32_bf16 v[228:231], a[136:139], v[196:199], v[228:231]
    buffer_load_dwordx4 v[88:91], v251, s[16:19], s45 offen offset:2048
    s_waitcnt lgkmcnt(0)
    v_mfma_f32_16x16x32_bf16 v[216:219], a[140:143], v[200:203], v[216:219]
    v_mfma_f32_16x16x32_bf16 v[232:235], a[212:215], v[200:203], v[232:235]
    v_mfma_f32_16x16x32_bf16 v[220:223], a[140:143], v[204:207], v[220:223]
    v_mfma_f32_16x16x32_bf16 v[236:239], a[212:215], v[204:207], v[236:239]
    v_mfma_f32_16x16x32_bf16 v[224:227], a[140:143], v[208:211], v[224:227]
    v_mfma_f32_16x16x32_bf16 v[228:231], a[140:143], v[212:215], v[228:231]
    buffer_load_dwordx4 v[92:95], v251, s[16:19], s45 offen offset:3072
    v_lshrrev_b32 v141, 1, v250
    v_lshlrev_b32 v144, 8, v141
    v_lshl_add_u32 v144, v249, 4, v144
    v_xor_b32 v141, s20, v250
    v_and_b32 v141, 1, v141
    v_mul_u32_u24 v141, 18432, v141
    v_add_u32 v144, v144, v141
    s_mul_i32 s38, s28, 73728
    s_add_u32 s38, s38, 4194304
    s_waitcnt vmcnt(24)
    s_xor_b32 s24, s20, 0
    s_lshr_b32 s24, s24, 1
    s_mul_i32 s24, s24, 36864
    s_add_u32 s24, s24, s38
    s_lshl_b32 s25, s31, 9
    s_add_u32 s24, s24, s25
    v_permlane16_swap_b32 v232, v236
    v_permlane16_swap_b32 v233, v237
    v_permlane16_swap_b32 v234, v238
    v_permlane16_swap_b32 v235, v239
    v_lshlrev_b32 v140, 16, v164
    v_and_b32 v141, s59, v164
    v_lshlrev_b32 v142, 16, v165
    v_and_b32 v143, s59, v165
    v_pk_add_f32 v[232:233], v[232:233], v[140:141]
    v_pk_add_f32 v[234:235], v[234:235], v[142:143]
    v_cvt_pk_bf16_f32 v232, v232, v233
    v_cvt_pk_bf16_f32 v233, v234, v235
    v_lshlrev_b32 v140, 16, v166
    v_and_b32 v141, s59, v166
    v_lshlrev_b32 v142, 16, v167
    v_and_b32 v143, s59, v167
    v_pk_add_f32 v[236:237], v[236:237], v[140:141]
    v_pk_add_f32 v[238:239], v[238:239], v[142:143]
    v_cvt_pk_bf16_f32 v234, v236, v237
    v_cvt_pk_bf16_f32 v235, v238, v239
    buffer_store_dwordx4 v[232:235], v144, s[12:15], s24 offen sc1
    s_xor_b32 s24, s20, 0
    s_lshr_b32 s24, s24, 1
    s_mul_i32 s24, s24, 36864
    s_add_u32 s24, s24, s38
    s_lshl_b32 s25, s30, 9
    s_add_u32 s24, s24, s25
    v_permlane16_swap_b32 v216, v220
    v_permlane16_swap_b32 v217, v221
    v_permlane16_swap_b32 v218, v222
    v_permlane16_swap_b32 v219, v223
    v_lshlrev_b32 v140, 16, v156
    v_and_b32 v141, s59, v156
    v_lshlrev_b32 v142, 16, v157
    v_and_b32 v143, s59, v157
    v_pk_add_f32 v[216:217], v[216:217], v[140:141]
    v_pk_add_f32 v[218:219], v[218:219], v[142:143]
    v_cvt_pk_bf16_f32 v216, v216, v217
    v_cvt_pk_bf16_f32 v217, v218, v219
    v_lshlrev_b32 v140, 16, v158
    v_and_b32 v141, s59, v158
    v_lshlrev_b32 v142, 16, v159
    v_and_b32 v143, s59, v159
    v_pk_add_f32 v[220:221], v[220:221], v[140:141]
    v_pk_add_f32 v[222:223], v[222:223], v[142:143]
    v_cvt_pk_bf16_f32 v218, v220, v221
    v_cvt_pk_bf16_f32 v219, v222, v223
    buffer_store_dwordx4 v[216:219], v144, s[12:15], s24 offen sc1
    s_xor_b32 s24, s20, 2
    s_lshr_b32 s24, s24, 1
    s_mul_i32 s24, s24, 36864
    s_add_u32 s24, s24, s38
    s_lshl_b32 s25, s30, 9
    s_add_u32 s24, s24, s25
    v_permlane16_swap_b32 v224, v228
    v_permlane16_swap_b32 v225, v229
    v_permlane16_swap_b32 v226, v230
    v_permlane16_swap_b32 v227, v231
    v_lshlrev_b32 v140, 16, v160
    v_and_b32 v141, s59, v160
    v_lshlrev_b32 v142, 16, v161
    v_and_b32 v143, s59, v161
    v_pk_add_f32 v[224:225], v[224:225], v[140:141]
    v_pk_add_f32 v[226:227], v[226:227], v[142:143]
    v_cvt_pk_bf16_f32 v224, v224, v225
    v_cvt_pk_bf16_f32 v225, v226, v227
    v_lshlrev_b32 v140, 16, v162
    v_and_b32 v141, s59, v162
    v_lshlrev_b32 v142, 16, v163
    v_and_b32 v143, s59, v163
    v_pk_add_f32 v[228:229], v[228:229], v[140:141]
    v_pk_add_f32 v[230:231], v[230:231], v[142:143]
    v_cvt_pk_bf16_f32 v226, v228, v229
    v_cvt_pk_bf16_f32 v227, v230, v231
    buffer_store_dwordx4 v[224:227], v144, s[12:15], s24 offen sc1
    s_lshl_b32 s24, s28, 10
    s_lshl_b32 s25, s29, 7
    s_add_u32 s24, s24, s25
    s_add_u32 s24, s24, 163840
    s_waitcnt vmcnt(0)
    s_barrier
    s_cmp_lg_u32 s20, 0
    s_cbranch_scc1 L_noarr3
    s_mov_b64 exec, 1
    buffer_store_dword v245, v244, s[12:15], s24 offen sc1
    s_mov_b64 exec, -1
L_noarr3:
L_p3:
    s_lshr_b32 s24, s21, 2
    s_lshl_b32 s24, s24, 4
    s_lshr_b32 s25, s22, 1
    s_add_u32 s28, s24, s25
    s_and_b32 s24, s21, 3
    s_lshl_b32 s24, s24, 1
    s_and_b32 s25, s22, 1
    s_add_u32 s29, s24, s25
    s_lshl_b32 s25, s29, 2
    s_add_u32 s25, s25, s20
    s_mul_i32 s25, s25, 331776
    s_add_u32 s25, s25, 8388608
    s_add_u32 s16, s100, s25
    s_addc_u32 s17, s101, 0
    s_mov_b32 s18, 36864
    s_mov_b32 s19, 0x20000
    s_mov_b32 s40, 0
    s_mov_b32 s41, 4096
    s_mov_b32 s42, 8192
    s_mov_b32 s43, 12288
    s_mov_b32 s44, 16384
    s_mov_b32 s45, 20480
    s_mov_b32 s46, 24576
    s_mov_b32 s47, 28672
    s_mov_b32 s48, 32768
    s_mov_b32 s8, s74
    s_mov_b32 s9, s75
    s_mov_b32 s10, 0x2400
    s_mov_b32 s11, 0x20000
    s_add_u32 s64, s16, 165888
    s_addc_u32 s65, s17, 0
    s_mul_i32 s24, s28, 37
    s_lshr_b32 s24, s24, 8
    s_mul_i32 s24, s24, 7
    s_sub_u32 s24, s28, s24
    s_add_u32 s68, s24, 1
    s_add_u32 s24, s24, 1
    s_cmp_eq_u32 s24, 7
    s_cselect_b32 s24, 0, s24
    s_add_u32 s69, s24, 1
    s_add_u32 s24, s24, 1
    s_cmp_eq_u32 s24, 7
    s_cselect_b32 s24, 0, s24
    s_add_u32 s70, s24, 1
    s_add_u32 s24, s24, 1
    s_cmp_eq_u32 s24, 7
    s_cselect_b32 s24, 0, s24
    s_add_u32 s71, s24, 1
    s_add_u32 s24, s24, 1
    s_cmp_eq_u32 s24, 7
    s_cselect_b32 s24, 0, s24
    s_add_u32 s72, s24, 1
    s_add_u32 s24, s24, 1
    s_cmp_eq_u32 s24, 7
    s_cselect_b32 s24, 0, s24
    s_add_u32 s73, s24, 1
    s_add_u32 s24, s24, 1
    s_cmp_eq_u32 s24, 7
    s_cselect_b32 s24, 0, s24
    s_add_u32 s74, s24, 1
    s_add_u32 s24, s24, 1
    s_cmp_eq_u32 s24, 7
    s_cselect_b32 s24, 0, s24
    v_mov_b32 v252, 0
    v_mov_b32 v253, 1
    v_lshl_add_u32 v254, s20, 6, v248
    s_cmp_eq_u32 s63, 1
    s_cbranch_scc1 L_havepf
    s_mov_b32 s24, 96768
    s_mov_b64 exec, 1
    s_mov_b32 s27, 0
L_poll8:
    buffer_load_dword v208, v252, s[12:15], s24 offen offset:0 sc1
    s_waitcnt vmcnt(0)
    v_cmp_ne_u32 vcc, 1, v208
    s_add_u32 s27, s27, 1
    s_nop 3
    s_cbranch_vccz L_poll8_done
    s_cmp_ge_u32 s27, 0x4000
    s_cbranch_scc1 L_poll8_done
    s_sleep 4
    s_branch L_poll8
L_poll8_done:
    s_mov_b64 exec, -1
    buffer_load_dwordx4 v[0:3], v251, s[16:19], s40 offen offset:0
    buffer_load_dwordx4 v[4:7], v251, s[16:19], s40 offen offset:1024
    buffer_load_dwordx4 v[8:11], v251, s[16:19], s40 offen offset:2048
    buffer_load_dwordx4 v[12:15], v251, s[16:19], s40 offen offset:3072
    buffer_load_dwordx4 v[16:19], v251, s[16:19], s41 offen offset:0
    buffer_load_dwordx4 v[20:23], v251, s[16:19], s41 offen offset:1024
    buffer_load_dwordx4 v[24:27], v251, s[16:19], s41 offen offset:2048
    buffer_load_dwordx4 v[28:31], v251, s[16:19], s41 offen offset:3072
    buffer_load_dwordx4 v[32:35], v251, s[16:19], s42 offen offset:0
    buffer_load_dwordx4 v[36:39], v251, s[16:19], s42 offen offset:1024
    buffer_load_dwordx4 v[40:43], v251, s[16:19], s42 offen offset:2048
    buffer_load_dwordx4 v[44:47], v251, s[16:19], s42 offen offset:3072
    buffer_load_dwordx4 v[48:51], v251, s[16:19], s43 offen offset:0
    buffer_load_dwordx4 v[52:55], v251, s[16:19], s43 offen offset:1024
    buffer_load_dwordx4 v[56:59], v251, s[16:19], s43 offen offset:2048
    buffer_load_dwordx4 v[60:63], v251, s[16:19], s43 offen offset:3072
    buffer_load_dwordx4 v[64:67], v251, s[16:19], s44 offen offset:0
    buffer_load_dwordx4 v[68:71], v251, s[16:19], s44 offen offset:1024
    buffer_load_dwordx4 v[72:75], v251, s[16:19], s44 offen offset:2048
    buffer_load_dwordx4 v[76:79], v251, s[16:19], s44 offen offset:3072
    buffer_load_dwordx4 v[80:83], v251, s[16:19], s45 offen offset:0
    buffer_load_dwordx4 v[84:87], v251, s[16:19], s45 offen offset:1024
    buffer_load_dwordx4 v[88:91], v251, s[16:19], s45 offen offset:2048
    buffer_load_dwordx4 v[92:95], v251, s[16:19], s45 offen offset:3072
L_havepf:
    v_lshlrev_b32 v208, 4, v254
    v_lshlrev_b32 v209, 3, v254
    s_mul_i32 s24, s29, 2304
    s_add_u32 s24, s24, 104448
    s_mul_i32 s26, s29, 1152
    buffer_load_dwordx4 v[144:147], v208, s[12:15], s24 offen sc1
    buffer_load_dwordx2 v[168:169], v209, s[8:11], s26 offen
    buffer_load_dwordx4 v[96:99], v251, s[16:19], s46 offen offset:0
    buffer_load_dwordx4 v[100:103], v251, s[16:19], s46 offen offset:1024
    buffer_load_dwordx4 v[104:107], v251, s[16:19], s46 offen offset:2048
    buffer_load_dwordx4 v[108:111], v251, s[16:19], s46 offen offset:3072
    buffer_load_dwordx4 v[112:115], v251, s[16:19], s47 offen offset:0
    buffer_load_dwordx4 v[116:119], v251, s[16:19], s47 offen offset:1024
    buffer_load_dwordx4 v[120:123], v251, s[16:19], s47 offen offset:2048
    buffer_load_dwordx4 v[124:127], v251, s[16:19], s47 offen offset:3072
    s_xor_b32 s24, s20, 0
    s_mul_i32 s24, s24, 18432
    v_add_u32 v176, s24, v251
    s_xor_b32 s24, s20, 1
    s_mul_i32 s24, s24, 18432
    v_add_u32 v177, s24, v251
    s_xor_b32 s24, s20, 2
    s_mul_i32 s24, s24, 18432
    v_add_u32 v178, s24, v251
    s_xor_b32 s24, s20, 3
    s_mul_i32 s24, s24, 18432
    v_add_u32 v179, s24, v251
    s_mul_i32 s24, s20, 1152
    s_add_u32 s24, s24, 147456
    v_lshlrev_b32 v180, 5, v250
    v_add_u32 v180, s24, v180
    v_mov_b32 v192, s58
    v_mov_b32 v193, s58
    v_mov_b32 v194, s58
    v_mov_b32 v195, s58
    s_waitcnt vmcnt(8)
    v_lshlrev_b32 v148, 16, v168
    v_and_b32 v149, s59, v168
    v_lshlrev_b32 v150, 16, v169
    v_and_b32 v151, s59, v169
    v_lshlrev_b32 v208, 5, v254
    v_add_u32 v208, 147456, v208
    v_cmp_gt_u32 vcc, 0x90, v254
    s_and_saveexec_b64 s[50:51], vcc
    ds_write_b128 v208, v[144:147]
    ds_write_b128 v208, v[148:151] offset:16
    s_mov_b64 exec, s[50:51]
    s_mul_i32 s32, s28, 73728
    s_mul_i32 s24, s20, 18432
    s_add_u32 s32, s32, s24
    s_add_u32 s32, s32, 4194304
    s_add_u32 m0, s24, 0
    s_cmp_lg_u32 s20, 0
    s_cbranch_scc1 L_nopoll2
    s_lshl_b32 s24, s28, 10
    s_add_u32 s24, s24, 163840
    v_lshlrev_b32 v209, 7, v248
    s_mov_b64 exec, 0x3f
    s_mov_b32 s27, 0
L_poll9:
    buffer_load_dword v208, v209, s[12:15], s24 offen offset:0 sc1
    s_waitcnt vmcnt(0)
    v_cmp_ne_u32 vcc, 1, v208
    s_add_u32 s27, s27, 1
    s_nop 3
    s_cbranch_vccz L_poll9_done
    s_cmp_ge_u32 s27, 0x4000
    s_cbranch_scc1 L_poll9_done
    s_sleep 2
    s_branch L_poll9
L_poll9_done:
    s_mov_b64 exec, -1
L_nopoll2:
    s_barrier
    s_mov_b32 s25, s32
    v_lshlrev_b32 v191, 7, v248
    buffer_load_dwordx4 v251, s[12:15], s25 offen offset:0 sc1 lds
    buffer_load_dwordx4 v251, s[12:15], s25 offen offset:1024 sc1 lds
    buffer_load_dwordx4 v251, s[12:15], s25 offen offset:2048 sc1 lds
    buffer_load_dwordx4 v251, s[12:15], s25 offen offset:3072 sc1 lds
    s_add_u32 s25, s25, 4096
    s_add_u32 m0, m0, 4096
    s_nop 0
    buffer_load_dwordx4 v251, s[12:15], s25 offen offset:0 sc1 lds
    buffer_load_dwordx4 v251, s[12:15], s25 offen offset:1024 sc1 lds
    s_waitcnt vmcnt(5)
    ds_read_b128 a[0:3], v176 offset:0
    buffer_load_dwordx4 v251, s[12:15], s25 offen offset:2048 sc1 lds
    s_waitcnt vmcnt(5)
    ds_read_b128 a[16:19], v176 offset:1024
    buffer_load_dwordx4 v251, s[12:15], s25 offen offset:3072 sc1 lds
    s_add_u32 s25, s25, 4096
    s_add_u32 m0, m0, 4096
    s_nop 0
    s_waitcnt vmcnt(5)
    ds_read_b128 a[32:35], v176 offset:2048
    buffer_load_dwordx4 v251, s[12:15], s25 offen offset:0 sc1 lds
    s_waitcnt vmcnt(5)
    ds_read_b128 a[48:51], v176 offset:3072
    buffer_load_dwordx4 v251, s[12:15], s25 offen offset:1024 sc1 lds
    s_waitcnt vmcnt(5)
    ds_read_b128 a[64:67], v176 offset:4096
    buffer_load_dwordx4 v251, s[12:15], s25 offen offset:2048 sc1 lds
    s_waitcnt lgkmcnt(4)
    v_mfma_f32_16x16x32_bf16 v[208:211], v[192:195], a[0:3], 0
    v_mfma_f32_16x16x32_bf16 v[212:215], a[0:3], a[0:3], 0
    s_waitcnt vmcnt(5)
    ds_read_b128 a[80:83], v176 offset:5120
    buffer_load_dwordx4 v251, s[12:15], s25 offen offset:3072 sc1 lds
    s_add_u32 s25, s25, 4096
    s_add_u32 m0, m0, 4096
    s_nop 0
    s_waitcnt lgkmcnt(4)
    v_mfma_f32_16x16x32_bf16 v[208:211], v[192:195], a[16:19], v[208:211]
    v_mfma_f32_16x16x32_bf16 v[212:215], a[16:19], a[16:19], v[212:215]
    s_barrier
    ds_read_b128 a[4:7], v177 offset:0
    ds_read_b128 a[8:11], v178 offset:0
    ds_read_b128 a[12:15], v179 offset:0
    ds_read_b128 a[20:23], v177 offset:1024
    ds_read_b128 a[24:27], v178 offset:1024
    ds_read_b128 a[28:31], v179 offset:1024
    ds_read_b128 a[36:39], v177 offset:2048
    ds_read_b128 a[40:43], v178 offset:2048
    ds_read_b128 a[44:47], v179 offset:2048
    s_waitcnt lgkmcnt(9)
    v_mfma_f32_16x16x32_bf16 v[208:211], v[192:195], a[32:35], v[208:211]
    v_mfma_f32_16x16x32_bf16 v[212:215], a[32:35], a[32:35], v[212:215]
    v_mfma_f32_16x16x32_bf16 v[208:211], v[192:195], a[48:51], v[208:211]
    v_mfma_f32_16x16x32_bf16 v[212:215], a[48:51], a[48:51], v[212:215]
    v_mfma_f32_16x16x32_bf16 v[208:211], v[192:195], a[64:67], v[208:211]
    v_mfma_f32_16x16x32_bf16 v[212:215], a[64:67], a[64:67], v[212:215]
    v_mfma_f32_16x16x32_bf16 v[208:211], v[192:195], a[80:83], v[208:211]
    v_mfma_f32_16x16x32_bf16 v[212:215], a[80:83], a[80:83], v[212:215]
    s_waitcnt lgkmcnt(6)
    s_waitcnt vmcnt(42)
    v_mfma_f32_16x16x32_bf16 v[144:147], v[0:3], a[0:3], 0
    buffer_load_dwordx4 v251, s[12:15], s25 offen offset:0 sc1 lds
    v_mfma_f32_16x16x32_bf16 v[148:151], v[0:3], a[4:7], 0
    ds_read_b128 a[52:55], v177 offset:3072
    ds_read_b128 a[56:59], v178 offset:3072
    v_mfma_f32_16x16x32_bf16 v[152:155], v[0:3], a[8:11], 0
    ds_read_b128 a[60:63], v179 offset:3072
    ds_read_b128 a[68:71], v177 offset:4096
    v_mfma_f32_16x16x32_bf16 v[156:159], v[0:3], a[12:15], 0
    ds_read_b128 a[72:75], v178 offset:4096
    ds_read_b128 a[76:79], v179 offset:4096
    s_waitcnt lgkmcnt(9)
    v_mfma_f32_16x16x32_bf16 v[144:147], v[4:7], a[16:19], v[144:147]
    buffer_load_dwordx4 v251, s[12:15], s25 offen offset:1024 sc1 lds
    v_mfma_f32_16x16x32_bf16 v[148:151], v[4:7], a[20:23], v[148:151]
    ds_read_b128 a[84:87], v177 offset:5120
    ds_read_b128 a[88:91], v178 offset:5120
    v_mfma_f32_16x16x32_bf16 v[152:155], v[4:7], a[24:27], v[152:155]
    ds_read_b128 a[92:95], v179 offset:5120
    v_mfma_f32_16x16x32_bf16 v[156:159], v[4:7], a[28:31], v[156:159]
    s_waitcnt lgkmcnt(9)
    s_waitcnt vmcnt(42)
    v_mfma_f32_16x16x32_bf16 v[144:147], v[8:11], a[32:35], v[144:147]
    buffer_load_dwordx4 v251, s[12:15], s25 offen offset:2048 sc1 lds
    v_mfma_f32_16x16x32_bf16 v[148:151], v[8:11], a[36:39], v[148:151]
    v_mfma_f32_16x16x32_bf16 v[152:155], v[8:11], a[40:43], v[152:155]
    v_mfma_f32_16x16x32_bf16 v[156:159], v[8:11], a[44:47], v[156:159]
    s_waitcnt lgkmcnt(6)
    v_mfma_f32_16x16x32_bf16 v[144:147], v[12:15], a[48:51], v[144:147]
    buffer_load_dwordx4 v251, s[12:15], s25 offen offset:3072 sc1 lds
    s_add_u32 s25, s25, 4096
    s_add_u32 m0, m0, 4096
    s_nop 0
    v_mfma_f32_16x16x32_bf16 v[148:151], v[12:15], a[52:55], v[148:151]
    v_mfma_f32_16x16x32_bf16 v[152:155], v[12:15], a[56:59], v[152:155]
    v_mfma_f32_16x16x32_bf16 v[156:159], v[12:15], a[60:63], v[156:159]
    s_waitcnt lgkmcnt(3)
    s_waitcnt vmcnt(42)
    v_mfma_f32_16x16x32_bf16 v[144:147], v[16:19], a[64:67], v[144:147]
    buffer_load_dwordx4 v251, s[12:15], s25 offen offset:0 sc1 lds
    v_mfma_f32_16x16x32_bf16 v[148:151], v[16:19], a[68:71], v[148:151]
    v_mfma_f32_16x16x32_bf16 v[152:155], v[16:19], a[72:75], v[152:155]
    v_mfma_f32_16x16x32_bf16 v[156:159], v[16:19], a[76:79], v[156:159]
    s_waitcnt lgkmcnt(0)
    v_mfma_f32_16x16x32_bf16 v[144:147], v[20:23], a[80:83], v[144:147]
    buffer_load_dwordx4 v251, s[12:15], s25 offen offset:1024 sc1 lds
    v_mfma_f32_16x16x32_bf16 v[148:151], v[20:23], a[84:87], v[148:151]
    v_mfma_f32_16x16x32_bf16 v[152:155], v[20:23], a[88:91], v[152:155]
    v_mfma_f32_16x16x32_bf16 v[156:159], v[20:23], a[92:95], v[156:159]
    s_waitcnt vmcnt(11)
    ds_read_b128 a[96:99], v176 offset:6144
    s_mov_b32 s24, 92160
    s_mov_b32 exec_hi, 0
    buffer_load_dword v181, v191, s[12:15], s24 offen sc1
    s_mov_b32 exec_hi, -1
    s_waitcnt vmcnt(11)
    ds_read_b128 a[112:115], v176 offset:7168
    buffer_load_dwordx4 v[128:131], v251, s[16:19], s48 offen offset:0
    s_waitcnt vmcnt(11)
    ds_read_b128 a[128:131], v176 offset:8192
    buffer_load_dwordx4 v[132:135], v251, s[16:19], s48 offen offset:1024
    s_waitcnt vmcnt(11)
    ds_read_b128 a[144:147], v176 offset:9216
    buffer_load_dwordx4 v[136:139], v251, s[16:19], s48 offen offset:2048
    s_waitcnt vmcnt(11)
    ds_read_b128 a[160:163], v176 offset:10240
    buffer_load_dwordx4 v[140:143], v251, s[16:19], s48 offen offset:3072
    s_add_u32 s16, s16, 36864
    s_addc_u32 s17, s17, 0
    s_waitcnt lgkmcnt(4)
    v_mfma_f32_16x16x32_bf16 v[208:211], v[192:195], a[96:99], v[208:211]
    v_mfma_f32_16x16x32_bf16 v[212:215], a[96:99], a[96:99], v[212:215]
    s_waitcnt vmcnt(11)
    ds_read_b128 a[176:179], v176 offset:11264
    buffer_load_dwordx4 v[0:3], v251, s[16:19], s40 offen offset:0
    s_waitcnt lgkmcnt(4)
    v_mfma_f32_16x16x32_bf16 v[208:211], v[192:195], a[112:115], v[208:211]
    v_mfma_f32_16x16x32_bf16 v[212:215], a[112:115], a[112:115], v[212:215]
    s_barrier
    ds_read_b128 a[100:103], v177 offset:6144
    ds_read_b128 a[104:107], v178 offset:6144
    ds_read_b128 a[108:111], v179 offset:6144
    ds_read_b128 a[116:119], v177 offset:7168
    ds_read_b128 a[120:123], v178 offset:7168
    ds_read_b128 a[124:127], v179 offset:7168
    ds_read_b128 a[132:135], v177 offset:8192
    ds_read_b128 a[136:139], v178 offset:8192
    ds_read_b128 a[140:143], v179 offset:8192
    s_waitcnt lgkmcnt(9)
    v_mfma_f32_16x16x32_bf16 v[208:211], v[192:195], a[128:131], v[208:211]
    v_mfma_f32_16x16x32_bf16 v[212:215], a[128:131], a[128:131], v[212:215]
    v_mfma_f32_16x16x32_bf16 v[208:211], v[192:195], a[144:147], v[208:211]
    v_mfma_f32_16x16x32_bf16 v[212:215], a[144:147], a[144:147], v[212:215]
    v_mfma_f32_16x16x32_bf16 v[208:211], v[192:195], a[160:163], v[208:211]
    v_mfma_f32_16x16x32_bf16 v[212:215], a[160:163], a[160:163], v[212:215]
    v_mfma_f32_16x16x32_bf16 v[208:211], v[192:195], a[176:179], v[208:211]
    v_mfma_f32_16x16x32_bf16 v[212:215], a[176:179], a[176:179], v[212:215]
    s_waitcnt lgkmcnt(6)
    s_waitcnt vmcnt(48)
    v_mfma_f32_16x16x32_bf16 v[144:147], v[24:27], a[96:99], v[144:147]
    buffer_load_dwordx4 v[4:7], v251, s[16:19], s40 offen offset:1024
    v_mfma_f32_16x16x32_bf16 v[148:151], v[24:27], a[100:103], v[148:151]
    ds_read_b128 a[148:151], v177 offset:9216
    ds_read_b128 a[152:155], v178 offset:9216
    v_mfma_f32_16x16x32_bf16 v[152:155], v[24:27], a[104:107], v[152:155]
    ds_read_b128 a[156:159], v179 offset:9216
    ds_read_b128 a[164:167], v177 offset:10240
    v_mfma_f32_16x16x32_bf16 v[156:159], v[24:27], a[108:111], v[156:159]
    ds_read_b128 a[168:171], v178 offset:10240
    ds_read_b128 a[172:175], v179 offset:10240
    s_waitcnt lgkmcnt(9)
    v_mfma_f32_16x16x32_bf16 v[144:147], v[28:31], a[112:115], v[144:147]
    buffer_load_dwordx4 v[8:11], v251, s[16:19], s40 offen offset:2048
    v_mfma_f32_16x16x32_bf16 v[148:151], v[28:31], a[116:119], v[148:151]
    ds_read_b128 a[180:183], v177 offset:11264
    ds_read_b128 a[184:187], v178 offset:11264
    v_mfma_f32_16x16x32_bf16 v[152:155], v[28:31], a[120:123], v[152:155]
    ds_read_b128 a[188:191], v179 offset:11264
    v_mfma_f32_16x16x32_bf16 v[156:159], v[28:31], a[124:127], v[156:159]
    s_waitcnt lgkmcnt(9)
    s_waitcnt vmcnt(48)
    v_mfma_f32_16x16x32_bf16 v[144:147], v[32:35], a[128:131], v[144:147]
    buffer_load_dwordx4 v[12:15], v251, s[16:19], s40 offen offset:3072
    v_mfma_f32_16x16x32_bf16 v[148:151], v[32:35], a[132:135], v[148:151]
    v_mfma_f32_16x16x32_bf16 v[152:155], v[32:35], a[136:139], v[152:155]
    v_mfma_f32_16x16x32_bf16 v[156:159], v[32:35], a[140:143], v[156:159]
    s_waitcnt lgkmcnt(6)
    v_mfma_f32_16x16x32_bf16 v[144:147], v[36:39], a[144:147], v[144:147]
    buffer_load_dwordx4 v[16:19], v251, s[16:19], s41 offen offset:0
    v_mfma_f32_16x16x32_bf16 v[148:151], v[36:39], a[148:151], v[148:151]
    v_mfma_f32_16x16x32_bf16 v[152:155], v[36:39], a[152:155], v[152:155]
    v_mfma_f32_16x16x32_bf16 v[156:159], v[36:39], a[156:159], v[156:159]
    s_waitcnt lgkmcnt(3)
    s_waitcnt vmcnt(48)
    v_mfma_f32_16x16x32_bf16 v[144:147], v[40:43], a[160:163], v[144:147]
    buffer_load_dwordx4 v[20:23], v251, s[16:19], s41 offen offset:1024
    v_mfma_f32_16x16x32_bf16 v[148:151], v[40:43], a[164:167], v[148:151]
    v_mfma_f32_16x16x32_bf16 v[152:155], v[40:43], a[168:171], v[152:155]
    v_mfma_f32_16x16x32_bf16 v[156:159], v[40:43], a[172:175], v[156:159]
    s_waitcnt lgkmcnt(0)
    v_mfma_f32_16x16x32_bf16 v[144:147], v[44:47], a[176:179], v[144:147]
    buffer_load_dwordx4 v[24:27], v251, s[16:19], s41 offen offset:2048
    v_mfma_f32_16x16x32_bf16 v[148:151], v[44:47], a[180:183], v[148:151]
    v_mfma_f32_16x16x32_bf16 v[152:155], v[44:47], a[184:187], v[152:155]
    v_mfma_f32_16x16x32_bf16 v[156:159], v[44:47], a[188:191], v[156:159]
    s_waitcnt vmcnt(17)
    ds_read_b128 a[192:195], v176 offset:12288
    buffer_load_dwordx4 v[28:31], v251, s[16:19], s41 offen offset:3072
    s_waitcnt vmcnt(17)
    ds_read_b128 a[208:211], v176 offset:13312
    buffer_load_dwordx4 v[32:35], v251, s[16:19], s42 offen offset:0
    s_waitcnt vmcnt(17)
    ds_read_b128 a[224:227], v176 offset:14336
    buffer_load_dwordx4 v[36:39], v251, s[16:19], s42 offen offset:1024
    s_waitcnt vmcnt(17)
    ds_read_b128 a[240:243], v176 offset:15360
    s_waitcnt vmcnt(16)
    ds_read_b128 v[216:219], v176 offset:16384
    s_waitcnt lgkmcnt(4)
    v_mfma_f32_16x16x32_bf16 v[208:211], v[192:195], a[192:195], v[208:211]
    v_mfma_f32_16x16x32_bf16 v[212:215], a[192:195], a[192:195], v[212:215]
    s_waitcnt vmcnt(15)
    ds_read_b128 v[232:235], v176 offset:17408
    s_waitcnt lgkmcnt(4)
    v_mfma_f32_16x16x32_bf16 v[208:211], v[192:195], a[208:211], v[208:211]
    v_mfma_f32_16x16x32_bf16 v[212:215], a[208:211], a[208:211], v[212:215]
    s_barrier
    ds_read_b128 a[196:199], v177 offset:12288
    ds_read_b128 a[200:203], v178 offset:12288
    ds_read_b128 a[204:207], v179 offset:12288
    ds_read_b128 a[212:215], v177 offset:13312
    ds_read_b128 a[216:219], v178 offset:13312
    ds_read_b128 a[220:223], v179 offset:13312
    ds_read_b128 a[228:231], v177 offset:14336
    ds_read_b128 a[232:235], v178 offset:14336
    ds_read_b128 a[236:239], v179 offset:14336
    s_waitcnt lgkmcnt(9)
    v_mfma_f32_16x16x32_bf16 v[208:211], v[192:195], a[224:227], v[208:211]
    v_mfma_f32_16x16x32_bf16 v[212:215], a[224:227], a[224:227], v[212:215]
    v_mfma_f32_16x16x32_bf16 v[208:211], v[192:195], a[240:243], v[208:211]
    v_mfma_f32_16x16x32_bf16 v[212:215], a[240:243], a[240:243], v[212:215]
    v_mfma_f32_16x16x32_bf16 v[208:211], v[192:195], v[216:219], v[208:211]
    v_mfma_f32_16x16x32_bf16 v[212:215], v[216:219], v[216:219], v[212:215]
    v_mfma_f32_16x16x32_bf16 v[208:211], v[192:195], v[232:235], v[208:211]
    v_mfma_f32_16x16x32_bf16 v[212:215], v[232:235], v[232:235], v[212:215]
    s_waitcnt lgkmcnt(6)
    s_waitcnt vmcnt(51)
    v_mfma_f32_16x16x32_bf16 v[144:147], v[48:51], a[192:195], v[144:147]
    buffer_load_dwordx4 v[40:43], v251, s[16:19], s42 offen offset:2048
    v_mfma_f32_16x16x32_bf16 v[148:151], v[48:51], a[196:199], v[148:151]
    ds_read_b128 a[244:247], v177 offset:15360
    ds_read_b128 a[248:251], v178 offset:15360
    v_mfma_f32_16x16x32_bf16 v[152:155], v[48:51], a[200:203], v[152:155]
    ds_read_b128 a[252:255], v179 offset:15360
    ds_read_b128 v[220:223], v177 offset:16384
    v_mfma_f32_16x16x32_bf16 v[156:159], v[48:51], a[204:207], v[156:159]
    ds_read_b128 v[224:227], v178 offset:16384
    ds_read_b128 v[228:231], v179 offset:16384
    s_waitcnt lgkmcnt(9)
    v_mfma_f32_16x16x32_bf16 v[144:147], v[52:55], a[208:211], v[144:147]
    buffer_load_dwordx4 v[44:47], v251, s[16:19], s42 offen offset:3072
    v_mfma_f32_16x16x32_bf16 v[148:151], v[52:55], a[212:215], v[148:151]
    ds_read_b128 v[236:239], v177 offset:17408
    ds_read_b128 v[240:243], v178 offset:17408
    v_mfma_f32_16x16x32_bf16 v[152:155], v[52:55], a[216:219], v[152:155]
    ds_read_b128 v[244:247], v179 offset:17408
    v_and_b32 v200, 3, v249
    v_mfma_f32_16x16x32_bf16 v[156:159], v[52:55], a[220:223], v[156:159]
    v_lshrrev_b32 v201, 2, v249
    v_cmp_eq_u32 vcc, 1, v200
    s_waitcnt lgkmcnt(9)
    s_waitcnt vmcnt(51)
    v_mfma_f32_16x16x32_bf16 v[144:147], v[56:59], a[224:227], v[144:147]
    buffer_load_dwordx4 v[48:51], v251, s[16:19], s43 offen offset:0
    v_mfma_f32_16x16x32_bf16 v[148:151], v[56:59], a[228:231], v[148:151]
    s_nop 1
    v_cndmask_b32 v212, v212, v213, vcc
    v_mfma_f32_16x16x32_bf16 v[152:155], v[56:59], a[232:235], v[152:155]
    v_cmp_eq_u32 vcc, 2, v200
    s_nop 1
    v_mfma_f32_16x16x32_bf16 v[156:159], v[56:59], a[236:239], v[156:159]
    v_cndmask_b32 v212, v212, v214, vcc
    v_cmp_eq_u32 vcc, 3, v200
    s_waitcnt lgkmcnt(6)
    v_mfma_f32_16x16x32_bf16 v[144:147], v[60:63], a[240:243], v[144:147]
    buffer_load_dwordx4 v[52:55], v251, s[16:19], s43 offen offset:1024
    v_mfma_f32_16x16x32_bf16 v[148:151], v[60:63], a[244:247], v[148:151]
    s_nop 1
    v_cndmask_b32 v212, v212, v215, vcc
    v_mfma_f32_16x16x32_bf16 v[152:155], v[60:63], a[248:251], v[152:155]
    v_cmp_eq_u32 vcc, v201, v250
    s_nop 1
    v_mfma_f32_16x16x32_bf16 v[156:159], v[60:63], a[252:255], v[156:159]
    v_cndmask_b32 v212, 0, v212, vcc
    v_mov_b32 v213, v212
    s_waitcnt lgkmcnt(3)
    s_waitcnt vmcnt(51)
    v_mfma_f32_16x16x32_bf16 v[144:147], v[64:67], v[216:219], v[144:147]
    buffer_load_dwordx4 v[56:59], v251, s[16:19], s43 offen offset:2048
    v_mfma_f32_16x16x32_bf16 v[148:151], v[64:67], v[220:223], v[148:151]
    s_nop 1
    v_permlane32_swap_b32 v212, v213
    v_mfma_f32_16x16x32_bf16 v[152:155], v[64:67], v[224:227], v[152:155]
    s_nop 1
    v_add_f32 v212, v212, v213
    v_mfma_f32_16x16x32_bf16 v[156:159], v[64:67], v[228:231], v[156:159]
    v_mov_b32 v213, v212
    s_nop 1
    s_waitcnt lgkmcnt(0)
    v_mfma_f32_16x16x32_bf16 v[144:147], v[68:71], v[232:235], v[144:147]
    buffer_load_dwordx4 v[60:63], v251, s[16:19], s43 offen offset:3072
    v_mfma_f32_16x16x32_bf16 v[148:151], v[68:71], v[236:239], v[148:151]
    v_permlane16_swap_b32 v212, v213
    s_nop 1
    v_mfma_f32_16x16x32_bf16 v[152:155], v[68:71], v[240:243], v[152:155]
    v_add_f32 v212, v212, v213
    v_mul_f32 v208, 0x3ae38e39, v208
    v_mfma_f32_16x16x32_bf16 v[156:159], v[68:71], v[244:247], v[156:159]
    v_mul_f32 v212, 0x3ae38e39, v212
    v_fma_f32 v212, -v208, v208, v212
    v_max_f32 v212, 0, v212
    v_add_f32 v212, 0x3727c5ac, v212
    v_rsq_f32 v212, v212
    s_nop 0
    v_mul_f32 v213, v208, v212
    v_sub_f32 v213, 0, v213
    s_lshl_b32 s24, s20, 7
    s_add_u32 s24, s24, 152064
    v_lshlrev_b32 v255, 3, v249
    v_add_u32 v200, s24, v255
    s_waitcnt vmcnt(51)
    s_waitcnt vmcnt(20)
    ds_write_b64 v200, v[212:213]
    s_mov_b32 exec_hi, 0
    v_cmp_ne_u32 vcc, 8, v181
    s_mov_b32 exec_hi, -1
    s_mov_b32 s24, 92160
    s_nop 2
    s_cbranch_vccz L_r1c
    s_mov_b64 exec, 0xffffffff
    s_mov_b32 s27, 0
L_poll10:
    buffer_load_dword v181, v191, s[12:15], s24 offen offset:0 sc1
    s_waitcnt vmcnt(0)
    v_cmp_ne_u32 vcc, 8, v181
    s_add_u32 s27, s27, 1
    s_nop 3
    s_cbranch_vccz L_poll10_done
    s_cmp_ge_u32 s27, 0x4000
    s_cbranch_scc1 L_poll10_done
    s_sleep 8
    s_branch L_poll10
L_poll10_done:
    s_mov_b64 exec, -1
L_r1c:
    s_waitcnt lgkmcnt(0)
    s_barrier
    s_xor_b32 s24, s20, 0
    s_lshl_b32 s24, s24, 7
    s_add_u32 s24, s24, 152064
    v_add_u32 v200, s24, v255
    ds_read_b64 v[208:209], v200
    s_xor_b32 s24, s20, 1
    s_lshl_b32 s24, s24, 7
    s_add_u32 s24, s24, 152064
    v_add_u32 v201, s24, v255
    ds_read_b64 v[210:211], v201
    s_xor_b32 s24, s20, 2
    s_lshl_b32 s24, s24, 7
    s_add_u32 s24, s24, 152064
    v_add_u32 v202, s24, v255
    ds_read_b64 v[212:213], v202
    s_xor_b32 s24, s20, 3
    s_lshl_b32 s24, s24, 7
    s_add_u32 s24, s24, 152064
    v_add_u32 v203, s24, v255
    ds_read_b64 v[214:215], v203
    s_mul_i32 s24, s20, 3072
    s_add_u32 s24, s24, 73728
    v_add_u32 v190, 73728, v176
    v_add_u32 v176, s24, v176
    v_add_u32 v191, 73728, v177
    v_add_u32 v177, s24, v177
    v_add_u32 v254, 73728, v178
    v_add_u32 v178, s24, v178
    v_add_u32 v255, 73728, v179
    v_add_u32 v179, s24, v179
    s_waitcnt lgkmcnt(0)
    v_mov_b32 v182, v208
    v_mov_b32 v186, v209
    v_mov_b32 v183, v210
    v_mov_b32 v187, v211
    v_mov_b32 v184, v212
    v_mov_b32 v188, v213
    v_mov_b32 v185, v214
    v_mov_b32 v189, v215
    s_mov_b32 s31, 3
.p2align 6
L_g1:
    v_mfma_f32_16x16x32_bf16 v[160:163], v[72:75], a[0:3], 0
    buffer_load_dwordx4 v[64:67], v251, s[16:19], s44 offen offset:0
    v_mfma_f32_16x16x32_bf16 v[160:163], v[76:79], a[16:19], v[160:163]
    v_mfma_f32_16x16x32_bf16 v[164:167], v[76:79], a[20:23], 0
    v_mfma_f32_16x16x32_bf16 v[164:167], v[72:75], a[4:7], v[164:167]
    v_mfma_f32_16x16x32_bf16 v[168:171], v[72:75], a[8:11], 0
    buffer_load_dwordx4 v[68:71], v251, s[16:19], s44 offen offset:1024
    v_mfma_f32_16x16x32_bf16 v[168:171], v[76:79], a[24:27], v[168:171]
    v_mfma_f32_16x16x32_bf16 v[172:175], v[76:79], a[28:31], 0
    v_mfma_f32_16x16x32_bf16 v[172:175], v[72:75], a[12:15], v[172:175]
    s_waitcnt vmcnt(32)
    v_mfma_f32_16x16x32_bf16 v[160:163], v[80:83], a[32:35], v[160:163]
    buffer_load_dwordx4 v[72:75], v251, s[16:19], s44 offen offset:2048
    v_mfma_f32_16x16x32_bf16 v[160:163], v[84:87], a[48:51], v[160:163]
    ds_read_b128 v[192:195], v180 offset:0
    ds_read_b128 v[196:199], v180 offset:16
    v_mfma_f32_16x16x32_bf16 v[164:167], v[84:87], a[52:55], v[164:167]
    s_nop 0
    s_nop 0
    v_mfma_f32_16x16x32_bf16 v[164:167], v[80:83], a[36:39], v[164:167]
    s_nop 0
    s_nop 0
    v_mfma_f32_16x16x32_bf16 v[168:171], v[80:83], a[40:43], v[168:171]
    buffer_load_dwordx4 v[76:79], v251, s[16:19], s44 offen offset:3072
    v_mfma_f32_16x16x32_bf16 v[168:171], v[84:87], a[56:59], v[168:171]
    s_waitcnt lgkmcnt(0)
    v_fma_f32 v208, v186, v192, v196
    v_mfma_f32_16x16x32_bf16 v[172:175], v[84:87], a[60:63], v[172:175]
    v_fma_f32 v209, v186, v193, v197
    v_fma_f32 v210, v186, v194, v198
    v_mfma_f32_16x16x32_bf16 v[172:175], v[80:83], a[44:47], v[172:175]
    v_fma_f32 v211, v186, v195, v199
    s_waitcnt vmcnt(32)
    v_mfma_f32_16x16x32_bf16 v[160:163], v[88:91], a[64:67], v[160:163]
    buffer_load_dwordx4 v[80:83], v251, s[16:19], s45 offen offset:0
    v_mfma_f32_16x16x32_bf16 v[160:163], v[92:95], a[80:83], v[160:163]
    v_fma_f32 v144, v182, v144, v208
    v_fma_f32 v145, v182, v145, v209
    v_mfma_f32_16x16x32_bf16 v[164:167], v[92:95], a[84:87], v[164:167]
    v_fma_f32 v146, v182, v146, v210
    v_fma_f32 v147, v182, v147, v211
    v_mfma_f32_16x16x32_bf16 v[164:167], v[88:91], a[68:71], v[164:167]
    v_max_f32 v144, 0, v144
    v_max_f32 v145, 0, v145
    v_mfma_f32_16x16x32_bf16 v[168:171], v[88:91], a[72:75], v[168:171]
    buffer_load_dwordx4 v[84:87], v251, s[16:19], s45 offen offset:1024
    v_mfma_f32_16x16x32_bf16 v[168:171], v[92:95], a[88:91], v[168:171]
    v_max_f32 v146, 0, v146
    v_max_f32 v147, 0, v147
    v_mfma_f32_16x16x32_bf16 v[172:175], v[92:95], a[92:95], v[172:175]
    v_mul_f32 v144, v144, v144
    v_mul_f32 v145, v145, v145
    v_mfma_f32_16x16x32_bf16 v[172:175], v[88:91], a[76:79], v[172:175]
    v_mul_f32 v146, v146, v146
    s_waitcnt vmcnt(32)
    v_mfma_f32_16x16x32_bf16 v[160:163], v[96:99], a[96:99], v[160:163]
    buffer_load_dwordx4 v[88:91], v251, s[16:19], s45 offen offset:2048
    v_mfma_f32_16x16x32_bf16 v[160:163], v[100:103], a[112:115], v[160:163]
    v_mul_f32 v147, v147, v147
    v_cvt_pk_bf16_f32 v200, v144, v145
    v_mfma_f32_16x16x32_bf16 v[164:167], v[100:103], a[116:119], v[164:167]
    v_cvt_pk_bf16_f32 v201, v146, v147
    ds_write_b64 v176, v[200:201] offset:0
    v_mfma_f32_16x16x32_bf16 v[164:167], v[96:99], a[100:103], v[164:167]
    v_fma_f32 v208, v187, v192, v196
    v_fma_f32 v209, v187, v193, v197
    v_mfma_f32_16x16x32_bf16 v[168:171], v[96:99], a[104:107], v[168:171]
    buffer_load_dwordx4 v[92:95], v251, s[16:19], s45 offen offset:3072
    v_mfma_f32_16x16x32_bf16 v[168:171], v[100:103], a[120:123], v[168:171]
    v_fma_f32 v210, v187, v194, v198
    v_fma_f32 v211, v187, v195, v199
    v_mfma_f32_16x16x32_bf16 v[172:175], v[100:103], a[124:127], v[172:175]
    v_fma_f32 v148, v183, v148, v208
    v_fma_f32 v149, v183, v149, v209
    v_mfma_f32_16x16x32_bf16 v[172:175], v[96:99], a[108:111], v[172:175]
    v_fma_f32 v150, v183, v150, v210
    s_waitcnt vmcnt(32)
    v_mfma_f32_16x16x32_bf16 v[160:163], v[104:107], a[128:131], v[160:163]
    buffer_load_dwordx4 v[96:99], v251, s[16:19], s46 offen offset:0
    v_mfma_f32_16x16x32_bf16 v[160:163], v[108:111], a[144:147], v[160:163]
    v_fma_f32 v151, v183, v151, v211
    v_max_f32 v148, 0, v148
    v_mfma_f32_16x16x32_bf16 v[164:167], v[108:111], a[148:151], v[164:167]
    v_max_f32 v149, 0, v149
    v_max_f32 v150, 0, v150
    v_mfma_f32_16x16x32_bf16 v[164:167], v[104:107], a[132:135], v[164:167]
    v_max_f32 v151, 0, v151
    v_mul_f32 v148, v148, v148
    v_mfma_f32_16x16x32_bf16 v[168:171], v[104:107], a[136:139], v[168:171]
    buffer_load_dwordx4 v[100:103], v251, s[16:19], s46 offen offset:1024
    v_mfma_f32_16x16x32_bf16 v[168:171], v[108:111], a[152:155], v[168:171]
    v_mul_f32 v149, v149, v149
    v_mul_f32 v150, v150, v150
    v_mfma_f32_16x16x32_bf16 v[172:175], v[108:111], a[156:159], v[172:175]
    v_mul_f32 v151, v151, v151
    v_cvt_pk_bf16_f32 v202, v148, v149
    v_mfma_f32_16x16x32_bf16 v[172:175], v[104:107], a[140:143], v[172:175]
    v_cvt_pk_bf16_f32 v203, v150, v151
    s_waitcnt vmcnt(32)
    v_mfma_f32_16x16x32_bf16 v[160:163], v[112:115], a[160:163], v[160:163]
    buffer_load_dwordx4 v[104:107], v251, s[16:19], s46 offen offset:2048
    v_mfma_f32_16x16x32_bf16 v[160:163], v[116:119], a[176:179], v[160:163]
    ds_write_b64 v177, v[202:203] offset:0
    v_fma_f32 v208, v188, v192, v196
    v_mfma_f32_16x16x32_bf16 v[164:167], v[116:119], a[180:183], v[164:167]
    v_fma_f32 v209, v188, v193, v197
    v_fma_f32 v210, v188, v194, v198
    v_mfma_f32_16x16x32_bf16 v[164:167], v[112:115], a[164:167], v[164:167]
    v_fma_f32 v211, v188, v195, v199
    v_fma_f32 v152, v184, v152, v208
    v_mfma_f32_16x16x32_bf16 v[168:171], v[112:115], a[168:171], v[168:171]
    buffer_load_dwordx4 v[108:111], v251, s[16:19], s46 offen offset:3072
    v_mfma_f32_16x16x32_bf16 v[168:171], v[116:119], a[184:187], v[168:171]
    v_fma_f32 v153, v184, v153, v209
    v_fma_f32 v154, v184, v154, v210
    v_mfma_f32_16x16x32_bf16 v[172:175], v[116:119], a[188:191], v[172:175]
    v_fma_f32 v155, v184, v155, v211
    v_max_f32 v152, 0, v152
    v_mfma_f32_16x16x32_bf16 v[172:175], v[112:115], a[172:175], v[172:175]
    v_max_f32 v153, 0, v153
    s_waitcnt vmcnt(32)
    v_mfma_f32_16x16x32_bf16 v[160:163], v[120:123], a[192:195], v[160:163]
    buffer_load_dwordx4 v[112:115], v251, s[16:19], s47 offen offset:0
    v_mfma_f32_16x16x32_bf16 v[160:163], v[124:127], a[208:211], v[160:163]
    v_max_f32 v154, 0, v154
    v_max_f32 v155, 0, v155
    v_mfma_f32_16x16x32_bf16 v[164:167], v[124:127], a[212:215], v[164:167]
    v_mul_f32 v152, v152, v152
    v_mul_f32 v153, v153, v153
    v_mfma_f32_16x16x32_bf16 v[164:167], v[120:123], a[196:199], v[164:167]
    v_mul_f32 v154, v154, v154
    v_mul_f32 v155, v155, v155
    v_mfma_f32_16x16x32_bf16 v[168:171], v[120:123], a[200:203], v[168:171]
    buffer_load_dwordx4 v[116:119], v251, s[16:19], s47 offen offset:1024
    v_mfma_f32_16x16x32_bf16 v[168:171], v[124:127], a[216:219], v[168:171]
    v_cvt_pk_bf16_f32 v204, v152, v153
    v_cvt_pk_bf16_f32 v205, v154, v155
    v_mfma_f32_16x16x32_bf16 v[172:175], v[124:127], a[220:223], v[172:175]
    ds_write_b64 v178, v[204:205] offset:0
    v_fma_f32 v208, v189, v192, v196
    v_mfma_f32_16x16x32_bf16 v[172:175], v[120:123], a[204:207], v[172:175]
    v_fma_f32 v209, v189, v193, v197
    s_waitcnt vmcnt(32)
    v_mfma_f32_16x16x32_bf16 v[160:163], v[128:131], a[224:227], v[160:163]
    buffer_load_dwordx4 v[120:123], v251, s[16:19], s47 offen offset:2048
    v_mfma_f32_16x16x32_bf16 v[160:163], v[132:135], a[240:243], v[160:163]
    v_fma_f32 v210, v189, v194, v198
    v_fma_f32 v211, v189, v195, v199
    v_mfma_f32_16x16x32_bf16 v[164:167], v[132:135], a[244:247], v[164:167]
    v_fma_f32 v156, v185, v156, v208
    v_fma_f32 v157, v185, v157, v209
    v_mfma_f32_16x16x32_bf16 v[164:167], v[128:131], a[228:231], v[164:167]
    v_fma_f32 v158, v185, v158, v210
    v_fma_f32 v159, v185, v159, v211
    v_mfma_f32_16x16x32_bf16 v[168:171], v[128:131], a[232:235], v[168:171]
    buffer_load_dwordx4 v[124:127], v251, s[16:19], s47 offen offset:3072
    v_mfma_f32_16x16x32_bf16 v[168:171], v[132:135], a[248:251], v[168:171]
    v_max_f32 v156, 0, v156
    v_max_f32 v157, 0, v157
    v_mfma_f32_16x16x32_bf16 v[172:175], v[132:135], a[252:255], v[172:175]
    v_max_f32 v158, 0, v158
    v_max_f32 v159, 0, v159
    v_mfma_f32_16x16x32_bf16 v[172:175], v[128:131], a[236:239], v[172:175]
    v_mul_f32 v156, v156, v156
    s_waitcnt vmcnt(32)
    v_mfma_f32_16x16x32_bf16 v[160:163], v[136:139], v[216:219], v[160:163]
    buffer_load_dwordx4 v[128:131], v251, s[16:19], s48 offen offset:0
    v_mfma_f32_16x16x32_bf16 v[160:163], v[140:143], v[232:235], v[160:163]
    v_mul_f32 v157, v157, v157
    v_mul_f32 v158, v158, v158
    v_mfma_f32_16x16x32_bf16 v[164:167], v[140:143], v[236:239], v[164:167]
    v_mul_f32 v159, v159, v159
    v_cvt_pk_bf16_f32 v206, v156, v157
    v_mfma_f32_16x16x32_bf16 v[164:167], v[136:139], v[220:223], v[164:167]
    v_cvt_pk_bf16_f32 v207, v158, v159
    ds_write_b64 v179, v[206:207] offset:0
    v_mfma_f32_16x16x32_bf16 v[168:171], v[136:139], v[224:227], v[168:171]
    buffer_load_dwordx4 v[132:135], v251, s[16:19], s48 offen offset:1024
    v_mfma_f32_16x16x32_bf16 v[168:171], v[140:143], v[240:243], v[168:171]
    v_mfma_f32_16x16x32_bf16 v[172:175], v[140:143], v[244:247], v[172:175]
    v_mfma_f32_16x16x32_bf16 v[172:175], v[136:139], v[228:231], v[172:175]
    s_waitcnt vmcnt(32)
    v_mfma_f32_16x16x32_bf16 v[144:147], v[0:3], a[0:3], 0
    buffer_load_dwordx4 v[136:139], v251, s[16:19], s48 offen offset:2048
    v_mfma_f32_16x16x32_bf16 v[144:147], v[4:7], a[16:19], v[144:147]
    v_mfma_f32_16x16x32_bf16 v[148:151], v[4:7], a[20:23], 0
    v_mfma_f32_16x16x32_bf16 v[148:151], v[0:3], a[4:7], v[148:151]
    v_mfma_f32_16x16x32_bf16 v[152:155], v[0:3], a[8:11], 0
    buffer_load_dwordx4 v[140:143], v251, s[16:19], s48 offen offset:3072
    s_add_u32 s16, s16, 36864
    s_addc_u32 s17, s17, 0
    v_mfma_f32_16x16x32_bf16 v[152:155], v[4:7], a[24:27], v[152:155]
    v_mfma_f32_16x16x32_bf16 v[156:159], v[4:7], a[28:31], 0
    v_mfma_f32_16x16x32_bf16 v[156:159], v[0:3], a[12:15], v[156:159]
    s_waitcnt vmcnt(32)
    v_mfma_f32_16x16x32_bf16 v[144:147], v[8:11], a[32:35], v[144:147]
    buffer_load_dwordx4 v[0:3], v251, s[16:19], s40 offen offset:0
    v_mfma_f32_16x16x32_bf16 v[144:147], v[12:15], a[48:51], v[144:147]
    ds_read_b128 v[192:195], v180 offset:128
    ds_read_b128 v[196:199], v180 offset:144
    v_mfma_f32_16x16x32_bf16 v[148:151], v[12:15], a[52:55], v[148:151]
    s_nop 0
    s_nop 0
    v_mfma_f32_16x16x32_bf16 v[148:151], v[8:11], a[36:39], v[148:151]
    s_nop 0
    s_nop 0
    v_mfma_f32_16x16x32_bf16 v[152:155], v[8:11], a[40:43], v[152:155]
    buffer_load_dwordx4 v[4:7], v251, s[16:19], s40 offen offset:1024
    v_mfma_f32_16x16x32_bf16 v[152:155], v[12:15], a[56:59], v[152:155]
    s_waitcnt lgkmcnt(0)
    v_fma_f32 v208, v186, v192, v196
    v_mfma_f32_16x16x32_bf16 v[156:159], v[12:15], a[60:63], v[156:159]
    v_fma_f32 v209, v186, v193, v197
    v_fma_f32 v210, v186, v194, v198
    v_mfma_f32_16x16x32_bf16 v[156:159], v[8:11], a[44:47], v[156:159]
    v_fma_f32 v211, v186, v195, v199
    s_waitcnt vmcnt(32)
    v_mfma_f32_16x16x32_bf16 v[144:147], v[16:19], a[64:67], v[144:147]
    buffer_load_dwordx4 v[8:11], v251, s[16:19], s40 offen offset:2048
    v_mfma_f32_16x16x32_bf16 v[144:147], v[20:23], a[80:83], v[144:147]
    v_fma_f32 v160, v182, v160, v208
    v_fma_f32 v161, v182, v161, v209
    v_mfma_f32_16x16x32_bf16 v[148:151], v[20:23], a[84:87], v[148:151]
    v_fma_f32 v162, v182, v162, v210
    v_fma_f32 v163, v182, v163, v211
    v_mfma_f32_16x16x32_bf16 v[148:151], v[16:19], a[68:71], v[148:151]
    v_max_f32 v160, 0, v160
    v_max_f32 v161, 0, v161
    v_mfma_f32_16x16x32_bf16 v[152:155], v[16:19], a[72:75], v[152:155]
    buffer_load_dwordx4 v[12:15], v251, s[16:19], s40 offen offset:3072
    v_mfma_f32_16x16x32_bf16 v[152:155], v[20:23], a[88:91], v[152:155]
    v_max_f32 v162, 0, v162
    v_max_f32 v163, 0, v163
    v_mfma_f32_16x16x32_bf16 v[156:159], v[20:23], a[92:95], v[156:159]
    v_mul_f32 v160, v160, v160
    v_mul_f32 v161, v161, v161
    v_mfma_f32_16x16x32_bf16 v[156:159], v[16:19], a[76:79], v[156:159]
    v_mul_f32 v162, v162, v162
    s_waitcnt vmcnt(32)
    v_mfma_f32_16x16x32_bf16 v[144:147], v[24:27], a[96:99], v[144:147]
    buffer_load_dwordx4 v[16:19], v251, s[16:19], s41 offen offset:0
    v_mfma_f32_16x16x32_bf16 v[144:147], v[28:31], a[112:115], v[144:147]
    v_mul_f32 v163, v163, v163
    v_cvt_pk_bf16_f32 v200, v160, v161
    v_mfma_f32_16x16x32_bf16 v[148:151], v[28:31], a[116:119], v[148:151]
    v_cvt_pk_bf16_f32 v201, v162, v163
    ds_write_b64 v176, v[200:201] offset:8
    v_mfma_f32_16x16x32_bf16 v[148:151], v[24:27], a[100:103], v[148:151]
    v_fma_f32 v208, v187, v192, v196
    v_fma_f32 v209, v187, v193, v197
    v_mfma_f32_16x16x32_bf16 v[152:155], v[24:27], a[104:107], v[152:155]
    buffer_load_dwordx4 v[20:23], v251, s[16:19], s41 offen offset:1024
    v_mfma_f32_16x16x32_bf16 v[152:155], v[28:31], a[120:123], v[152:155]
    v_fma_f32 v210, v187, v194, v198
    v_fma_f32 v211, v187, v195, v199
    v_mfma_f32_16x16x32_bf16 v[156:159], v[28:31], a[124:127], v[156:159]
    v_fma_f32 v164, v183, v164, v208
    v_fma_f32 v165, v183, v165, v209
    v_mfma_f32_16x16x32_bf16 v[156:159], v[24:27], a[108:111], v[156:159]
    v_fma_f32 v166, v183, v166, v210
    s_waitcnt vmcnt(32)
    v_mfma_f32_16x16x32_bf16 v[144:147], v[32:35], a[128:131], v[144:147]
    buffer_load_dwordx4 v[24:27], v251, s[16:19], s41 offen offset:2048
    v_mfma_f32_16x16x32_bf16 v[144:147], v[36:39], a[144:147], v[144:147]
    v_fma_f32 v167, v183, v167, v211
    v_max_f32 v164, 0, v164
    v_mfma_f32_16x16x32_bf16 v[148:151], v[36:39], a[148:151], v[148:151]
    v_max_f32 v165, 0, v165
    v_max_f32 v166, 0, v166
    v_mfma_f32_16x16x32_bf16 v[148:151], v[32:35], a[132:135], v[148:151]
    v_max_f32 v167, 0, v167
    v_mul_f32 v164, v164, v164
    v_mfma_f32_16x16x32_bf16 v[152:155], v[32:35], a[136:139], v[152:155]
    buffer_load_dwordx4 v[28:31], v251, s[16:19], s41 offen offset:3072
    v_mfma_f32_16x16x32_bf16 v[152:155], v[36:39], a[152:155], v[152:155]
    v_mul_f32 v165, v165, v165
    v_mul_f32 v166, v166, v166
    v_mfma_f32_16x16x32_bf16 v[156:159], v[36:39], a[156:159], v[156:159]
    v_mul_f32 v167, v167, v167
    v_cvt_pk_bf16_f32 v202, v164, v165
    v_mfma_f32_16x16x32_bf16 v[156:159], v[32:35], a[140:143], v[156:159]
    v_cvt_pk_bf16_f32 v203, v166, v167
    s_waitcnt vmcnt(32)
    v_mfma_f32_16x16x32_bf16 v[144:147], v[40:43], a[160:163], v[144:147]
    buffer_load_dwordx4 v[32:35], v251, s[16:19], s42 offen offset:0
    v_mfma_f32_16x16x32_bf16 v[144:147], v[44:47], a[176:179], v[144:147]
    ds_write_b64 v177, v[202:203] offset:8
    v_fma_f32 v208, v188, v192, v196
    v_mfma_f32_16x16x32_bf16 v[148:151], v[44:47], a[180:183], v[148:151]
    v_fma_f32 v209, v188, v193, v197
    v_fma_f32 v210, v188, v194, v198
    v_mfma_f32_16x16x32_bf16 v[148:151], v[40:43], a[164:167], v[148:151]
    v_fma_f32 v211, v188, v195, v199
    v_fma_f32 v168, v184, v168, v208
    v_mfma_f32_16x16x32_bf16 v[152:155], v[40:43], a[168:171], v[152:155]
    buffer_load_dwordx4 v[36:39], v251, s[16:19], s42 offen offset:1024
    v_mfma_f32_16x16x32_bf16 v[152:155], v[44:47], a[184:187], v[152:155]
    v_fma_f32 v169, v184, v169, v209
    v_fma_f32 v170, v184, v170, v210
    v_mfma_f32_16x16x32_bf16 v[156:159], v[44:47], a[188:191], v[156:159]
    v_fma_f32 v171, v184, v171, v211
    v_max_f32 v168, 0, v168
    v_mfma_f32_16x16x32_bf16 v[156:159], v[40:43], a[172:175], v[156:159]
    v_max_f32 v169, 0, v169
    s_waitcnt vmcnt(32)
    v_mfma_f32_16x16x32_bf16 v[144:147], v[48:51], a[192:195], v[144:147]
    buffer_load_dwordx4 v[40:43], v251, s[16:19], s42 offen offset:2048
    v_mfma_f32_16x16x32_bf16 v[144:147], v[52:55], a[208:211], v[144:147]
    v_max_f32 v170, 0, v170
    v_max_f32 v171, 0, v171
    v_mfma_f32_16x16x32_bf16 v[148:151], v[52:55], a[212:215], v[148:151]
    v_mul_f32 v168, v168, v168
    v_mul_f32 v169, v169, v169
    v_mfma_f32_16x16x32_bf16 v[148:151], v[48:51], a[196:199], v[148:151]
    v_mul_f32 v170, v170, v170
    v_mul_f32 v171, v171, v171
    v_mfma_f32_16x16x32_bf16 v[152:155], v[48:51], a[200:203], v[152:155]
    buffer_load_dwordx4 v[44:47], v251, s[16:19], s42 offen offset:3072
    v_mfma_f32_16x16x32_bf16 v[152:155], v[52:55], a[216:219], v[152:155]
    v_cvt_pk_bf16_f32 v204, v168, v169
    v_cvt_pk_bf16_f32 v205, v170, v171
    v_mfma_f32_16x16x32_bf16 v[156:159], v[52:55], a[220:223], v[156:159]
    ds_write_b64 v178, v[204:205] offset:8
    v_fma_f32 v208, v189, v192, v196
    v_mfma_f32_16x16x32_bf16 v[156:159], v[48:51], a[204:207], v[156:159]
    v_fma_f32 v209, v189, v193, v197
    s_waitcnt vmcnt(32)
    v_mfma_f32_16x16x32_bf16 v[144:147], v[56:59], a[224:227], v[144:147]
    buffer_load_dwordx4 v[48:51], v251, s[16:19], s43 offen offset:0
    v_mfma_f32_16x16x32_bf16 v[144:147], v[60:63], a[240:243], v[144:147]
    v_fma_f32 v210, v189, v194, v198
    v_fma_f32 v211, v189, v195, v199
    v_mfma_f32_16x16x32_bf16 v[148:151], v[60:63], a[244:247], v[148:151]
    v_fma_f32 v172, v185, v172, v208
    v_fma_f32 v173, v185, v173, v209
    v_mfma_f32_16x16x32_bf16 v[148:151], v[56:59], a[228:231], v[148:151]
    v_fma_f32 v174, v185, v174, v210
    v_fma_f32 v175, v185, v175, v211
    v_mfma_f32_16x16x32_bf16 v[152:155], v[56:59], a[232:235], v[152:155]
    buffer_load_dwordx4 v[52:55], v251, s[16:19], s43 offen offset:1024
    v_mfma_f32_16x16x32_bf16 v[152:155], v[60:63], a[248:251], v[152:155]
    v_max_f32 v172, 0, v172
    v_max_f32 v173, 0, v173
    v_mfma_f32_16x16x32_bf16 v[156:159], v[60:63], a[252:255], v[156:159]
    v_max_f32 v174, 0, v174
    v_max_f32 v175, 0, v175
    v_mfma_f32_16x16x32_bf16 v[156:159], v[56:59], a[236:239], v[156:159]
    v_mul_f32 v172, v172, v172
    s_waitcnt vmcnt(32)
    v_mfma_f32_16x16x32_bf16 v[144:147], v[64:67], v[216:219], v[144:147]
    buffer_load_dwordx4 v[56:59], v251, s[16:19], s43 offen offset:2048
    v_mfma_f32_16x16x32_bf16 v[144:147], v[68:71], v[232:235], v[144:147]
    v_mul_f32 v173, v173, v173
    v_mul_f32 v174, v174, v174
    v_mfma_f32_16x16x32_bf16 v[148:151], v[68:71], v[236:239], v[148:151]
    v_mul_f32 v175, v175, v175
    v_cvt_pk_bf16_f32 v206, v172, v173
    v_mfma_f32_16x16x32_bf16 v[148:151], v[64:67], v[220:223], v[148:151]
    v_cvt_pk_bf16_f32 v207, v174, v175
    ds_write_b64 v179, v[206:207] offset:8
    v_mfma_f32_16x16x32_bf16 v[152:155], v[64:67], v[224:227], v[152:155]
    buffer_load_dwordx4 v[60:63], v251, s[16:19], s43 offen offset:3072
    v_mfma_f32_16x16x32_bf16 v[152:155], v[68:71], v[240:243], v[152:155]
    v_add_u32 v176, 1024, v176
    v_add_u32 v177, 1024, v177
    v_mfma_f32_16x16x32_bf16 v[156:159], v[68:71], v[244:247], v[156:159]
    v_add_u32 v178, 1024, v178
    v_add_u32 v179, 1024, v179
    v_mfma_f32_16x16x32_bf16 v[156:159], v[64:67], v[228:231], v[156:159]
    v_add_u32 v180, 256, v180
    s_waitcnt vmcnt(32)
    s_sub_u32 s31, s31, 1
    s_cmp_lg_u32 s31, 0
    s_cbranch_scc1 L_g1
    v_mfma_f32_16x16x32_bf16 v[160:163], v[72:75], a[0:3], 0
    buffer_load_dwordx4 v[64:67], v251, s[16:19], s44 offen offset:0
    v_mfma_f32_16x16x32_bf16 v[160:163], v[76:79], a[16:19], v[160:163]
    s_lshl_b32 s24, s20, 11
    s_sub_u32 s24, 9216, s24
    v_add_u32 v176, s24, v176
    v_mfma_f32_16x16x32_bf16 v[164:167], v[76:79], a[20:23], 0
    v_add_u32 v177, s24, v177
    v_add_u32 v178, s24, v178
    v_add_u32 v179, s24, v179
    v_mfma_f32_16x16x32_bf16 v[164:167], v[72:75], a[4:7], v[164:167]
    v_mfma_f32_16x16x32_bf16 v[168:171], v[72:75], a[8:11], 0
    buffer_load_dwordx4 v[68:71], v251, s[16:19], s44 offen offset:1024
    v_mfma_f32_16x16x32_bf16 v[168:171], v[76:79], a[24:27], v[168:171]
    v_mfma_f32_16x16x32_bf16 v[172:175], v[76:79], a[28:31], 0
    v_mfma_f32_16x16x32_bf16 v[172:175], v[72:75], a[12:15], v[172:175]
    s_waitcnt vmcnt(32)
    v_mfma_f32_16x16x32_bf16 v[160:163], v[80:83], a[32:35], v[160:163]
    s_add_u32 s16, s64, 0
    s_addc_u32 s17, s65, 0
    buffer_load_dwordx4 v[72:75], v251, s[16:19], s40 offen offset:0
    v_mfma_f32_16x16x32_bf16 v[160:163], v[84:87], a[48:51], v[160:163]
    ds_read_b128 v[192:195], v180 offset:0
    ds_read_b128 v[196:199], v180 offset:16
    s_nop 0
    v_mfma_f32_16x16x32_bf16 v[164:167], v[84:87], a[52:55], v[164:167]
    s_nop 0
    s_nop 0
    s_nop 0
    v_mfma_f32_16x16x32_bf16 v[164:167], v[80:83], a[36:39], v[164:167]
    s_waitcnt lgkmcnt(0)
    v_fma_f32 v208, v186, v192, v196
    v_fma_f32 v209, v186, v193, v197
    v_mfma_f32_16x16x32_bf16 v[168:171], v[80:83], a[40:43], v[168:171]
    buffer_load_dwordx4 v[76:79], v251, s[16:19], s40 offen offset:1024
    v_mfma_f32_16x16x32_bf16 v[168:171], v[84:87], a[56:59], v[168:171]
    v_fma_f32 v210, v186, v194, v198
    v_fma_f32 v211, v186, v195, v199
    v_fma_f32 v144, v182, v144, v208
    v_mfma_f32_16x16x32_bf16 v[172:175], v[84:87], a[60:63], v[172:175]
    v_fma_f32 v145, v182, v145, v209
    v_fma_f32 v146, v182, v146, v210
    v_fma_f32 v147, v182, v147, v211
    v_mfma_f32_16x16x32_bf16 v[172:175], v[80:83], a[44:47], v[172:175]
    v_max_f32 v144, 0, v144
    v_max_f32 v145, 0, v145
    s_waitcnt vmcnt(32)
    v_mfma_f32_16x16x32_bf16 v[160:163], v[88:91], a[64:67], v[160:163]
    buffer_load_dwordx4 v[80:83], v251, s[16:19], s40 offen offset:2048
    v_mfma_f32_16x16x32_bf16 v[160:163], v[92:95], a[80:83], v[160:163]
    v_max_f32 v146, 0, v146
    v_max_f32 v147, 0, v147
    v_mul_f32 v144, v144, v144
    v_mfma_f32_16x16x32_bf16 v[164:167], v[92:95], a[84:87], v[164:167]
    v_mul_f32 v145, v145, v145
    v_mul_f32 v146, v146, v146
    v_mul_f32 v147, v147, v147
    v_mfma_f32_16x16x32_bf16 v[164:167], v[88:91], a[68:71], v[164:167]
    v_cvt_pk_bf16_f32 v200, v144, v145
    v_cvt_pk_bf16_f32 v201, v146, v147
    ds_write_b64 v176, v[200:201] offset:0
    v_mfma_f32_16x16x32_bf16 v[168:171], v[88:91], a[72:75], v[168:171]
    buffer_load_dwordx4 v[84:87], v251, s[16:19], s40 offen offset:3072
    v_mfma_f32_16x16x32_bf16 v[168:171], v[92:95], a[88:91], v[168:171]
    v_fma_f32 v208, v187, v192, v196
    v_fma_f32 v209, v187, v193, v197
    v_fma_f32 v210, v187, v194, v198
    v_mfma_f32_16x16x32_bf16 v[172:175], v[92:95], a[92:95], v[172:175]
    v_fma_f32 v211, v187, v195, v199
    v_fma_f32 v148, v183, v148, v208
    v_fma_f32 v149, v183, v149, v209
    v_mfma_f32_16x16x32_bf16 v[172:175], v[88:91], a[76:79], v[172:175]
    v_fma_f32 v150, v183, v150, v210
    v_fma_f32 v151, v183, v151, v211
    s_waitcnt vmcnt(32)
    v_mfma_f32_16x16x32_bf16 v[160:163], v[96:99], a[96:99], v[160:163]
    buffer_load_dwordx4 v[88:91], v251, s[16:19], s41 offen offset:0
    v_mfma_f32_16x16x32_bf16 v[160:163], v[100:103], a[112:115], v[160:163]
    v_max_f32 v148, 0, v148
    v_max_f32 v149, 0, v149
    v_max_f32 v150, 0, v150
    v_mfma_f32_16x16x32_bf16 v[164:167], v[100:103], a[116:119], v[164:167]
    v_max_f32 v151, 0, v151
    v_mul_f32 v148, v148, v148
    v_mul_f32 v149, v149, v149
    v_mfma_f32_16x16x32_bf16 v[164:167], v[96:99], a[100:103], v[164:167]
    v_mul_f32 v150, v150, v150
    v_mul_f32 v151, v151, v151
    v_cvt_pk_bf16_f32 v202, v148, v149
    v_mfma_f32_16x16x32_bf16 v[168:171], v[96:99], a[104:107], v[168:171]
    buffer_load_dwordx4 v[92:95], v251, s[16:19], s41 offen offset:1024
    v_mfma_f32_16x16x32_bf16 v[168:171], v[100:103], a[120:123], v[168:171]
    v_cvt_pk_bf16_f32 v203, v150, v151
    ds_write_b64 v177, v[202:203] offset:0
    v_fma_f32 v208, v188, v192, v196
    v_mfma_f32_16x16x32_bf16 v[172:175], v[100:103], a[124:127], v[172:175]
    v_fma_f32 v209, v188, v193, v197
    v_fma_f32 v210, v188, v194, v198
    v_fma_f32 v211, v188, v195, v199
    v_mfma_f32_16x16x32_bf16 v[172:175], v[96:99], a[108:111], v[172:175]
    v_fma_f32 v152, v184, v152, v208
    v_fma_f32 v153, v184, v153, v209
    s_waitcnt vmcnt(32)
    v_mfma_f32_16x16x32_bf16 v[160:163], v[104:107], a[128:131], v[160:163]
    buffer_load_dwordx4 v[96:99], v251, s[16:19], s41 offen offset:2048
    v_mfma_f32_16x16x32_bf16 v[160:163], v[108:111], a[144:147], v[160:163]
    v_fma_f32 v154, v184, v154, v210
    v_fma_f32 v155, v184, v155, v211
    v_max_f32 v152, 0, v152
    v_mfma_f32_16x16x32_bf16 v[164:167], v[108:111], a[148:151], v[164:167]
    v_max_f32 v153, 0, v153
    v_max_f32 v154, 0, v154
    v_max_f32 v155, 0, v155
    v_mfma_f32_16x16x32_bf16 v[164:167], v[104:107], a[132:135], v[164:167]
    v_mul_f32 v152, v152, v152
    v_mul_f32 v153, v153, v153
    v_mul_f32 v154, v154, v154
    v_mfma_f32_16x16x32_bf16 v[168:171], v[104:107], a[136:139], v[168:171]
    buffer_load_dwordx4 v[100:103], v251, s[16:19], s41 offen offset:3072
    v_mfma_f32_16x16x32_bf16 v[168:171], v[108:111], a[152:155], v[168:171]
    v_mul_f32 v155, v155, v155
    v_cvt_pk_bf16_f32 v204, v152, v153
    v_cvt_pk_bf16_f32 v205, v154, v155
    v_mfma_f32_16x16x32_bf16 v[172:175], v[108:111], a[156:159], v[172:175]
    ds_write_b64 v178, v[204:205] offset:0
    v_fma_f32 v208, v189, v192, v196
    v_fma_f32 v209, v189, v193, v197
    v_mfma_f32_16x16x32_bf16 v[172:175], v[104:107], a[140:143], v[172:175]
    v_fma_f32 v210, v189, v194, v198
    v_fma_f32 v211, v189, v195, v199
    s_waitcnt vmcnt(32)
    v_mfma_f32_16x16x32_bf16 v[160:163], v[112:115], a[160:163], v[160:163]
    buffer_load_dwordx4 v[104:107], v251, s[16:19], s42 offen offset:0
    v_mfma_f32_16x16x32_bf16 v[160:163], v[116:119], a[176:179], v[160:163]
    v_fma_f32 v156, v185, v156, v208
    v_fma_f32 v157, v185, v157, v209
    v_fma_f32 v158, v185, v158, v210
    v_mfma_f32_16x16x32_bf16 v[164:167], v[116:119], a[180:183], v[164:167]
    v_fma_f32 v159, v185, v159, v211
    v_max_f32 v156, 0, v156
    v_max_f32 v157, 0, v157
    v_mfma_f32_16x16x32_bf16 v[164:167], v[112:115], a[164:167], v[164:167]
    v_max_f32 v158, 0, v158
    v_max_f32 v159, 0, v159
    v_mul_f32 v156, v156, v156
    v_mfma_f32_16x16x32_bf16 v[168:171], v[112:115], a[168:171], v[168:171]
    buffer_load_dwordx4 v[108:111], v251, s[16:19], s42 offen offset:1024
    v_mfma_f32_16x16x32_bf16 v[168:171], v[116:119], a[184:187], v[168:171]
    v_mul_f32 v157, v157, v157
    v_mul_f32 v158, v158, v158
    v_mul_f32 v159, v159, v159
    v_mfma_f32_16x16x32_bf16 v[172:175], v[116:119], a[188:191], v[172:175]
    v_cvt_pk_bf16_f32 v206, v156, v157
    v_cvt_pk_bf16_f32 v207, v158, v159
    ds_write_b64 v179, v[206:207] offset:0
    v_mfma_f32_16x16x32_bf16 v[172:175], v[112:115], a[172:175], v[172:175]
    s_mov_b32 s4, s96
    s_mov_b32 s5, s97
    s_waitcnt vmcnt(32)
    v_mfma_f32_16x16x32_bf16 v[160:163], v[120:123], a[192:195], v[160:163]
    buffer_load_dwordx4 v[112:115], v251, s[16:19], s42 offen offset:2048
    v_mfma_f32_16x16x32_bf16 v[160:163], v[124:127], a[208:211], v[160:163]
    s_mov_b32 s6, 0x240000
    s_mov_b32 s7, 0x20000
    s_mov_b32 s8, s78
    v_mfma_f32_16x16x32_bf16 v[164:167], v[124:127], a[212:215], v[164:167]
    s_mov_b32 s9, s79
    s_mov_b32 s10, 0x480
    s_mov_b32 s11, 0x20000
    v_mfma_f32_16x16x32_bf16 v[164:167], v[120:123], a[196:199], v[164:167]
    s_lshl_b32 s24, s29, 5
    s_add_u32 s24, s24, s28
    s_mul_i32 s24, s24, 73728
    v_mfma_f32_16x16x32_bf16 v[168:171], v[120:123], a[200:203], v[168:171]
    buffer_load_dwordx4 v[116:119], v251, s[16:19], s42 offen offset:3072
    v_mfma_f32_16x16x32_bf16 v[168:171], v[124:127], a[216:219], v[168:171]
    s_mul_i32 s25, s20, 18432
    s_add_u32 s34, s24, s25
    s_add_u32 s34, s34, 20971520
    v_mfma_f32_16x16x32_bf16 v[172:175], v[124:127], a[220:223], v[172:175]
    s_add_u32 s30, s34, 16384
    s_mov_b32 s33, s29
    s_lshl_b32 s35, s28, 10
    v_mfma_f32_16x16x32_bf16 v[172:175], v[120:123], a[204:207], v[172:175]
    s_lshl_b32 s24, s20, 2
    s_add_u32 s35, s35, s24
    s_waitcnt vmcnt(32)
    v_mfma_f32_16x16x32_bf16 v[160:163], v[128:131], a[224:227], v[160:163]
    buffer_load_dwordx4 v[120:123], v251, s[16:19], s43 offen offset:0
    v_mfma_f32_16x16x32_bf16 v[160:163], v[132:135], a[240:243], v[160:163]
    s_add_u32 s35, s35, 49152
    s_lshl_b32 s24, s29, 7
    v_mov_b32 v181, s24
    v_mfma_f32_16x16x32_bf16 v[164:167], v[132:135], a[244:247], v[164:167]
    v_lshlrev_b32 v212, 7, v248
    s_lshl_b32 s57, s28, 10
    s_add_u32 s57, s57, 49168
    v_mfma_f32_16x16x32_bf16 v[164:167], v[128:131], a[228:231], v[164:167]
    v_lshrrev_b32 v214, 1, v250
    v_lshlrev_b32 v214, 8, v214
    v_lshl_add_u32 v214, v249, 4, v214
    v_mfma_f32_16x16x32_bf16 v[168:171], v[128:131], a[232:235], v[168:171]
    buffer_load_dwordx4 v[124:127], v251, s[16:19], s43 offen offset:1024
    v_mfma_f32_16x16x32_bf16 v[168:171], v[132:135], a[248:251], v[168:171]
    v_and_b32 v215, 1, v250
    v_lshl_add_u32 v214, v215, 3, v214
    v_lshlrev_b32 v252, 3, v250
    v_mfma_f32_16x16x32_bf16 v[172:175], v[132:135], a[252:255], v[172:175]
    v_xor_b32 v215, s20, v250
    v_and_b32 v215, 1, v215
    v_lshl_add_u32 v215, v215, 4, v249
    v_mfma_f32_16x16x32_bf16 v[172:175], v[128:131], a[236:239], v[172:175]
    v_mul_u32_u24 v215, 1152, v215
    v_lshrrev_b32 v213, 1, v250
    s_waitcnt vmcnt(32)
    v_mfma_f32_16x16x32_bf16 v[160:163], v[136:139], v[216:219], v[160:163]
    buffer_load_dwordx4 v[128:131], v251, s[16:19], s43 offen offset:2048
    v_mfma_f32_16x16x32_bf16 v[160:163], v[140:143], v[232:235], v[160:163]
    v_lshl_add_u32 v215, v213, 4, v215
    s_lshl_b32 s24, s29, 2
    s_add_u32 s37, s24, s20
    v_mfma_f32_16x16x32_bf16 v[164:167], v[140:143], v[236:239], v[164:167]
    s_add_u32 s38, s20, 32
    s_lshr_b32 s24, s29, 1
    s_cmp_eq_u32 s24, s20
    s_cselect_b32 s39, 1, 0
    v_mfma_f32_16x16x32_bf16 v[164:167], v[136:139], v[220:223], v[164:167]
    s_mul_i32 s32, s28, 73728
    s_mul_i32 s24, s20, 18432
    s_add_u32 s49, s32, s24
    v_mfma_f32_16x16x32_bf16 v[168:171], v[136:139], v[224:227], v[168:171]
    buffer_load_dwordx4 v[132:135], v251, s[16:19], s43 offen offset:3072
    v_mfma_f32_16x16x32_bf16 v[168:171], v[140:143], v[240:243], v[168:171]
    s_add_u32 s49, s49, 20971520
    v_mfma_f32_16x16x32_bf16 v[172:175], v[140:143], v[244:247], v[172:175]
    v_mfma_f32_16x16x32_bf16 v[172:175], v[136:139], v[228:231], v[172:175]
    s_waitcnt vmcnt(32)
    s_waitcnt lgkmcnt(0)
    s_barrier
    v_mfma_f32_16x16x32_bf16 v[144:147], v[0:3], a[0:3], 0
    buffer_load_dwordx4 v[136:139], v251, s[16:19], s44 offen offset:0
    v_mfma_f32_16x16x32_bf16 v[144:147], v[4:7], a[16:19], v[144:147]
    ds_read_b128 v[192:195], v180 offset:128
    ds_read_b128 v[196:199], v180 offset:144
    v_mfma_f32_16x16x32_bf16 v[148:151], v[4:7], a[20:23], 0
    v_mfma_f32_16x16x32_bf16 v[148:151], v[0:3], a[4:7], v[148:151]
    v_mfma_f32_16x16x32_bf16 v[152:155], v[0:3], a[8:11], 0
    buffer_load_dwordx4 v[140:143], v251, s[16:19], s44 offen offset:1024
    v_mfma_f32_16x16x32_bf16 v[152:155], v[4:7], a[24:27], v[152:155]
    v_mfma_f32_16x16x32_bf16 v[156:159], v[4:7], a[28:31], 0
    v_mfma_f32_16x16x32_bf16 v[156:159], v[0:3], a[12:15], v[156:159]
    s_waitcnt vmcnt(32)
    v_mfma_f32_16x16x32_bf16 v[144:147], v[8:11], a[32:35], v[144:147]
    s_mul_i32 s66, s68, 18432
    s_add_u32 s16, s64, s66
    s_addc_u32 s17, s65, 0
    buffer_load_dwordx4 v[0:3], v251, s[16:19], s40 offen offset:0
    v_mfma_f32_16x16x32_bf16 v[144:147], v[12:15], a[48:51], v[144:147]
    ds_read_b128 a[0:3], v190 offset:0
    ds_read_b128 a[4:7], v191 offset:0
    s_waitcnt lgkmcnt(2)
    v_mfma_f32_16x16x32_bf16 v[148:151], v[12:15], a[52:55], v[148:151]
    ds_read_b128 a[8:11], v254 offset:0
    ds_read_b128 a[12:15], v255 offset:0
    v_fma_f32 v208, v186, v192, v196
    v_mfma_f32_16x16x32_bf16 v[148:151], v[8:11], a[36:39], v[148:151]
    v_fma_f32 v209, v186, v193, v197
    v_fma_f32 v210, v186, v194, v198
    v_fma_f32 v211, v186, v195, v199
    v_mfma_f32_16x16x32_bf16 v[152:155], v[8:11], a[40:43], v[152:155]
    buffer_load_dwordx4 v[4:7], v251, s[16:19], s40 offen offset:1024
    v_mfma_f32_16x16x32_bf16 v[152:155], v[12:15], a[56:59], v[152:155]
    ds_read_b128 a[16:19], v190 offset:1024
    ds_read_b128 a[20:23], v191 offset:1024
    v_fma_f32 v160, v182, v160, v208
    v_mfma_f32_16x16x32_bf16 v[156:159], v[12:15], a[60:63], v[156:159]
    ds_read_b128 a[24:27], v254 offset:1024
    ds_read_b128 a[28:31], v255 offset:1024
    v_fma_f32 v161, v182, v161, v209
    v_mfma_f32_16x16x32_bf16 v[156:159], v[8:11], a[44:47], v[156:159]
    v_fma_f32 v162, v182, v162, v210
    v_fma_f32 v163, v182, v163, v211
    s_waitcnt vmcnt(32)
    v_mfma_f32_16x16x32_bf16 v[144:147], v[16:19], a[64:67], v[144:147]
    buffer_load_dwordx4 v[8:11], v251, s[16:19], s40 offen offset:2048
    v_mfma_f32_16x16x32_bf16 v[144:147], v[20:23], a[80:83], v[144:147]
    ds_read_b128 a[32:35], v190 offset:2048
    ds_read_b128 a[36:39], v191 offset:2048
    v_max_f32 v160, 0, v160
    v_mfma_f32_16x16x32_bf16 v[148:151], v[20:23], a[84:87], v[148:151]
    ds_read_b128 a[40:43], v254 offset:2048
    ds_read_b128 a[44:47], v255 offset:2048
    v_max_f32 v161, 0, v161
    v_mfma_f32_16x16x32_bf16 v[148:151], v[16:19], a[68:71], v[148:151]
    v_max_f32 v162, 0, v162
    v_max_f32 v163, 0, v163
    v_mul_f32 v160, v160, v160
    v_mfma_f32_16x16x32_bf16 v[152:155], v[16:19], a[72:75], v[152:155]
    buffer_load_dwordx4 v[12:15], v251, s[16:19], s40 offen offset:3072
    v_mfma_f32_16x16x32_bf16 v[152:155], v[20:23], a[88:91], v[152:155]
    ds_read_b128 a[48:51], v190 offset:3072
    ds_read_b128 a[52:55], v191 offset:3072
    v_mul_f32 v161, v161, v161
    v_mfma_f32_16x16x32_bf16 v[156:159], v[20:23], a[92:95], v[156:159]
    ds_read_b128 a[56:59], v254 offset:3072
    ds_read_b128 a[60:63], v255 offset:3072
    v_mul_f32 v162, v162, v162
    v_mfma_f32_16x16x32_bf16 v[156:159], v[16:19], a[76:79], v[156:159]
    v_mul_f32 v163, v163, v163
    v_cvt_pk_bf16_f32 v200, v160, v161
    s_waitcnt vmcnt(32)
    v_mfma_f32_16x16x32_bf16 v[144:147], v[24:27], a[96:99], v[144:147]
    buffer_load_dwordx4 v[16:19], v251, s[16:19], s41 offen offset:0
    v_mfma_f32_16x16x32_bf16 v[144:147], v[28:31], a[112:115], v[144:147]
    ds_read_b128 a[64:67], v190 offset:4096
    ds_read_b128 a[68:71], v191 offset:4096
    v_cvt_pk_bf16_f32 v201, v162, v163
    v_mfma_f32_16x16x32_bf16 v[148:151], v[28:31], a[116:119], v[148:151]
    ds_read_b128 a[72:75], v254 offset:4096
    ds_read_b128 a[76:79], v255 offset:4096
    ds_write_b64 v176, v[200:201] offset:8
    v_mfma_f32_16x16x32_bf16 v[148:151], v[24:27], a[100:103], v[148:151]
    v_fma_f32 v208, v187, v192, v196
    v_fma_f32 v209, v187, v193, v197
    v_fma_f32 v210, v187, v194, v198
    v_mfma_f32_16x16x32_bf16 v[152:155], v[24:27], a[104:107], v[152:155]
    buffer_load_dwordx4 v[20:23], v251, s[16:19], s41 offen offset:1024
    v_mfma_f32_16x16x32_bf16 v[152:155], v[28:31], a[120:123], v[152:155]
    ds_read_b128 a[80:83], v190 offset:5120
    ds_read_b128 a[84:87], v191 offset:5120
    v_fma_f32 v211, v187, v195, v199
    v_mfma_f32_16x16x32_bf16 v[156:159], v[28:31], a[124:127], v[156:159]
    ds_read_b128 a[88:91], v254 offset:5120
    ds_read_b128 a[92:95], v255 offset:5120
    v_fma_f32 v164, v183, v164, v208
    v_mfma_f32_16x16x32_bf16 v[156:159], v[24:27], a[108:111], v[156:159]
    v_fma_f32 v165, v183, v165, v209
    v_fma_f32 v166, v183, v166, v210
    s_waitcnt vmcnt(32)
    v_mfma_f32_16x16x32_bf16 v[144:147], v[32:35], a[128:131], v[144:147]
    buffer_load_dwordx4 v[24:27], v251, s[16:19], s41 offen offset:2048
    v_mfma_f32_16x16x32_bf16 v[144:147], v[36:39], a[144:147], v[144:147]
    ds_read_b128 a[96:99], v190 offset:6144
    ds_read_b128 a[100:103], v191 offset:6144
    v_fma_f32 v167, v183, v167, v211
    v_mfma_f32_16x16x32_bf16 v[148:151], v[36:39], a[148:151], v[148:151]
    ds_read_b128 a[104:107], v254 offset:6144
    ds_read_b128 a[108:111], v255 offset:6144
    v_max_f32 v164, 0, v164
    v_mfma_f32_16x16x32_bf16 v[148:151], v[32:35], a[132:135], v[148:151]
    v_max_f32 v165, 0, v165
    v_max_f32 v166, 0, v166
    v_max_f32 v167, 0, v167
    v_mfma_f32_16x16x32_bf16 v[152:155], v[32:35], a[136:139], v[152:155]
    buffer_load_dwordx4 v[28:31], v251, s[16:19], s41 offen offset:3072
    v_mfma_f32_16x16x32_bf16 v[152:155], v[36:39], a[152:155], v[152:155]
    ds_read_b128 a[112:115], v190 offset:7168
    ds_read_b128 a[116:119], v191 offset:7168
    v_mul_f32 v164, v164, v164
    v_mfma_f32_16x16x32_bf16 v[156:159], v[36:39], a[156:159], v[156:159]
    ds_read_b128 a[120:123], v254 offset:7168
    ds_read_b128 a[124:127], v255 offset:7168
    v_mul_f32 v165, v165, v165
    v_mfma_f32_16x16x32_bf16 v[156:159], v[32:35], a[140:143], v[156:159]
    v_mul_f32 v166, v166, v166
    v_mul_f32 v167, v167, v167
    s_waitcnt vmcnt(32)
    v_mfma_f32_16x16x32_bf16 v[144:147], v[40:43], a[160:163], v[144:147]
    buffer_load_dwordx4 v[32:35], v251, s[16:19], s42 offen offset:0
    v_mfma_f32_16x16x32_bf16 v[144:147], v[44:47], a[176:179], v[144:147]
    ds_read_b128 a[128:131], v190 offset:8192
    ds_read_b128 a[132:135], v191 offset:8192
    v_cvt_pk_bf16_f32 v202, v164, v165
    v_mfma_f32_16x16x32_bf16 v[148:151], v[44:47], a[180:183], v[148:151]
    ds_read_b128 a[136:139], v254 offset:8192
    ds_read_b128 a[140:143], v255 offset:8192
    v_cvt_pk_bf16_f32 v203, v166, v167
    v_mfma_f32_16x16x32_bf16 v[148:151], v[40:43], a[164:167], v[148:151]
    ds_write_b64 v177, v[202:203] offset:8
    v_fma_f32 v208, v188, v192, v196
    v_fma_f32 v209, v188, v193, v197
    v_mfma_f32_16x16x32_bf16 v[152:155], v[40:43], a[168:171], v[152:155]
    buffer_load_dwordx4 v[36:39], v251, s[16:19], s42 offen offset:1024
    v_mfma_f32_16x16x32_bf16 v[152:155], v[44:47], a[184:187], v[152:155]
    ds_read_b128 a[144:147], v190 offset:9216
    ds_read_b128 a[148:151], v191 offset:9216
    v_fma_f32 v210, v188, v194, v198
    v_mfma_f32_16x16x32_bf16 v[156:159], v[44:47], a[188:191], v[156:159]
    ds_read_b128 a[152:155], v254 offset:9216
    ds_read_b128 a[156:159], v255 offset:9216
    v_fma_f32 v211, v188, v195, v199
    v_mfma_f32_16x16x32_bf16 v[156:159], v[40:43], a[172:175], v[156:159]
    v_fma_f32 v168, v184, v168, v208
    v_fma_f32 v169, v184, v169, v209
    s_waitcnt vmcnt(32)
    v_mfma_f32_16x16x32_bf16 v[144:147], v[48:51], a[192:195], v[144:147]
    buffer_load_dwordx4 v[40:43], v251, s[16:19], s42 offen offset:2048
    v_mfma_f32_16x16x32_bf16 v[144:147], v[52:55], a[208:211], v[144:147]
    ds_read_b128 a[160:163], v190 offset:10240
    ds_read_b128 a[164:167], v191 offset:10240
    v_fma_f32 v170, v184, v170, v210
    v_mfma_f32_16x16x32_bf16 v[148:151], v[52:55], a[212:215], v[148:151]
    ds_read_b128 a[168:171], v254 offset:10240
    ds_read_b128 a[172:175], v255 offset:10240
    v_fma_f32 v171, v184, v171, v211
    v_mfma_f32_16x16x32_bf16 v[148:151], v[48:51], a[196:199], v[148:151]
    v_max_f32 v168, 0, v168
    v_max_f32 v169, 0, v169
    v_max_f32 v170, 0, v170
    v_mfma_f32_16x16x32_bf16 v[152:155], v[48:51], a[200:203], v[152:155]
    buffer_load_dwordx4 v[44:47], v251, s[16:19], s42 offen offset:3072
    v_mfma_f32_16x16x32_bf16 v[152:155], v[52:55], a[216:219], v[152:155]
    ds_read_b128 a[176:179], v190 offset:11264
    ds_read_b128 a[180:183], v191 offset:11264
    v_max_f32 v171, 0, v171
    v_mfma_f32_16x16x32_bf16 v[156:159], v[52:55], a[220:223], v[156:159]
    ds_read_b128 a[184:187], v254 offset:11264
    ds_read_b128 a[188:191], v255 offset:11264
    v_mul_f32 v168, v168, v168
    v_mfma_f32_16x16x32_bf16 v[156:159], v[48:51], a[204:207], v[156:159]
    v_mul_f32 v169, v169, v169
    v_mul_f32 v170, v170, v170
    s_waitcnt vmcnt(32)
    v_mfma_f32_16x16x32_bf16 v[144:147], v[56:59], a[224:227], v[144:147]
    buffer_load_dwordx4 v[48:51], v251, s[16:19], s43 offen offset:0
    v_mfma_f32_16x16x32_bf16 v[144:147], v[60:63], a[240:243], v[144:147]
    v_mul_f32 v171, v171, v171
    v_cvt_pk_bf16_f32 v204, v168, v169
    v_cvt_pk_bf16_f32 v205, v170, v171
    v_mfma_f32_16x16x32_bf16 v[148:151], v[60:63], a[244:247], v[148:151]
    ds_write_b64 v178, v[204:205] offset:8
    v_fma_f32 v208, v189, v192, v196
    v_fma_f32 v209, v189, v193, v197
    v_mfma_f32_16x16x32_bf16 v[148:151], v[56:59], a[228:231], v[148:151]
    v_fma_f32 v210, v189, v194, v198
    v_fma_f32 v211, v189, v195, v199
    v_fma_f32 v172, v185, v172, v208
    v_mfma_f32_16x16x32_bf16 v[152:155], v[56:59], a[232:235], v[152:155]
    buffer_load_dwordx4 v[52:55], v251, s[16:19], s43 offen offset:1024
    v_mfma_f32_16x16x32_bf16 v[152:155], v[60:63], a[248:251], v[152:155]
    v_fma_f32 v173, v185, v173, v209
    v_fma_f32 v174, v185, v174, v210
    v_fma_f32 v175, v185, v175, v211
    v_mfma_f32_16x16x32_bf16 v[156:159], v[60:63], a[252:255], v[156:159]
    v_max_f32 v172, 0, v172
    v_max_f32 v173, 0, v173
    v_max_f32 v174, 0, v174
    v_mfma_f32_16x16x32_bf16 v[156:159], v[56:59], a[236:239], v[156:159]
    v_max_f32 v175, 0, v175
    v_mul_f32 v172, v172, v172
    s_waitcnt vmcnt(32)
    v_mfma_f32_16x16x32_bf16 v[144:147], v[64:67], v[216:219], v[144:147]
    buffer_load_dwordx4 v[56:59], v251, s[16:19], s43 offen offset:2048
    v_mfma_f32_16x16x32_bf16 v[144:147], v[68:71], v[232:235], v[144:147]
    v_mul_f32 v173, v173, v173
    v_mul_f32 v174, v174, v174
    v_mul_f32 v175, v175, v175
    v_mfma_f32_16x16x32_bf16 v[148:151], v[68:71], v[236:239], v[148:151]
    v_cvt_pk_bf16_f32 v206, v172, v173
    v_cvt_pk_bf16_f32 v207, v174, v175
    ds_write_b64 v179, v[206:207] offset:8
    v_mfma_f32_16x16x32_bf16 v[148:151], v[64:67], v[220:223], v[148:151]
    v_mfma_f32_16x16x32_bf16 v[152:155], v[64:67], v[224:227], v[152:155]
    buffer_load_dwordx4 v[60:63], v251, s[16:19], s43 offen offset:3072
    v_mfma_f32_16x16x32_bf16 v[152:155], v[68:71], v[240:243], v[152:155]
    v_mfma_f32_16x16x32_bf16 v[156:159], v[68:71], v[244:247], v[156:159]
    v_mfma_f32_16x16x32_bf16 v[156:159], v[64:67], v[228:231], v[156:159]
    s_waitcnt vmcnt(32)
    s_waitcnt lgkmcnt(0)
    s_barrier
    v_mfma_f32_16x16x32_bf16 v[160:163], v[72:75], a[0:3], 0
    buffer_load_dwordx4 v[64:67], v251, s[16:19], s44 offen offset:0
    v_mfma_f32_16x16x32_bf16 v[160:163], v[76:79], a[16:19], v[160:163]
    ds_read_b128 v[192:195], v180 offset:256
    ds_read_b128 v[196:199], v180 offset:272
    s_lshr_b32 s24, s20, 1
    s_sub_u32 s24, s24, s20
    s_add_u32 s24, s24, 4
    s_lshl_b32 s24, s24, 10
    v_mfma_f32_16x16x32_bf16 v[164:167], v[76:79], a[20:23], 0
    s_and_b32 s25, s20, 1
    s_lshl_b32 s25, s25, 3
    s_add_u32 s24, s24, s25
    v_add_u32 v176, s24, v176
    v_add_u32 v177, s24, v177
    v_add_u32 v178, s24, v178
    v_add_u32 v179, s24, v179
    v_mfma_f32_16x16x32_bf16 v[164:167], v[72:75], a[4:7], v[164:167]
    ds_read_b128 a[192:195], v190 offset:12288
    ds_read_b128 a[196:199], v191 offset:12288
    ds_read_b128 a[200:203], v254 offset:12288
    ds_read_b128 a[204:207], v255 offset:12288
    v_mfma_f32_16x16x32_bf16 v[168:171], v[72:75], a[8:11], 0
    buffer_load_dwordx4 v[68:71], v251, s[16:19], s44 offen offset:1024
    v_mfma_f32_16x16x32_bf16 v[168:171], v[76:79], a[24:27], v[168:171]
    ds_read_b128 a[208:211], v190 offset:13312
    ds_read_b128 a[212:215], v191 offset:13312
    ds_read_b128 a[216:219], v254 offset:13312
    ds_read_b128 a[220:223], v255 offset:13312
    v_mfma_f32_16x16x32_bf16 v[172:175], v[76:79], a[28:31], 0
    ds_read_b128 a[224:227], v190 offset:14336
    ds_read_b128 a[228:231], v191 offset:14336
    v_mfma_f32_16x16x32_bf16 v[172:175], v[72:75], a[12:15], v[172:175]
    s_waitcnt vmcnt(32)
    v_mfma_f32_16x16x32_bf16 v[160:163], v[80:83], a[32:35], v[160:163]
    s_mul_i32 s66, s69, 18432
    s_add_u32 s16, s64, s66
    s_addc_u32 s17, s65, 0
    buffer_load_dwordx4 v[72:75], v251, s[16:19], s40 offen offset:0
    v_mfma_f32_16x16x32_bf16 v[160:163], v[84:87], a[48:51], v[160:163]
    ds_read_b128 a[232:235], v254 offset:14336
    ds_read_b128 a[236:239], v255 offset:14336
    s_waitcnt lgkmcnt(12)
    v_mfma_f32_16x16x32_bf16 v[164:167], v[84:87], a[52:55], v[164:167]
    v_fma_f32 v208, v186, v192, v196
    v_fma_f32 v209, v186, v193, v197
    v_fma_f32 v210, v186, v194, v198
    v_mfma_f32_16x16x32_bf16 v[164:167], v[80:83], a[36:39], v[164:167]
    v_fma_f32 v211, v186, v195, v199
    v_fma_f32 v144, v182, v144, v208
    v_fma_f32 v145, v182, v145, v209
    v_mfma_f32_16x16x32_bf16 v[168:171], v[80:83], a[40:43], v[168:171]
    buffer_load_dwordx4 v[76:79], v251, s[16:19], s40 offen offset:1024
    v_mfma_f32_16x16x32_bf16 v[168:171], v[84:87], a[56:59], v[168:171]
    ds_read_b128 a[240:243], v190 offset:15360
    ds_read_b128 a[244:247], v191 offset:15360
    v_fma_f32 v146, v182, v146, v210
    v_mfma_f32_16x16x32_bf16 v[172:175], v[84:87], a[60:63], v[172:175]
    v_fma_f32 v147, v182, v147, v211
    v_max_f32 v144, 0, v144
    v_max_f32 v145, 0, v145
    v_mfma_f32_16x16x32_bf16 v[172:175], v[80:83], a[44:47], v[172:175]
    v_max_f32 v146, 0, v146
    v_max_f32 v147, 0, v147
    s_waitcnt vmcnt(32)
    v_mfma_f32_16x16x32_bf16 v[160:163], v[88:91], a[64:67], v[160:163]
    buffer_load_dwordx4 v[80:83], v251, s[16:19], s40 offen offset:2048
    v_mfma_f32_16x16x32_bf16 v[160:163], v[92:95], a[80:83], v[160:163]
    ds_read_b128 a[248:251], v254 offset:15360
    ds_read_b128 a[252:255], v255 offset:15360
    v_mul_f32 v144, v144, v144
    v_mfma_f32_16x16x32_bf16 v[164:167], v[92:95], a[84:87], v[164:167]
    v_mul_f32 v145, v145, v145
    v_mul_f32 v146, v146, v146
    v_mul_f32 v147, v147, v147
    v_mfma_f32_16x16x32_bf16 v[164:167], v[88:91], a[68:71], v[164:167]
    v_cvt_pk_bf16_f32 v200, v144, v145
    v_cvt_pk_bf16_f32 v201, v146, v147
    ds_write_b64 v176, v[200:201] offset:0
    v_mfma_f32_16x16x32_bf16 v[168:171], v[88:91], a[72:75], v[168:171]
    buffer_load_dwordx4 v[84:87], v251, s[16:19], s40 offen offset:3072
    v_mfma_f32_16x16x32_bf16 v[168:171], v[92:95], a[88:91], v[168:171]
    v_fma_f32 v208, v187, v192, v196
    v_fma_f32 v209, v187, v193, v197
    v_fma_f32 v210, v187, v194, v198
    v_mfma_f32_16x16x32_bf16 v[172:175], v[92:95], a[92:95], v[172:175]
    v_fma_f32 v211, v187, v195, v199
    v_fma_f32 v148, v183, v148, v208
    v_fma_f32 v149, v183, v149, v209
    v_mfma_f32_16x16x32_bf16 v[172:175], v[88:91], a[76:79], v[172:175]
    v_fma_f32 v150, v183, v150, v210
    v_fma_f32 v151, v183, v151, v211
    s_waitcnt vmcnt(32)
    v_mfma_f32_16x16x32_bf16 v[160:163], v[96:99], a[96:99], v[160:163]
    buffer_load_dwordx4 v[88:91], v251, s[16:19], s41 offen offset:0
    v_mfma_f32_16x16x32_bf16 v[160:163], v[100:103], a[112:115], v[160:163]
    v_max_f32 v148, 0, v148
    v_max_f32 v149, 0, v149
    v_max_f32 v150, 0, v150
    v_mfma_f32_16x16x32_bf16 v[164:167], v[100:103], a[116:119], v[164:167]
    v_max_f32 v151, 0, v151
    v_mul_f32 v148, v148, v148
    v_mul_f32 v149, v149, v149
    v_mfma_f32_16x16x32_bf16 v[164:167], v[96:99], a[100:103], v[164:167]
    v_mul_f32 v150, v150, v150
    v_mul_f32 v151, v151, v151
    v_cvt_pk_bf16_f32 v202, v148, v149
    v_mfma_f32_16x16x32_bf16 v[168:171], v[96:99], a[104:107], v[168:171]
    buffer_load_dwordx4 v[92:95], v251, s[16:19], s41 offen offset:1024
    v_mfma_f32_16x16x32_bf16 v[168:171], v[100:103], a[120:123], v[168:171]
    v_cvt_pk_bf16_f32 v203, v150, v151
    ds_write_b64 v177, v[202:203] offset:0
    v_fma_f32 v208, v188, v192, v196
    v_mfma_f32_16x16x32_bf16 v[172:175], v[100:103], a[124:127], v[172:175]
    v_fma_f32 v209, v188, v193, v197
    v_fma_f32 v210, v188, v194, v198
    v_fma_f32 v211, v188, v195, v199
    v_mfma_f32_16x16x32_bf16 v[172:175], v[96:99], a[108:111], v[172:175]
    v_fma_f32 v152, v184, v152, v208
    v_fma_f32 v153, v184, v153, v209
    s_waitcnt vmcnt(32)
    v_mfma_f32_16x16x32_bf16 v[160:163], v[104:107], a[128:131], v[160:163]
    buffer_load_dwordx4 v[96:99], v251, s[16:19], s41 offen offset:2048
    v_mfma_f32_16x16x32_bf16 v[160:163], v[108:111], a[144:147], v[160:163]
    v_fma_f32 v154, v184, v154, v210
    v_fma_f32 v155, v184, v155, v211
    v_max_f32 v152, 0, v152
    v_mfma_f32_16x16x32_bf16 v[164:167], v[108:111], a[148:151], v[164:167]
    v_max_f32 v153, 0, v153
    v_max_f32 v154, 0, v154
    v_max_f32 v155, 0, v155
    v_mfma_f32_16x16x32_bf16 v[164:167], v[104:107], a[132:135], v[164:167]
    v_mul_f32 v152, v152, v152
    v_mul_f32 v153, v153, v153
    v_mul_f32 v154, v154, v154
    v_mfma_f32_16x16x32_bf16 v[168:171], v[104:107], a[136:139], v[168:171]
    buffer_load_dwordx4 v[100:103], v251, s[16:19], s41 offen offset:3072
    v_mfma_f32_16x16x32_bf16 v[168:171], v[108:111], a[152:155], v[168:171]
    v_mul_f32 v155, v155, v155
    v_cvt_pk_bf16_f32 v204, v152, v153
    v_cvt_pk_bf16_f32 v205, v154, v155
    v_mfma_f32_16x16x32_bf16 v[172:175], v[108:111], a[156:159], v[172:175]
    ds_write_b64 v178, v[204:205] offset:0
    v_fma_f32 v208, v189, v192, v196
    v_fma_f32 v209, v189, v193, v197
    v_mfma_f32_16x16x32_bf16 v[172:175], v[104:107], a[140:143], v[172:175]
    v_fma_f32 v210, v189, v194, v198
    v_fma_f32 v211, v189, v195, v199
    s_waitcnt vmcnt(32)
    v_mfma_f32_16x16x32_bf16 v[160:163], v[112:115], a[160:163], v[160:163]
    buffer_load_dwordx4 v[104:107], v251, s[16:19], s42 offen offset:0
    v_mfma_f32_16x16x32_bf16 v[160:163], v[116:119], a[176:179], v[160:163]
    v_fma_f32 v156, v185, v156, v208
    v_fma_f32 v157, v185, v157, v209
    v_fma_f32 v158, v185, v158, v210
    v_mfma_f32_16x16x32_bf16 v[164:167], v[116:119], a[180:183], v[164:167]
    v_fma_f32 v159, v185, v159, v211
    v_max_f32 v156, 0, v156
    v_max_f32 v157, 0, v157
    v_mfma_f32_16x16x32_bf16 v[164:167], v[112:115], a[164:167], v[164:167]
    v_max_f32 v158, 0, v158
    v_max_f32 v159, 0, v159
    v_mul_f32 v156, v156, v156
    v_mfma_f32_16x16x32_bf16 v[168:171], v[112:115], a[168:171], v[168:171]
    buffer_load_dwordx4 v[108:111], v251, s[16:19], s42 offen offset:1024
    v_mfma_f32_16x16x32_bf16 v[168:171], v[116:119], a[184:187], v[168:171]
    v_mul_f32 v157, v157, v157
    v_mul_f32 v158, v158, v158
    v_mul_f32 v159, v159, v159
    v_mfma_f32_16x16x32_bf16 v[172:175], v[116:119], a[188:191], v[172:175]
    v_cvt_pk_bf16_f32 v206, v156, v157
    v_cvt_pk_bf16_f32 v207, v158, v159
    ds_write_b64 v179, v[206:207] offset:0
    v_mfma_f32_16x16x32_bf16 v[172:175], v[112:115], a[172:175], v[172:175]
    s_waitcnt vmcnt(32)
    s_waitcnt lgkmcnt(4)
    v_mfma_f32_16x16x32_bf16 v[160:163], v[120:123], a[192:195], v[160:163]
    buffer_load_dwordx4 v[112:115], v251, s[16:19], s42 offen offset:2048
    v_mfma_f32_16x16x32_bf16 v[160:163], v[124:127], a[208:211], v[160:163]
    v_mfma_f32_16x16x32_bf16 v[164:167], v[124:127], a[212:215], v[164:167]
    v_mfma_f32_16x16x32_bf16 v[164:167], v[120:123], a[196:199], v[164:167]
    v_mfma_f32_16x16x32_bf16 v[168:171], v[120:123], a[200:203], v[168:171]
    buffer_load_dwordx4 v[116:119], v251, s[16:19], s42 offen offset:3072
    v_mfma_f32_16x16x32_bf16 v[168:171], v[124:127], a[216:219], v[168:171]
    s_waitcnt lgkmcnt(0)
    s_barrier
    ds_read_b128 v[216:219], v190 offset:16384
    ds_read_b128 v[220:223], v191 offset:16384
    ds_read_b128 v[224:227], v254 offset:16384
    ds_read_b128 v[228:231], v255 offset:16384
    v_mfma_f32_16x16x32_bf16 v[172:175], v[124:127], a[220:223], v[172:175]
    ds_read_b128 v[232:235], v190 offset:17408
    ds_read_b128 v[236:239], v191 offset:17408
    ds_read_b128 v[240:243], v254 offset:17408
    ds_read_b128 v[244:247], v255 offset:17408
    v_mfma_f32_16x16x32_bf16 v[172:175], v[120:123], a[204:207], v[172:175]
    s_waitcnt vmcnt(32)
    v_mfma_f32_16x16x32_bf16 v[160:163], v[128:131], a[224:227], v[160:163]
    buffer_load_dwordx4 v[120:123], v251, s[16:19], s43 offen offset:0
    v_mfma_f32_16x16x32_bf16 v[160:163], v[132:135], a[240:243], v[160:163]
    v_mfma_f32_16x16x32_bf16 v[164:167], v[132:135], a[244:247], v[164:167]
    v_mfma_f32_16x16x32_bf16 v[164:167], v[128:131], a[228:231], v[164:167]
    v_mfma_f32_16x16x32_bf16 v[168:171], v[128:131], a[232:235], v[168:171]
    buffer_load_dwordx4 v[124:127], v251, s[16:19], s43 offen offset:1024
    v_mfma_f32_16x16x32_bf16 v[168:171], v[132:135], a[248:251], v[168:171]
    v_mfma_f32_16x16x32_bf16 v[172:175], v[132:135], a[252:255], v[172:175]
    v_mfma_f32_16x16x32_bf16 v[172:175], v[128:131], a[236:239], v[172:175]
    s_waitcnt lgkmcnt(0)
    s_waitcnt vmcnt(32)
    v_mfma_f32_16x16x32_bf16 v[160:163], v[136:139], v[216:219], v[160:163]
    buffer_load_dwordx4 v[128:131], v251, s[16:19], s43 offen offset:2048
    v_mfma_f32_16x16x32_bf16 v[160:163], v[140:143], v[232:235], v[160:163]
    v_mfma_f32_16x16x32_bf16 v[164:167], v[140:143], v[236:239], v[164:167]
    v_mfma_f32_16x16x32_bf16 v[164:167], v[136:139], v[220:223], v[164:167]
    v_mfma_f32_16x16x32_bf16 v[168:171], v[136:139], v[224:227], v[168:171]
    buffer_load_dwordx4 v[132:135], v251, s[16:19], s43 offen offset:3072
    v_mfma_f32_16x16x32_bf16 v[168:171], v[140:143], v[240:243], v[168:171]
    v_mfma_f32_16x16x32_bf16 v[172:175], v[140:143], v[244:247], v[172:175]
    v_mfma_f32_16x16x32_bf16 v[172:175], v[136:139], v[228:231], v[172:175]
    s_waitcnt vmcnt(32)
    v_mfma_f32_16x16x32_bf16 v[144:147], v[0:3], a[0:3], 0
    buffer_load_dwordx4 v[136:139], v251, s[16:19], s44 offen offset:0
    v_mfma_f32_16x16x32_bf16 v[144:147], v[4:7], a[16:19], v[144:147]
    v_mfma_f32_16x16x32_bf16 v[148:151], v[4:7], a[20:23], 0
    v_mfma_f32_16x16x32_bf16 v[148:151], v[0:3], a[4:7], v[148:151]
    v_mfma_f32_16x16x32_bf16 v[152:155], v[0:3], a[8:11], 0
    buffer_load_dwordx4 v[140:143], v251, s[16:19], s44 offen offset:1024
    v_mfma_f32_16x16x32_bf16 v[152:155], v[4:7], a[24:27], v[152:155]
    v_mfma_f32_16x16x32_bf16 v[156:159], v[4:7], a[28:31], 0
    v_mfma_f32_16x16x32_bf16 v[156:159], v[0:3], a[12:15], v[156:159]
    s_waitcnt vmcnt(32)
    v_mfma_f32_16x16x32_bf16 v[144:147], v[8:11], a[32:35], v[144:147]
    s_mul_i32 s66, s70, 18432
    s_add_u32 s16, s64, s66
    s_addc_u32 s17, s65, 0
    buffer_load_dwordx4 v[0:3], v251, s[16:19], s40 offen offset:0
    v_mfma_f32_16x16x32_bf16 v[144:147], v[12:15], a[48:51], v[144:147]
    v_cvt_pk_bf16_f32 v200, v160, v161
    v_cvt_pk_bf16_f32 v201, v162, v163
    v_mfma_f32_16x16x32_bf16 v[148:151], v[12:15], a[52:55], v[148:151]
    v_cvt_pk_bf16_f32 v202, v164, v165
    v_cvt_pk_bf16_f32 v203, v166, v167
    v_mfma_f32_16x16x32_bf16 v[148:151], v[8:11], a[36:39], v[148:151]
    v_cvt_pk_bf16_f32 v204, v168, v169
    v_cvt_pk_bf16_f32 v205, v170, v171
    v_mfma_f32_16x16x32_bf16 v[152:155], v[8:11], a[40:43], v[152:155]
    buffer_load_dwordx4 v[4:7], v251, s[16:19], s40 offen offset:1024
    v_mfma_f32_16x16x32_bf16 v[152:155], v[12:15], a[56:59], v[152:155]
    v_cvt_pk_bf16_f32 v206, v172, v173
    v_cvt_pk_bf16_f32 v207, v174, v175
    v_mfma_f32_16x16x32_bf16 v[156:159], v[12:15], a[60:63], v[156:159]
    v_mfma_f32_16x16x32_bf16 v[156:159], v[8:11], a[44:47], v[156:159]
    s_waitcnt vmcnt(32)
    v_mfma_f32_16x16x32_bf16 v[144:147], v[16:19], a[64:67], v[144:147]
    buffer_load_dwordx4 v[8:11], v251, s[16:19], s40 offen offset:2048
    v_mfma_f32_16x16x32_bf16 v[144:147], v[20:23], a[80:83], v[144:147]
    v_mfma_f32_16x16x32_bf16 v[148:151], v[20:23], a[84:87], v[148:151]
    v_mfma_f32_16x16x32_bf16 v[148:151], v[16:19], a[68:71], v[148:151]
    v_mfma_f32_16x16x32_bf16 v[152:155], v[16:19], a[72:75], v[152:155]
    v_mfma_f32_16x16x32_bf16 v[152:155], v[20:23], a[88:91], v[152:155]
    v_mfma_f32_16x16x32_bf16 v[156:159], v[20:23], a[92:95], v[156:159]
    buffer_store_dwordx4 v[200:203], v251, s[12:15], s30 offen sc1
    v_mfma_f32_16x16x32_bf16 v[156:159], v[16:19], a[76:79], v[156:159]
    s_waitcnt vmcnt(32)
    v_mfma_f32_16x16x32_bf16 v[144:147], v[24:27], a[96:99], v[144:147]
    buffer_load_dwordx4 v[12:15], v251, s[16:19], s40 offen offset:3072
    v_mfma_f32_16x16x32_bf16 v[144:147], v[28:31], a[112:115], v[144:147]
    v_mfma_f32_16x16x32_bf16 v[148:151], v[28:31], a[116:119], v[148:151]
    v_mfma_f32_16x16x32_bf16 v[148:151], v[24:27], a[100:103], v[148:151]
    v_mfma_f32_16x16x32_bf16 v[152:155], v[24:27], a[104:107], v[152:155]
    buffer_load_dwordx4 v[16:19], v251, s[16:19], s41 offen offset:0
    v_mfma_f32_16x16x32_bf16 v[152:155], v[28:31], a[120:123], v[152:155]
    v_mfma_f32_16x16x32_bf16 v[156:159], v[28:31], a[124:127], v[156:159]
    v_mfma_f32_16x16x32_bf16 v[156:159], v[24:27], a[108:111], v[156:159]
    s_waitcnt vmcnt(32)
    v_mfma_f32_16x16x32_bf16 v[144:147], v[32:35], a[128:131], v[144:147]
    buffer_load_dwordx4 v[20:23], v251, s[16:19], s41 offen offset:1024
    v_mfma_f32_16x16x32_bf16 v[144:147], v[36:39], a[144:147], v[144:147]
    v_mfma_f32_16x16x32_bf16 v[148:151], v[36:39], a[148:151], v[148:151]
    v_mfma_f32_16x16x32_bf16 v[148:151], v[32:35], a[132:135], v[148:151]
    v_mfma_f32_16x16x32_bf16 v[152:155], v[32:35], a[136:139], v[152:155]
    buffer_load_dwordx4 v[24:27], v251, s[16:19], s41 offen offset:2048
    v_mfma_f32_16x16x32_bf16 v[152:155], v[36:39], a[152:155], v[152:155]
    v_mfma_f32_16x16x32_bf16 v[156:159], v[36:39], a[156:159], v[156:159]
    v_mfma_f32_16x16x32_bf16 v[156:159], v[32:35], a[140:143], v[156:159]
    s_waitcnt vmcnt(32)
    v_mfma_f32_16x16x32_bf16 v[144:147], v[40:43], a[160:163], v[144:147]
    buffer_load_dwordx4 v[28:31], v251, s[16:19], s41 offen offset:3072
    v_mfma_f32_16x16x32_bf16 v[144:147], v[44:47], a[176:179], v[144:147]
    v_mfma_f32_16x16x32_bf16 v[148:151], v[44:47], a[180:183], v[148:151]
    v_mfma_f32_16x16x32_bf16 v[148:151], v[40:43], a[164:167], v[148:151]
    v_mfma_f32_16x16x32_bf16 v[152:155], v[40:43], a[168:171], v[152:155]
    v_mfma_f32_16x16x32_bf16 v[152:155], v[44:47], a[184:187], v[152:155]
    v_mfma_f32_16x16x32_bf16 v[156:159], v[44:47], a[188:191], v[156:159]
    buffer_store_dwordx4 v[204:207], v251, s[12:15], s30 offen offset:1024 sc1
    v_mfma_f32_16x16x32_bf16 v[156:159], v[40:43], a[172:175], v[156:159]
    s_waitcnt vmcnt(32)
    v_mfma_f32_16x16x32_bf16 v[144:147], v[48:51], a[192:195], v[144:147]
    buffer_load_dwordx4 v[32:35], v251, s[16:19], s42 offen offset:0
    v_mfma_f32_16x16x32_bf16 v[144:147], v[52:55], a[208:211], v[144:147]
    v_mfma_f32_16x16x32_bf16 v[148:151], v[52:55], a[212:215], v[148:151]
    v_mfma_f32_16x16x32_bf16 v[148:151], v[48:51], a[196:199], v[148:151]
    v_mfma_f32_16x16x32_bf16 v[152:155], v[48:51], a[200:203], v[152:155]
    buffer_load_dwordx4 v[36:39], v251, s[16:19], s42 offen offset:1024
    v_mfma_f32_16x16x32_bf16 v[152:155], v[52:55], a[216:219], v[152:155]
    v_mfma_f32_16x16x32_bf16 v[156:159], v[52:55], a[220:223], v[156:159]
    v_mfma_f32_16x16x32_bf16 v[156:159], v[48:51], a[204:207], v[156:159]
    s_waitcnt vmcnt(32)
    v_mfma_f32_16x16x32_bf16 v[144:147], v[56:59], a[224:227], v[144:147]
    buffer_load_dwordx4 v[40:43], v251, s[16:19], s42 offen offset:2048
    v_mfma_f32_16x16x32_bf16 v[144:147], v[60:63], a[240:243], v[144:147]
    v_mfma_f32_16x16x32_bf16 v[148:151], v[60:63], a[244:247], v[148:151]
    v_mfma_f32_16x16x32_bf16 v[148:151], v[56:59], a[228:231], v[148:151]
    v_mfma_f32_16x16x32_bf16 v[152:155], v[56:59], a[232:235], v[152:155]
    buffer_load_dwordx4 v[44:47], v251, s[16:19], s42 offen offset:3072
    v_mfma_f32_16x16x32_bf16 v[152:155], v[60:63], a[248:251], v[152:155]
    v_mfma_f32_16x16x32_bf16 v[156:159], v[60:63], a[252:255], v[156:159]
    v_mfma_f32_16x16x32_bf16 v[156:159], v[56:59], a[236:239], v[156:159]
    s_waitcnt vmcnt(32)
    v_mfma_f32_16x16x32_bf16 v[144:147], v[64:67], v[216:219], v[144:147]
    buffer_load_dwordx4 v[48:51], v251, s[16:19], s43 offen offset:0
    v_mfma_f32_16x16x32_bf16 v[144:147], v[68:71], v[232:235], v[144:147]
    v_mfma_f32_16x16x32_bf16 v[148:151], v[68:71], v[236:239], v[148:151]
    v_mfma_f32_16x16x32_bf16 v[148:151], v[64:67], v[220:223], v[148:151]
    v_mfma_f32_16x16x32_bf16 v[152:155], v[64:67], v[224:227], v[152:155]
    v_mfma_f32_16x16x32_bf16 v[152:155], v[68:71], v[240:243], v[152:155]
    v_mfma_f32_16x16x32_bf16 v[156:159], v[68:71], v[244:247], v[156:159]
    v_mfma_f32_16x16x32_bf16 v[156:159], v[64:67], v[228:231], v[156:159]
    s_waitcnt vmcnt(31)
    s_add_u32 s33, s29, s68
    s_and_b32 s33, s33, 7
    s_lshl_b32 s30, s33, 11
    s_add_u32 s30, s30, s34
    v_mfma_f32_16x16x32_bf16 v[160:163], v[72:75], a[0:3], 0
    buffer_load_dwordx4 v[52:55], v251, s[16:19], s43 offen offset:1024
    v_mfma_f32_16x16x32_bf16 v[160:163], v[76:79], a[16:19], v[160:163]
    v_mfma_f32_16x16x32_bf16 v[164:167], v[76:79], a[20:23], 0
    v_mfma_f32_16x16x32_bf16 v[164:167], v[72:75], a[4:7], v[164:167]
    v_mfma_f32_16x16x32_bf16 v[168:171], v[72:75], a[8:11], 0
    buffer_load_dwordx4 v[56:59], v251, s[16:19], s43 offen offset:2048
    v_mfma_f32_16x16x32_bf16 v[168:171], v[76:79], a[24:27], v[168:171]
    v_mfma_f32_16x16x32_bf16 v[172:175], v[76:79], a[28:31], 0
    v_mfma_f32_16x16x32_bf16 v[172:175], v[72:75], a[12:15], v[172:175]
    s_waitcnt vmcnt(31)
    v_mfma_f32_16x16x32_bf16 v[160:163], v[80:83], a[32:35], v[160:163]
    buffer_load_dwordx4 v[60:63], v251, s[16:19], s43 offen offset:3072
    v_mfma_f32_16x16x32_bf16 v[160:163], v[84:87], a[48:51], v[160:163]
    v_cvt_pk_bf16_f32 v200, v144, v145
    v_cvt_pk_bf16_f32 v201, v146, v147
    v_mfma_f32_16x16x32_bf16 v[164:167], v[84:87], a[52:55], v[164:167]
    v_cvt_pk_bf16_f32 v202, v148, v149
    v_cvt_pk_bf16_f32 v203, v150, v151
    v_mfma_f32_16x16x32_bf16 v[164:167], v[80:83], a[36:39], v[164:167]
    v_cvt_pk_bf16_f32 v204, v152, v153
    v_cvt_pk_bf16_f32 v205, v154, v155
    v_mfma_f32_16x16x32_bf16 v[168:171], v[80:83], a[40:43], v[168:171]
    buffer_load_dwordx4 v[64:67], v251, s[16:19], s44 offen offset:0
    v_mfma_f32_16x16x32_bf16 v[168:171], v[84:87], a[56:59], v[168:171]
    v_cvt_pk_bf16_f32 v206, v156, v157
    v_cvt_pk_bf16_f32 v207, v158, v159
    v_mfma_f32_16x16x32_bf16 v[172:175], v[84:87], a[60:63], v[172:175]
    v_mfma_f32_16x16x32_bf16 v[172:175], v[80:83], a[44:47], v[172:175]
    s_waitcnt vmcnt(31)
    v_mfma_f32_16x16x32_bf16 v[160:163], v[88:91], a[64:67], v[160:163]
    buffer_load_dwordx4 v[68:71], v251, s[16:19], s44 offen offset:1024
    v_mfma_f32_16x16x32_bf16 v[160:163], v[92:95], a[80:83], v[160:163]
    v_mfma_f32_16x16x32_bf16 v[164:167], v[92:95], a[84:87], v[164:167]
    v_mfma_f32_16x16x32_bf16 v[164:167], v[88:91], a[68:71], v[164:167]
    v_mfma_f32_16x16x32_bf16 v[168:171], v[88:91], a[72:75], v[168:171]
    v_mfma_f32_16x16x32_bf16 v[168:171], v[92:95], a[88:91], v[168:171]
    v_mfma_f32_16x16x32_bf16 v[172:175], v[92:95], a[92:95], v[172:175]
    buffer_store_dwordx4 v[200:203], v251, s[12:15], s30 offen sc1
    v_mfma_f32_16x16x32_bf16 v[172:175], v[88:91], a[76:79], v[172:175]
    s_waitcnt vmcnt(31)
    v_mfma_f32_16x16x32_bf16 v[160:163], v[96:99], a[96:99], v[160:163]
    s_mul_i32 s66, s71, 18432
    s_add_u32 s16, s64, s66
    s_addc_u32 s17, s65, 0
    buffer_load_dwordx4 v[72:75], v251, s[16:19], s40 offen offset:0
    v_mfma_f32_16x16x32_bf16 v[160:163], v[100:103], a[112:115], v[160:163]
    v_mfma_f32_16x16x32_bf16 v[164:167], v[100:103], a[116:119], v[164:167]
    v_mfma_f32_16x16x32_bf16 v[164:167], v[96:99], a[100:103], v[164:167]
    v_mfma_f32_16x16x32_bf16 v[168:171], v[96:99], a[104:107], v[168:171]
    buffer_load_dwordx4 v[76:79], v251, s[16:19], s40 offen offset:1024
    v_mfma_f32_16x16x32_bf16 v[168:171], v[100:103], a[120:123], v[168:171]
    v_mfma_f32_16x16x32_bf16 v[172:175], v[100:103], a[124:127], v[172:175]
    v_mfma_f32_16x16x32_bf16 v[172:175], v[96:99], a[108:111], v[172:175]
    s_waitcnt vmcnt(31)
    v_mfma_f32_16x16x32_bf16 v[160:163], v[104:107], a[128:131], v[160:163]
    buffer_load_dwordx4 v[80:83], v251, s[16:19], s40 offen offset:2048
    v_mfma_f32_16x16x32_bf16 v[160:163], v[108:111], a[144:147], v[160:163]
    v_mfma_f32_16x16x32_bf16 v[164:167], v[108:111], a[148:151], v[164:167]
    v_mfma_f32_16x16x32_bf16 v[164:167], v[104:107], a[132:135], v[164:167]
    v_mfma_f32_16x16x32_bf16 v[168:171], v[104:107], a[136:139], v[168:171]
    buffer_load_dwordx4 v[84:87], v251, s[16:19], s40 offen offset:3072
    v_mfma_f32_16x16x32_bf16 v[168:171], v[108:111], a[152:155], v[168:171]
    v_mfma_f32_16x16x32_bf16 v[172:175], v[108:111], a[156:159], v[172:175]
    v_mfma_f32_16x16x32_bf16 v[172:175], v[104:107], a[140:143], v[172:175]
    s_waitcnt vmcnt(31)
    v_mfma_f32_16x16x32_bf16 v[160:163], v[112:115], a[160:163], v[160:163]
    buffer_load_dwordx4 v[88:91], v251, s[16:19], s41 offen offset:0
    v_mfma_f32_16x16x32_bf16 v[160:163], v[116:119], a[176:179], v[160:163]
    v_mfma_f32_16x16x32_bf16 v[164:167], v[116:119], a[180:183], v[164:167]
    v_mfma_f32_16x16x32_bf16 v[164:167], v[112:115], a[164:167], v[164:167]
    v_mfma_f32_16x16x32_bf16 v[168:171], v[112:115], a[168:171], v[168:171]
    v_mfma_f32_16x16x32_bf16 v[168:171], v[116:119], a[184:187], v[168:171]
    v_mfma_f32_16x16x32_bf16 v[172:175], v[116:119], a[188:191], v[172:175]
    buffer_store_dwordx4 v[204:207], v251, s[12:15], s30 offen offset:1024 sc1
    v_mfma_f32_16x16x32_bf16 v[172:175], v[112:115], a[172:175], v[172:175]
    s_waitcnt vmcnt(31)
    v_mfma_f32_16x16x32_bf16 v[160:163], v[120:123], a[192:195], v[160:163]
    buffer_load_dwordx4 v[92:95], v251, s[16:19], s41 offen offset:1024
    v_mfma_f32_16x16x32_bf16 v[160:163], v[124:127], a[208:211], v[160:163]
    v_mfma_f32_16x16x32_bf16 v[164:167], v[124:127], a[212:215], v[164:167]
    v_mfma_f32_16x16x32_bf16 v[164:167], v[120:123], a[196:199], v[164:167]
    v_mfma_f32_16x16x32_bf16 v[168:171], v[120:123], a[200:203], v[168:171]
    buffer_load_dwordx4 v[96:99], v251, s[16:19], s41 offen offset:2048
    v_mfma_f32_16x16x32_bf16 v[168:171], v[124:127], a[216:219], v[168:171]
    v_mfma_f32_16x16x32_bf16 v[172:175], v[124:127], a[220:223], v[172:175]
    v_mfma_f32_16x16x32_bf16 v[172:175], v[120:123], a[204:207], v[172:175]
    s_waitcnt vmcnt(31)
    v_mfma_f32_16x16x32_bf16 v[160:163], v[128:131], a[224:227], v[160:163]
    buffer_load_dwordx4 v[100:103], v251, s[16:19], s41 offen offset:3072
    v_mfma_f32_16x16x32_bf16 v[160:163], v[132:135], a[240:243], v[160:163]
    v_mfma_f32_16x16x32_bf16 v[164:167], v[132:135], a[244:247], v[164:167]
    v_mfma_f32_16x16x32_bf16 v[164:167], v[128:131], a[228:231], v[164:167]
    v_mfma_f32_16x16x32_bf16 v[168:171], v[128:131], a[232:235], v[168:171]
    buffer_load_dwordx4 v[104:107], v251, s[16:19], s42 offen offset:0
    v_mfma_f32_16x16x32_bf16 v[168:171], v[132:135], a[248:251], v[168:171]
    v_mfma_f32_16x16x32_bf16 v[172:175], v[132:135], a[252:255], v[172:175]
    v_mfma_f32_16x16x32_bf16 v[172:175], v[128:131], a[236:239], v[172:175]
    s_waitcnt vmcnt(31)
    v_mfma_f32_16x16x32_bf16 v[160:163], v[136:139], v[216:219], v[160:163]
    buffer_load_dwordx4 v[108:111], v251, s[16:19], s42 offen offset:1024
    v_mfma_f32_16x16x32_bf16 v[160:163], v[140:143], v[232:235], v[160:163]
    v_mfma_f32_16x16x32_bf16 v[164:167], v[140:143], v[236:239], v[164:167]
    v_mfma_f32_16x16x32_bf16 v[164:167], v[136:139], v[220:223], v[164:167]
    v_mfma_f32_16x16x32_bf16 v[168:171], v[136:139], v[224:227], v[168:171]
    v_mfma_f32_16x16x32_bf16 v[168:171], v[140:143], v[240:243], v[168:171]
    v_mfma_f32_16x16x32_bf16 v[172:175], v[140:143], v[244:247], v[172:175]
    v_mfma_f32_16x16x32_bf16 v[172:175], v[136:139], v[228:231], v[172:175]
    s_waitcnt vmcnt(30)
    s_add_u32 s33, s29, s69
    s_and_b32 s33, s33, 7
    s_lshl_b32 s30, s33, 11
    s_add_u32 s30, s30, s34
    v_mfma_f32_16x16x32_bf16 v[144:147], v[0:3], a[0:3], 0
    buffer_load_dwordx4 v[112:115], v251, s[16:19], s42 offen offset:2048
    v_mfma_f32_16x16x32_bf16 v[144:147], v[4:7], a[16:19], v[144:147]
    v_mfma_f32_16x16x32_bf16 v[148:151], v[4:7], a[20:23], 0
    v_mfma_f32_16x16x32_bf16 v[148:151], v[0:3], a[4:7], v[148:151]
    v_mfma_f32_16x16x32_bf16 v[152:155], v[0:3], a[8:11], 0
    buffer_load_dwordx4 v[116:119], v251, s[16:19], s42 offen offset:3072
    v_mfma_f32_16x16x32_bf16 v[152:155], v[4:7], a[24:27], v[152:155]
    v_mfma_f32_16x16x32_bf16 v[156:159], v[4:7], a[28:31], 0
    v_mfma_f32_16x16x32_bf16 v[156:159], v[0:3], a[12:15], v[156:159]
    s_waitcnt vmcnt(29)
    v_mfma_f32_16x16x32_bf16 v[144:147], v[8:11], a[32:35], v[144:147]
    buffer_load_dwordx4 v[120:123], v251, s[16:19], s43 offen offset:0
    v_mfma_f32_16x16x32_bf16 v[144:147], v[12:15], a[48:51], v[144:147]
    v_cvt_pk_bf16_f32 v200, v160, v161
    v_cvt_pk_bf16_f32 v201, v162, v163
    v_mfma_f32_16x16x32_bf16 v[148:151], v[12:15], a[52:55], v[148:151]
    v_cvt_pk_bf16_f32 v202, v164, v165
    v_cvt_pk_bf16_f32 v203, v166, v167
    v_mfma_f32_16x16x32_bf16 v[148:151], v[8:11], a[36:39], v[148:151]
    v_cvt_pk_bf16_f32 v204, v168, v169
    v_cvt_pk_bf16_f32 v205, v170, v171
    v_mfma_f32_16x16x32_bf16 v[152:155], v[8:11], a[40:43], v[152:155]
    buffer_load_dwordx4 v[124:127], v251, s[16:19], s43 offen offset:1024
    v_mfma_f32_16x16x32_bf16 v[152:155], v[12:15], a[56:59], v[152:155]
    v_cvt_pk_bf16_f32 v206, v172, v173
    v_cvt_pk_bf16_f32 v207, v174, v175
    v_mfma_f32_16x16x32_bf16 v[156:159], v[12:15], a[60:63], v[156:159]
    v_mfma_f32_16x16x32_bf16 v[156:159], v[8:11], a[44:47], v[156:159]
    s_waitcnt vmcnt(29)
    v_mfma_f32_16x16x32_bf16 v[144:147], v[16:19], a[64:67], v[144:147]
    buffer_load_dwordx4 v[128:131], v251, s[16:19], s43 offen offset:2048
    v_mfma_f32_16x16x32_bf16 v[144:147], v[20:23], a[80:83], v[144:147]
    v_mfma_f32_16x16x32_bf16 v[148:151], v[20:23], a[84:87], v[148:151]
    v_mfma_f32_16x16x32_bf16 v[148:151], v[16:19], a[68:71], v[148:151]
    v_mfma_f32_16x16x32_bf16 v[152:155], v[16:19], a[72:75], v[152:155]
    v_mfma_f32_16x16x32_bf16 v[152:155], v[20:23], a[88:91], v[152:155]
    v_mfma_f32_16x16x32_bf16 v[156:159], v[20:23], a[92:95], v[156:159]
    buffer_store_dwordx4 v[200:203], v251, s[12:15], s30 offen sc1
    v_mfma_f32_16x16x32_bf16 v[156:159], v[16:19], a[76:79], v[156:159]
    s_waitcnt vmcnt(29)
    v_mfma_f32_16x16x32_bf16 v[144:147], v[24:27], a[96:99], v[144:147]
    buffer_load_dwordx4 v[132:135], v251, s[16:19], s43 offen offset:3072
    v_mfma_f32_16x16x32_bf16 v[144:147], v[28:31], a[112:115], v[144:147]
    v_mfma_f32_16x16x32_bf16 v[148:151], v[28:31], a[116:119], v[148:151]
    v_mfma_f32_16x16x32_bf16 v[148:151], v[24:27], a[100:103], v[148:151]
    v_mfma_f32_16x16x32_bf16 v[152:155], v[24:27], a[104:107], v[152:155]
    buffer_load_dwordx4 v[136:139], v251, s[16:19], s44 offen offset:0
    v_mfma_f32_16x16x32_bf16 v[152:155], v[28:31], a[120:123], v[152:155]
    v_mfma_f32_16x16x32_bf16 v[156:159], v[28:31], a[124:127], v[156:159]
    v_mfma_f32_16x16x32_bf16 v[156:159], v[24:27], a[108:111], v[156:159]
    s_waitcnt vmcnt(28)
    v_mfma_f32_16x16x32_bf16 v[144:147], v[32:35], a[128:131], v[144:147]
    buffer_load_dwordx4 v[140:143], v251, s[16:19], s44 offen offset:1024
    v_mfma_f32_16x16x32_bf16 v[144:147], v[36:39], a[144:147], v[144:147]
    v_mfma_f32_16x16x32_bf16 v[148:151], v[36:39], a[148:151], v[148:151]
    v_mfma_f32_16x16x32_bf16 v[148:151], v[32:35], a[132:135], v[148:151]
    v_mfma_f32_16x16x32_bf16 v[152:155], v[32:35], a[136:139], v[152:155]
    s_mul_i32 s66, s72, 18432
    s_add_u32 s16, s64, s66
    s_addc_u32 s17, s65, 0
    buffer_load_dwordx4 v[0:3], v251, s[16:19], s40 offen offset:0
    v_mfma_f32_16x16x32_bf16 v[152:155], v[36:39], a[152:155], v[152:155]
    v_mfma_f32_16x16x32_bf16 v[156:159], v[36:39], a[156:159], v[156:159]
    v_mfma_f32_16x16x32_bf16 v[156:159], v[32:35], a[140:143], v[156:159]
    s_waitcnt vmcnt(28)
    v_mfma_f32_16x16x32_bf16 v[144:147], v[40:43], a[160:163], v[144:147]
    buffer_load_dwordx4 v[4:7], v251, s[16:19], s40 offen offset:1024
    v_mfma_f32_16x16x32_bf16 v[144:147], v[44:47], a[176:179], v[144:147]
    v_mfma_f32_16x16x32_bf16 v[148:151], v[44:47], a[180:183], v[148:151]
    v_mfma_f32_16x16x32_bf16 v[148:151], v[40:43], a[164:167], v[148:151]
    v_mfma_f32_16x16x32_bf16 v[152:155], v[40:43], a[168:171], v[152:155]
    v_mfma_f32_16x16x32_bf16 v[152:155], v[44:47], a[184:187], v[152:155]
    v_mfma_f32_16x16x32_bf16 v[156:159], v[44:47], a[188:191], v[156:159]
    buffer_store_dwordx4 v[204:207], v251, s[12:15], s30 offen offset:1024 sc1
    v_mfma_f32_16x16x32_bf16 v[156:159], v[40:43], a[172:175], v[156:159]
    s_waitcnt vmcnt(28)
    v_mfma_f32_16x16x32_bf16 v[144:147], v[48:51], a[192:195], v[144:147]
    buffer_load_dwordx4 v[8:11], v251, s[16:19], s40 offen offset:2048
    v_mfma_f32_16x16x32_bf16 v[144:147], v[52:55], a[208:211], v[144:147]
    v_mfma_f32_16x16x32_bf16 v[148:151], v[52:55], a[212:215], v[148:151]
    v_mfma_f32_16x16x32_bf16 v[148:151], v[48:51], a[196:199], v[148:151]
    v_mfma_f32_16x16x32_bf16 v[152:155], v[48:51], a[200:203], v[152:155]
    buffer_load_dwordx4 v[12:15], v251, s[16:19], s40 offen offset:3072
    v_mfma_f32_16x16x32_bf16 v[152:155], v[52:55], a[216:219], v[152:155]
    v_mfma_f32_16x16x32_bf16 v[156:159], v[52:55], a[220:223], v[156:159]
    v_mfma_f32_16x16x32_bf16 v[156:159], v[48:51], a[204:207], v[156:159]
    s_waitcnt vmcnt(28)
    v_mfma_f32_16x16x32_bf16 v[144:147], v[56:59], a[224:227], v[144:147]
    buffer_load_dwordx4 v[16:19], v251, s[16:19], s41 offen offset:0
    v_mfma_f32_16x16x32_bf16 v[144:147], v[60:63], a[240:243], v[144:147]
    v_mfma_f32_16x16x32_bf16 v[148:151], v[60:63], a[244:247], v[148:151]
    v_mfma_f32_16x16x32_bf16 v[148:151], v[56:59], a[228:231], v[148:151]
    v_mfma_f32_16x16x32_bf16 v[152:155], v[56:59], a[232:235], v[152:155]
    buffer_load_dwordx4 v[20:23], v251, s[16:19], s41 offen offset:1024
    v_mfma_f32_16x16x32_bf16 v[152:155], v[60:63], a[248:251], v[152:155]
    v_mfma_f32_16x16x32_bf16 v[156:159], v[60:63], a[252:255], v[156:159]
    v_mfma_f32_16x16x32_bf16 v[156:159], v[56:59], a[236:239], v[156:159]
    s_waitcnt vmcnt(28)
    v_mfma_f32_16x16x32_bf16 v[144:147], v[64:67], v[216:219], v[144:147]
    buffer_load_dwordx4 v[24:27], v251, s[16:19], s41 offen offset:2048
    v_mfma_f32_16x16x32_bf16 v[144:147], v[68:71], v[232:235], v[144:147]
    v_mfma_f32_16x16x32_bf16 v[148:151], v[68:71], v[236:239], v[148:151]
    v_mfma_f32_16x16x32_bf16 v[148:151], v[64:67], v[220:223], v[148:151]
    v_mfma_f32_16x16x32_bf16 v[152:155], v[64:67], v[224:227], v[152:155]
    v_mfma_f32_16x16x32_bf16 v[152:155], v[68:71], v[240:243], v[152:155]
    v_mfma_f32_16x16x32_bf16 v[156:159], v[68:71], v[244:247], v[156:159]
    v_mfma_f32_16x16x32_bf16 v[156:159], v[64:67], v[228:231], v[156:159]
    s_waitcnt vmcnt(26)
    s_add_u32 s33, s29, s70
    s_and_b32 s33, s33, 7
    s_lshl_b32 s30, s33, 11
    s_add_u32 s30, s30, s34
    v_mfma_f32_16x16x32_bf16 v[160:163], v[72:75], a[0:3], 0
    buffer_load_dwordx4 v[28:31], v251, s[16:19], s41 offen offset:3072
    v_mfma_f32_16x16x32_bf16 v[160:163], v[76:79], a[16:19], v[160:163]
    v_mfma_f32_16x16x32_bf16 v[164:167], v[76:79], a[20:23], 0
    v_mfma_f32_16x16x32_bf16 v[164:167], v[72:75], a[4:7], v[164:167]
    v_mfma_f32_16x16x32_bf16 v[168:171], v[72:75], a[8:11], 0
    buffer_load_dwordx4 v[32:35], v251, s[16:19], s42 offen offset:0
    v_mfma_f32_16x16x32_bf16 v[168:171], v[76:79], a[24:27], v[168:171]
    v_mfma_f32_16x16x32_bf16 v[172:175], v[76:79], a[28:31], 0
    v_mfma_f32_16x16x32_bf16 v[172:175], v[72:75], a[12:15], v[172:175]
    s_waitcnt vmcnt(26)
    v_mfma_f32_16x16x32_bf16 v[160:163], v[80:83], a[32:35], v[160:163]
    buffer_load_dwordx4 v[36:39], v251, s[16:19], s42 offen offset:1024
    v_mfma_f32_16x16x32_bf16 v[160:163], v[84:87], a[48:51], v[160:163]
    v_cvt_pk_bf16_f32 v200, v144, v145
    v_cvt_pk_bf16_f32 v201, v146, v147
    v_mfma_f32_16x16x32_bf16 v[164:167], v[84:87], a[52:55], v[164:167]
    v_cvt_pk_bf16_f32 v202, v148, v149
    v_cvt_pk_bf16_f32 v203, v150, v151
    v_mfma_f32_16x16x32_bf16 v[164:167], v[80:83], a[36:39], v[164:167]
    v_cvt_pk_bf16_f32 v204, v152, v153
    v_cvt_pk_bf16_f32 v205, v154, v155
    v_mfma_f32_16x16x32_bf16 v[168:171], v[80:83], a[40:43], v[168:171]
    buffer_load_dwordx4 v[40:43], v251, s[16:19], s42 offen offset:2048
    v_mfma_f32_16x16x32_bf16 v[168:171], v[84:87], a[56:59], v[168:171]
    v_cvt_pk_bf16_f32 v206, v156, v157
    v_cvt_pk_bf16_f32 v207, v158, v159
    v_mfma_f32_16x16x32_bf16 v[172:175], v[84:87], a[60:63], v[172:175]
    v_mfma_f32_16x16x32_bf16 v[172:175], v[80:83], a[44:47], v[172:175]
    s_waitcnt vmcnt(25)
    v_mfma_f32_16x16x32_bf16 v[160:163], v[88:91], a[64:67], v[160:163]
    buffer_load_dwordx4 v[44:47], v251, s[16:19], s42 offen offset:3072
    v_mfma_f32_16x16x32_bf16 v[160:163], v[92:95], a[80:83], v[160:163]
    v_mfma_f32_16x16x32_bf16 v[164:167], v[92:95], a[84:87], v[164:167]
    v_mfma_f32_16x16x32_bf16 v[164:167], v[88:91], a[68:71], v[164:167]
    v_mfma_f32_16x16x32_bf16 v[168:171], v[88:91], a[72:75], v[168:171]
    v_mfma_f32_16x16x32_bf16 v[168:171], v[92:95], a[88:91], v[168:171]
    v_mfma_f32_16x16x32_bf16 v[172:175], v[92:95], a[92:95], v[172:175]
    buffer_store_dwordx4 v[200:203], v251, s[12:15], s30 offen sc1
    v_mfma_f32_16x16x32_bf16 v[172:175], v[88:91], a[76:79], v[172:175]
    s_waitcnt vmcnt(25)
    v_mfma_f32_16x16x32_bf16 v[160:163], v[96:99], a[96:99], v[160:163]
    buffer_load_dwordx4 v[48:51], v251, s[16:19], s43 offen offset:0
    v_mfma_f32_16x16x32_bf16 v[160:163], v[100:103], a[112:115], v[160:163]
    v_mfma_f32_16x16x32_bf16 v[164:167], v[100:103], a[116:119], v[164:167]
    v_mfma_f32_16x16x32_bf16 v[164:167], v[96:99], a[100:103], v[164:167]
    v_mfma_f32_16x16x32_bf16 v[168:171], v[96:99], a[104:107], v[168:171]
    buffer_load_dwordx4 v[52:55], v251, s[16:19], s43 offen offset:1024
    v_mfma_f32_16x16x32_bf16 v[168:171], v[100:103], a[120:123], v[168:171]
    v_mfma_f32_16x16x32_bf16 v[172:175], v[100:103], a[124:127], v[172:175]
    v_mfma_f32_16x16x32_bf16 v[172:175], v[96:99], a[108:111], v[172:175]
    s_waitcnt vmcnt(25)
    v_mfma_f32_16x16x32_bf16 v[160:163], v[104:107], a[128:131], v[160:163]
    buffer_load_dwordx4 v[56:59], v251, s[16:19], s43 offen offset:2048
    v_mfma_f32_16x16x32_bf16 v[160:163], v[108:111], a[144:147], v[160:163]
    v_mfma_f32_16x16x32_bf16 v[164:167], v[108:111], a[148:151], v[164:167]
    v_mfma_f32_16x16x32_bf16 v[164:167], v[104:107], a[132:135], v[164:167]
    v_mfma_f32_16x16x32_bf16 v[168:171], v[104:107], a[136:139], v[168:171]
    buffer_load_dwordx4 v[60:63], v251, s[16:19], s43 offen offset:3072
    v_mfma_f32_16x16x32_bf16 v[168:171], v[108:111], a[152:155], v[168:171]
    v_mfma_f32_16x16x32_bf16 v[172:175], v[108:111], a[156:159], v[172:175]
    v_mfma_f32_16x16x32_bf16 v[172:175], v[104:107], a[140:143], v[172:175]
    s_waitcnt vmcnt(25)
    v_mfma_f32_16x16x32_bf16 v[160:163], v[112:115], a[160:163], v[160:163]
    buffer_load_dwordx4 v[64:67], v251, s[16:19], s44 offen offset:0
    v_mfma_f32_16x16x32_bf16 v[160:163], v[116:119], a[176:179], v[160:163]
    v_mfma_f32_16x16x32_bf16 v[164:167], v[116:119], a[180:183], v[164:167]
    v_mfma_f32_16x16x32_bf16 v[164:167], v[112:115], a[164:167], v[164:167]
    v_mfma_f32_16x16x32_bf16 v[168:171], v[112:115], a[168:171], v[168:171]
    v_mfma_f32_16x16x32_bf16 v[168:171], v[116:119], a[184:187], v[168:171]
    v_mfma_f32_16x16x32_bf16 v[172:175], v[116:119], a[188:191], v[172:175]
    buffer_store_dwordx4 v[204:207], v251, s[12:15], s30 offen offset:1024 sc1
    v_mfma_f32_16x16x32_bf16 v[172:175], v[112:115], a[172:175], v[172:175]
    s_waitcnt vmcnt(25)
    v_mfma_f32_16x16x32_bf16 v[160:163], v[120:123], a[192:195], v[160:163]
    buffer_load_dwordx4 v[68:71], v251, s[16:19], s44 offen offset:1024
    v_mfma_f32_16x16x32_bf16 v[160:163], v[124:127], a[208:211], v[160:163]
    v_mfma_f32_16x16x32_bf16 v[164:167], v[124:127], a[212:215], v[164:167]
    v_mfma_f32_16x16x32_bf16 v[164:167], v[120:123], a[196:199], v[164:167]
    v_mfma_f32_16x16x32_bf16 v[168:171], v[120:123], a[200:203], v[168:171]
    s_mul_i32 s66, s73, 18432
    s_add_u32 s16, s64, s66
    s_addc_u32 s17, s65, 0
    buffer_load_dwordx4 v[72:75], v251, s[16:19], s40 offen offset:0
    v_mfma_f32_16x16x32_bf16 v[168:171], v[124:127], a[216:219], v[168:171]
    v_mfma_f32_16x16x32_bf16 v[172:175], v[124:127], a[220:223], v[172:175]
    v_mfma_f32_16x16x32_bf16 v[172:175], v[120:123], a[204:207], v[172:175]
    s_waitcnt vmcnt(24)
    v_mfma_f32_16x16x32_bf16 v[160:163], v[128:131], a[224:227], v[160:163]
    buffer_load_dwordx4 v[76:79], v251, s[16:19], s40 offen offset:1024
    v_mfma_f32_16x16x32_bf16 v[160:163], v[132:135], a[240:243], v[160:163]
    v_mfma_f32_16x16x32_bf16 v[164:167], v[132:135], a[244:247], v[164:167]
    v_mfma_f32_16x16x32_bf16 v[164:167], v[128:131], a[228:231], v[164:167]
    v_mfma_f32_16x16x32_bf16 v[168:171], v[128:131], a[232:235], v[168:171]
    buffer_load_dwordx4 v[80:83], v251, s[16:19], s40 offen offset:2048
    v_mfma_f32_16x16x32_bf16 v[168:171], v[132:135], a[248:251], v[168:171]
    v_mfma_f32_16x16x32_bf16 v[172:175], v[132:135], a[252:255], v[172:175]
    v_mfma_f32_16x16x32_bf16 v[172:175], v[128:131], a[236:239], v[172:175]
    s_waitcnt vmcnt(24)
    v_mfma_f32_16x16x32_bf16 v[160:163], v[136:139], v[216:219], v[160:163]
    buffer_load_dwordx4 v[84:87], v251, s[16:19], s40 offen offset:3072
    v_mfma_f32_16x16x32_bf16 v[160:163], v[140:143], v[232:235], v[160:163]
    v_mfma_f32_16x16x32_bf16 v[164:167], v[140:143], v[236:239], v[164:167]
    v_mfma_f32_16x16x32_bf16 v[164:167], v[136:139], v[220:223], v[164:167]
    v_mfma_f32_16x16x32_bf16 v[168:171], v[136:139], v[224:227], v[168:171]
    v_mfma_f32_16x16x32_bf16 v[168:171], v[140:143], v[240:243], v[168:171]
    v_mfma_f32_16x16x32_bf16 v[172:175], v[140:143], v[244:247], v[172:175]
    v_mfma_f32_16x16x32_bf16 v[172:175], v[136:139], v[228:231], v[172:175]
    s_waitcnt vmcnt(23)
    s_add_u32 s33, s29, s71
    s_and_b32 s33, s33, 7
    s_lshl_b32 s30, s33, 11
    s_add_u32 s30, s30, s34
    v_mfma_f32_16x16x32_bf16 v[144:147], v[0:3], a[0:3], 0
    buffer_load_dwordx4 v[88:91], v251, s[16:19], s41 offen offset:0
    v_mfma_f32_16x16x32_bf16 v[144:147], v[4:7], a[16:19], v[144:147]
    v_mfma_f32_16x16x32_bf16 v[148:151], v[4:7], a[20:23], 0
    v_mfma_f32_16x16x32_bf16 v[148:151], v[0:3], a[4:7], v[148:151]
    v_mfma_f32_16x16x32_bf16 v[152:155], v[0:3], a[8:11], 0
    buffer_load_dwordx4 v[92:95], v251, s[16:19], s41 offen offset:1024
    v_mfma_f32_16x16x32_bf16 v[152:155], v[4:7], a[24:27], v[152:155]
    v_mfma_f32_16x16x32_bf16 v[156:159], v[4:7], a[28:31], 0
    v_mfma_f32_16x16x32_bf16 v[156:159], v[0:3], a[12:15], v[156:159]
    s_waitcnt vmcnt(22)
    v_mfma_f32_16x16x32_bf16 v[144:147], v[8:11], a[32:35], v[144:147]
    buffer_load_dwordx4 v[96:99], v251, s[16:19], s41 offen offset:2048
    v_mfma_f32_16x16x32_bf16 v[144:147], v[12:15], a[48:51], v[144:147]
    v_cvt_pk_bf16_f32 v200, v160, v161
    v_cvt_pk_bf16_f32 v201, v162, v163
    v_mfma_f32_16x16x32_bf16 v[148:151], v[12:15], a[52:55], v[148:151]
    v_cvt_pk_bf16_f32 v202, v164, v165
    v_cvt_pk_bf16_f32 v203, v166, v167
    v_mfma_f32_16x16x32_bf16 v[148:151], v[8:11], a[36:39], v[148:151]
    v_cvt_pk_bf16_f32 v204, v168, v169
    v_cvt_pk_bf16_f32 v205, v170, v171
    v_mfma_f32_16x16x32_bf16 v[152:155], v[8:11], a[40:43], v[152:155]
    buffer_load_dwordx4 v[100:103], v251, s[16:19], s41 offen offset:3072
    v_mfma_f32_16x16x32_bf16 v[152:155], v[12:15], a[56:59], v[152:155]
    v_cvt_pk_bf16_f32 v206, v172, v173
    v_cvt_pk_bf16_f32 v207, v174, v175
    v_mfma_f32_16x16x32_bf16 v[156:159], v[12:15], a[60:63], v[156:159]
    v_mfma_f32_16x16x32_bf16 v[156:159], v[8:11], a[44:47], v[156:159]
    s_waitcnt vmcnt(22)
    v_mfma_f32_16x16x32_bf16 v[144:147], v[16:19], a[64:67], v[144:147]
    buffer_load_dwordx4 v[104:107], v251, s[16:19], s42 offen offset:0
    v_mfma_f32_16x16x32_bf16 v[144:147], v[20:23], a[80:83], v[144:147]
    v_mfma_f32_16x16x32_bf16 v[148:151], v[20:23], a[84:87], v[148:151]
    v_mfma_f32_16x16x32_bf16 v[148:151], v[16:19], a[68:71], v[148:151]
    v_mfma_f32_16x16x32_bf16 v[152:155], v[16:19], a[72:75], v[152:155]
    v_mfma_f32_16x16x32_bf16 v[152:155], v[20:23], a[88:91], v[152:155]
    v_mfma_f32_16x16x32_bf16 v[156:159], v[20:23], a[92:95], v[156:159]
    buffer_store_dwordx4 v[200:203], v251, s[12:15], s30 offen sc1
    v_mfma_f32_16x16x32_bf16 v[156:159], v[16:19], a[76:79], v[156:159]
    s_waitcnt vmcnt(22)
    v_mfma_f32_16x16x32_bf16 v[144:147], v[24:27], a[96:99], v[144:147]
    buffer_load_dwordx4 v[108:111], v251, s[16:19], s42 offen offset:1024
    v_mfma_f32_16x16x32_bf16 v[144:147], v[28:31], a[112:115], v[144:147]
    v_mfma_f32_16x16x32_bf16 v[148:151], v[28:31], a[116:119], v[148:151]
    v_mfma_f32_16x16x32_bf16 v[148:151], v[24:27], a[100:103], v[148:151]
    v_mfma_f32_16x16x32_bf16 v[152:155], v[24:27], a[104:107], v[152:155]
    buffer_load_dwordx4 v[112:115], v251, s[16:19], s42 offen offset:2048
    v_mfma_f32_16x16x32_bf16 v[152:155], v[28:31], a[120:123], v[152:155]
    v_mfma_f32_16x16x32_bf16 v[156:159], v[28:31], a[124:127], v[156:159]
    v_mfma_f32_16x16x32_bf16 v[156:159], v[24:27], a[108:111], v[156:159]
    s_waitcnt vmcnt(22)
    v_mfma_f32_16x16x32_bf16 v[144:147], v[32:35], a[128:131], v[144:147]
    buffer_load_dwordx4 v[116:119], v251, s[16:19], s42 offen offset:3072
    v_mfma_f32_16x16x32_bf16 v[144:147], v[36:39], a[144:147], v[144:147]
    v_mfma_f32_16x16x32_bf16 v[148:151], v[36:39], a[148:151], v[148:151]
    v_mfma_f32_16x16x32_bf16 v[148:151], v[32:35], a[132:135], v[148:151]
    v_mfma_f32_16x16x32_bf16 v[152:155], v[32:35], a[136:139], v[152:155]
    buffer_load_dwordx4 v[120:123], v251, s[16:19], s43 offen offset:0
    v_mfma_f32_16x16x32_bf16 v[152:155], v[36:39], a[152:155], v[152:155]
    v_mfma_f32_16x16x32_bf16 v[156:159], v[36:39], a[156:159], v[156:159]
    v_mfma_f32_16x16x32_bf16 v[156:159], v[32:35], a[140:143], v[156:159]
    s_waitcnt vmcnt(22)
    v_mfma_f32_16x16x32_bf16 v[144:147], v[40:43], a[160:163], v[144:147]
    buffer_load_dwordx4 v[124:127], v251, s[16:19], s43 offen offset:1024
    v_mfma_f32_16x16x32_bf16 v[144:147], v[44:47], a[176:179], v[144:147]
    v_mfma_f32_16x16x32_bf16 v[148:151], v[44:47], a[180:183], v[148:151]
    v_mfma_f32_16x16x32_bf16 v[148:151], v[40:43], a[164:167], v[148:151]
    v_mfma_f32_16x16x32_bf16 v[152:155], v[40:43], a[168:171], v[152:155]
    v_mfma_f32_16x16x32_bf16 v[152:155], v[44:47], a[184:187], v[152:155]
    v_mfma_f32_16x16x32_bf16 v[156:159], v[44:47], a[188:191], v[156:159]
    buffer_store_dwordx4 v[204:207], v251, s[12:15], s30 offen offset:1024 sc1
    v_mfma_f32_16x16x32_bf16 v[156:159], v[40:43], a[172:175], v[156:159]
    s_waitcnt vmcnt(21)
    v_mfma_f32_16x16x32_bf16 v[144:147], v[48:51], a[192:195], v[144:147]
    buffer_load_dwordx4 v[128:131], v251, s[16:19], s43 offen offset:2048
    v_mfma_f32_16x16x32_bf16 v[144:147], v[52:55], a[208:211], v[144:147]
    v_mfma_f32_16x16x32_bf16 v[148:151], v[52:55], a[212:215], v[148:151]
    v_mfma_f32_16x16x32_bf16 v[148:151], v[48:51], a[196:199], v[148:151]
    v_mfma_f32_16x16x32_bf16 v[152:155], v[48:51], a[200:203], v[152:155]
    buffer_load_dwordx4 v[132:135], v251, s[16:19], s43 offen offset:3072
    v_mfma_f32_16x16x32_bf16 v[152:155], v[52:55], a[216:219], v[152:155]
    v_mfma_f32_16x16x32_bf16 v[156:159], v[52:55], a[220:223], v[156:159]
    v_mfma_f32_16x16x32_bf16 v[156:159], v[48:51], a[204:207], v[156:159]
    s_waitcnt vmcnt(21)
    v_mfma_f32_16x16x32_bf16 v[144:147], v[56:59], a[224:227], v[144:147]
    buffer_load_dwordx4 v[136:139], v251, s[16:19], s44 offen offset:0
    v_mfma_f32_16x16x32_bf16 v[144:147], v[60:63], a[240:243], v[144:147]
    v_mfma_f32_16x16x32_bf16 v[148:151], v[60:63], a[244:247], v[148:151]
    v_mfma_f32_16x16x32_bf16 v[148:151], v[56:59], a[228:231], v[148:151]
    v_mfma_f32_16x16x32_bf16 v[152:155], v[56:59], a[232:235], v[152:155]
    buffer_load_dwordx4 v[140:143], v251, s[16:19], s44 offen offset:1024
    v_mfma_f32_16x16x32_bf16 v[152:155], v[60:63], a[248:251], v[152:155]
    v_mfma_f32_16x16x32_bf16 v[156:159], v[60:63], a[252:255], v[156:159]
    v_mfma_f32_16x16x32_bf16 v[156:159], v[56:59], a[236:239], v[156:159]
    s_waitcnt vmcnt(20)
    v_mfma_f32_16x16x32_bf16 v[144:147], v[64:67], v[216:219], v[144:147]
    s_mul_i32 s66, s74, 18432
    s_add_u32 s16, s64, s66
    s_addc_u32 s17, s65, 0
    buffer_load_dwordx4 v[0:3], v251, s[16:19], s40 offen offset:0
    v_mfma_f32_16x16x32_bf16 v[144:147], v[68:71], v[232:235], v[144:147]
    v_mfma_f32_16x16x32_bf16 v[148:151], v[68:71], v[236:239], v[148:151]
    v_mfma_f32_16x16x32_bf16 v[148:151], v[64:67], v[220:223], v[148:151]
    v_mfma_f32_16x16x32_bf16 v[152:155], v[64:67], v[224:227], v[152:155]
    v_mfma_f32_16x16x32_bf16 v[152:155], v[68:71], v[240:243], v[152:155]
    v_mfma_f32_16x16x32_bf16 v[156:159], v[68:71], v[244:247], v[156:159]
    v_mfma_f32_16x16x32_bf16 v[156:159], v[64:67], v[228:231], v[156:159]
    s_waitcnt vmcnt(19)
    s_add_u32 s33, s29, s72
    s_and_b32 s33, s33, 7
    s_lshl_b32 s30, s33, 11
    s_add_u32 s30, s30, s34
    v_mfma_f32_16x16x32_bf16 v[160:163], v[72:75], a[0:3], 0
    buffer_load_dwordx4 v[4:7], v251, s[16:19], s40 offen offset:1024
    v_mfma_f32_16x16x32_bf16 v[160:163], v[76:79], a[16:19], v[160:163]
    v_mfma_f32_16x16x32_bf16 v[164:167], v[76:79], a[20:23], 0
    v_mfma_f32_16x16x32_bf16 v[164:167], v[72:75], a[4:7], v[164:167]
    v_mfma_f32_16x16x32_bf16 v[168:171], v[72:75], a[8:11], 0
    buffer_load_dwordx4 v[8:11], v251, s[16:19], s40 offen offset:2048
    v_mfma_f32_16x16x32_bf16 v[168:171], v[76:79], a[24:27], v[168:171]
    v_mfma_f32_16x16x32_bf16 v[172:175], v[76:79], a[28:31], 0
    v_mfma_f32_16x16x32_bf16 v[172:175], v[72:75], a[12:15], v[172:175]
    s_waitcnt vmcnt(19)
    v_mfma_f32_16x16x32_bf16 v[160:163], v[80:83], a[32:35], v[160:163]
    buffer_load_dwordx4 v[12:15], v251, s[16:19], s40 offen offset:3072
    v_mfma_f32_16x16x32_bf16 v[160:163], v[84:87], a[48:51], v[160:163]
    v_cvt_pk_bf16_f32 v200, v144, v145
    v_cvt_pk_bf16_f32 v201, v146, v147
    v_mfma_f32_16x16x32_bf16 v[164:167], v[84:87], a[52:55], v[164:167]
    v_cvt_pk_bf16_f32 v202, v148, v149
    v_cvt_pk_bf16_f32 v203, v150, v151
    v_mfma_f32_16x16x32_bf16 v[164:167], v[80:83], a[36:39], v[164:167]
    v_cvt_pk_bf16_f32 v204, v152, v153
    v_cvt_pk_bf16_f32 v205, v154, v155
    v_mfma_f32_16x16x32_bf16 v[168:171], v[80:83], a[40:43], v[168:171]
    buffer_load_dwordx4 v[16:19], v251, s[16:19], s41 offen offset:0
    v_mfma_f32_16x16x32_bf16 v[168:171], v[84:87], a[56:59], v[168:171]
    v_cvt_pk_bf16_f32 v206, v156, v157
    v_cvt_pk_bf16_f32 v207, v158, v159
    v_mfma_f32_16x16x32_bf16 v[172:175], v[84:87], a[60:63], v[172:175]
    s_xor_b32 s24, s20, 0
    s_lshr_b32 s26, s24, 1
    v_mfma_f32_16x16x32_bf16 v[172:175], v[80:83], a[44:47], v[172:175]
    s_mul_i32 s26, s26, 36864
    s_waitcnt vmcnt(19)
    v_mfma_f32_16x16x32_bf16 v[160:163], v[88:91], a[64:67], v[160:163]
    buffer_load_dwordx4 v[20:23], v251, s[16:19], s41 offen offset:1024
    v_mfma_f32_16x16x32_bf16 v[160:163], v[92:95], a[80:83], v[160:163]
    s_add_u32 s26, s26, s32
    s_lshl_b32 s25, s37, 5
    v_mfma_f32_16x16x32_bf16 v[164:167], v[92:95], a[84:87], v[164:167]
    s_add_u32 s50, s26, s25
    s_mul_i32 s24, s24, 18432
    v_mfma_f32_16x16x32_bf16 v[164:167], v[88:91], a[68:71], v[164:167]
    s_add_u32 s24, s24, s32
    s_lshl_b32 s25, s37, 9
    v_mfma_f32_16x16x32_bf16 v[168:171], v[88:91], a[72:75], v[168:171]
    s_add_u32 s24, s24, s25
    s_sub_u32 s53, s24, s32
    v_mfma_f32_16x16x32_bf16 v[168:171], v[92:95], a[88:91], v[168:171]
    s_xor_b32 s24, s20, 1
    s_mul_i32 s24, s24, 18432
    v_mfma_f32_16x16x32_bf16 v[172:175], v[92:95], a[92:95], v[172:175]
    buffer_store_dwordx4 v[200:203], v251, s[12:15], s30 offen sc1
    s_add_u32 s24, s24, s32
    v_mfma_f32_16x16x32_bf16 v[172:175], v[88:91], a[76:79], v[172:175]
    s_lshl_b32 s25, s37, 9
    s_waitcnt vmcnt(19)
    v_mfma_f32_16x16x32_bf16 v[160:163], v[96:99], a[96:99], v[160:163]
    buffer_load_dwordx4 v[24:27], v251, s[16:19], s41 offen offset:2048
    v_mfma_f32_16x16x32_bf16 v[160:163], v[100:103], a[112:115], v[160:163]
    s_add_u32 s24, s24, s25
    s_sub_u32 s54, s24, s32
    v_mfma_f32_16x16x32_bf16 v[164:167], v[100:103], a[116:119], v[164:167]
    s_xor_b32 s24, s20, 2
    s_lshr_b32 s26, s24, 1
    v_mfma_f32_16x16x32_bf16 v[164:167], v[96:99], a[100:103], v[164:167]
    s_mul_i32 s26, s26, 36864
    s_add_u32 s26, s26, s32
    v_mfma_f32_16x16x32_bf16 v[168:171], v[96:99], a[104:107], v[168:171]
    buffer_load_dwordx4 v[28:31], v251, s[16:19], s41 offen offset:3072
    v_mfma_f32_16x16x32_bf16 v[168:171], v[100:103], a[120:123], v[168:171]
    s_lshl_b32 s25, s37, 5
    s_add_u32 s51, s26, s25
    v_mfma_f32_16x16x32_bf16 v[172:175], v[100:103], a[124:127], v[172:175]
    s_mul_i32 s24, s24, 18432
    s_add_u32 s24, s24, s32
    v_mfma_f32_16x16x32_bf16 v[172:175], v[96:99], a[108:111], v[172:175]
    s_lshl_b32 s25, s37, 9
    s_waitcnt vmcnt(18)
    v_mfma_f32_16x16x32_bf16 v[160:163], v[104:107], a[128:131], v[160:163]
    buffer_load_dwordx4 v[32:35], v251, s[16:19], s42 offen offset:0
    v_mfma_f32_16x16x32_bf16 v[160:163], v[108:111], a[144:147], v[160:163]
    s_add_u32 s24, s24, s25
    s_sub_u32 s55, s24, s32
    v_mfma_f32_16x16x32_bf16 v[164:167], v[108:111], a[148:151], v[164:167]
    s_xor_b32 s24, s20, 3
    s_mul_i32 s24, s24, 18432
    v_mfma_f32_16x16x32_bf16 v[164:167], v[104:107], a[132:135], v[164:167]
    s_add_u32 s24, s24, s32
    s_lshl_b32 s25, s37, 9
    v_mfma_f32_16x16x32_bf16 v[168:171], v[104:107], a[136:139], v[168:171]
    buffer_load_dwordx4 v[36:39], v251, s[16:19], s42 offen offset:1024
    v_mfma_f32_16x16x32_bf16 v[168:171], v[108:111], a[152:155], v[168:171]
    s_add_u32 s24, s24, s25
    s_sub_u32 s60, s24, s32
    v_mfma_f32_16x16x32_bf16 v[172:175], v[108:111], a[156:159], v[172:175]
    s_and_b32 s24, s29, 1
    s_lshl_b32 s24, s24, 1
    v_mfma_f32_16x16x32_bf16 v[172:175], v[104:107], a[140:143], v[172:175]
    s_add_u32 s24, s24, 0
    s_waitcnt vmcnt(18)
    v_mfma_f32_16x16x32_bf16 v[160:163], v[112:115], a[160:163], v[160:163]
    buffer_load_dwordx4 v[40:43], v251, s[16:19], s42 offen offset:2048
    v_mfma_f32_16x16x32_bf16 v[160:163], v[116:119], a[176:179], v[160:163]
    s_xor_b32 s24, s24, s20
    s_lshr_b32 s26, s24, 1
    v_mfma_f32_16x16x32_bf16 v[164:167], v[116:119], a[180:183], v[164:167]
    s_mul_i32 s26, s26, 36864
    s_add_u32 s26, s26, s32
    v_mfma_f32_16x16x32_bf16 v[164:167], v[112:115], a[164:167], v[164:167]
    s_lshl_b32 s25, s38, 5
    s_add_u32 s52, s26, s25
    v_mfma_f32_16x16x32_bf16 v[168:171], v[112:115], a[168:171], v[168:171]
    s_mul_i32 s24, s24, 18432
    s_add_u32 s24, s24, s32
    v_mfma_f32_16x16x32_bf16 v[168:171], v[116:119], a[184:187], v[168:171]
    s_lshl_b32 s25, s38, 9
    s_add_u32 s24, s24, s25
    v_mfma_f32_16x16x32_bf16 v[172:175], v[116:119], a[188:191], v[172:175]
    buffer_store_dwordx4 v[204:207], v251, s[12:15], s30 offen offset:1024 sc1
    s_sub_u32 s61, s24, s32
    v_mfma_f32_16x16x32_bf16 v[172:175], v[112:115], a[172:175], v[172:175]
    s_and_b32 s24, s29, 1
    s_waitcnt vmcnt(18)
    v_mfma_f32_16x16x32_bf16 v[160:163], v[120:123], a[192:195], v[160:163]
    buffer_load_dwordx4 v[44:47], v251, s[16:19], s42 offen offset:3072
    v_mfma_f32_16x16x32_bf16 v[160:163], v[124:127], a[208:211], v[160:163]
    s_lshl_b32 s24, s24, 1
    s_add_u32 s24, s24, 1
    v_mfma_f32_16x16x32_bf16 v[164:167], v[124:127], a[212:215], v[164:167]
    s_xor_b32 s24, s24, s20
    s_mul_i32 s24, s24, 18432
    v_mfma_f32_16x16x32_bf16 v[164:167], v[120:123], a[196:199], v[164:167]
    s_add_u32 s24, s24, s32
    s_lshl_b32 s25, s38, 9
    v_mfma_f32_16x16x32_bf16 v[168:171], v[120:123], a[200:203], v[168:171]
    buffer_load_dwordx4 v[48:51], v251, s[16:19], s43 offen offset:0
    v_mfma_f32_16x16x32_bf16 v[168:171], v[124:127], a[216:219], v[168:171]
    s_add_u32 s24, s24, s25
    s_sub_u32 s62, s24, s32
    v_mfma_f32_16x16x32_bf16 v[172:175], v[124:127], a[220:223], v[172:175]
    v_mfma_f32_16x16x32_bf16 v[172:175], v[120:123], a[204:207], v[172:175]
    s_waitcnt vmcnt(17)
    v_mfma_f32_16x16x32_bf16 v[160:163], v[128:131], a[224:227], v[160:163]
    buffer_load_dwordx4 v[52:55], v251, s[16:19], s43 offen offset:1024
    v_mfma_f32_16x16x32_bf16 v[160:163], v[132:135], a[240:243], v[160:163]
    v_mfma_f32_16x16x32_bf16 v[164:167], v[132:135], a[244:247], v[164:167]
    v_mfma_f32_16x16x32_bf16 v[164:167], v[128:131], a[228:231], v[164:167]
    v_mfma_f32_16x16x32_bf16 v[168:171], v[128:131], a[232:235], v[168:171]
    buffer_load_dwordx4 v[56:59], v251, s[16:19], s43 offen offset:2048
    v_mfma_f32_16x16x32_bf16 v[168:171], v[132:135], a[248:251], v[168:171]
    v_mfma_f32_16x16x32_bf16 v[172:175], v[132:135], a[252:255], v[172:175]
    v_mfma_f32_16x16x32_bf16 v[172:175], v[128:131], a[236:239], v[172:175]
    s_waitcnt vmcnt(17)
    v_mfma_f32_16x16x32_bf16 v[160:163], v[136:139], v[216:219], v[160:163]
    buffer_load_dwordx4 v[60:63], v251, s[16:19], s43 offen offset:3072
    v_mfma_f32_16x16x32_bf16 v[160:163], v[140:143], v[232:235], v[160:163]
    v_mfma_f32_16x16x32_bf16 v[164:167], v[140:143], v[236:239], v[164:167]
    v_mfma_f32_16x16x32_bf16 v[164:167], v[136:139], v[220:223], v[164:167]
    v_mfma_f32_16x16x32_bf16 v[168:171], v[136:139], v[224:227], v[168:171]
    v_mfma_f32_16x16x32_bf16 v[168:171], v[140:143], v[240:243], v[168:171]
    v_mfma_f32_16x16x32_bf16 v[172:175], v[140:143], v[244:247], v[172:175]
    v_mfma_f32_16x16x32_bf16 v[172:175], v[136:139], v[228:231], v[172:175]
    s_waitcnt vmcnt(16)
    s_add_u32 s33, s29, s73
    s_and_b32 s33, s33, 7
    s_lshl_b32 s30, s33, 11
    s_add_u32 s30, s30, s34
    v_mfma_f32_16x16x32_bf16 v[144:147], v[0:3], a[0:3], 0
    buffer_load_dwordx4 v[64:67], v251, s[16:19], s44 offen offset:0
    v_mfma_f32_16x16x32_bf16 v[144:147], v[4:7], a[16:19], v[144:147]
    v_mfma_f32_16x16x32_bf16 v[148:151], v[4:7], a[20:23], 0
    v_mfma_f32_16x16x32_bf16 v[148:151], v[0:3], a[4:7], v[148:151]
    v_mfma_f32_16x16x32_bf16 v[152:155], v[0:3], a[8:11], 0
    buffer_load_dwordx4 v[68:71], v251, s[16:19], s44 offen offset:1024
    v_mfma_f32_16x16x32_bf16 v[152:155], v[4:7], a[24:27], v[152:155]
    v_mfma_f32_16x16x32_bf16 v[156:159], v[4:7], a[28:31], 0
    v_mfma_f32_16x16x32_bf16 v[156:159], v[0:3], a[12:15], v[156:159]
    s_waitcnt vmcnt(16)
    v_mfma_f32_16x16x32_bf16 v[144:147], v[8:11], a[32:35], v[144:147]
    s_add_u32 s16, s64, 147456
    s_addc_u32 s17, s65, 0
    buffer_load_dwordx4 v[72:75], v251, s[16:19], s40 offen offset:0
    v_mfma_f32_16x16x32_bf16 v[144:147], v[12:15], a[48:51], v[144:147]
    v_cvt_pk_bf16_f32 v200, v160, v161
    v_cvt_pk_bf16_f32 v201, v162, v163
    v_mfma_f32_16x16x32_bf16 v[148:151], v[12:15], a[52:55], v[148:151]
    v_cvt_pk_bf16_f32 v202, v164, v165
    v_cvt_pk_bf16_f32 v203, v166, v167
    v_mfma_f32_16x16x32_bf16 v[148:151], v[8:11], a[36:39], v[148:151]
    v_cvt_pk_bf16_f32 v204, v168, v169
    v_cvt_pk_bf16_f32 v205, v170, v171
    v_mfma_f32_16x16x32_bf16 v[152:155], v[8:11], a[40:43], v[152:155]
    buffer_load_dwordx4 v[76:79], v251, s[16:19], s40 offen offset:1024
    v_mfma_f32_16x16x32_bf16 v[152:155], v[12:15], a[56:59], v[152:155]
    v_cvt_pk_bf16_f32 v206, v172, v173
    v_cvt_pk_bf16_f32 v207, v174, v175
    v_mfma_f32_16x16x32_bf16 v[156:159], v[12:15], a[60:63], v[156:159]
    v_mfma_f32_16x16x32_bf16 v[156:159], v[8:11], a[44:47], v[156:159]
    s_waitcnt vmcnt(16)
    v_mfma_f32_16x16x32_bf16 v[144:147], v[16:19], a[64:67], v[144:147]
    buffer_load_dwordx4 v[80:83], v251, s[16:19], s40 offen offset:2048
    v_mfma_f32_16x16x32_bf16 v[144:147], v[20:23], a[80:83], v[144:147]
    v_mfma_f32_16x16x32_bf16 v[148:151], v[20:23], a[84:87], v[148:151]
    v_mfma_f32_16x16x32_bf16 v[148:151], v[16:19], a[68:71], v[148:151]
    v_mfma_f32_16x16x32_bf16 v[152:155], v[16:19], a[72:75], v[152:155]
    v_mfma_f32_16x16x32_bf16 v[152:155], v[20:23], a[88:91], v[152:155]
    v_mfma_f32_16x16x32_bf16 v[156:159], v[20:23], a[92:95], v[156:159]
    buffer_store_dwordx4 v[200:203], v251, s[12:15], s30 offen sc1
    v_mfma_f32_16x16x32_bf16 v[156:159], v[16:19], a[76:79], v[156:159]
    s_waitcnt vmcnt(15)
    v_mfma_f32_16x16x32_bf16 v[144:147], v[24:27], a[96:99], v[144:147]
    buffer_load_dwordx4 v[84:87], v251, s[16:19], s40 offen offset:3072
    v_mfma_f32_16x16x32_bf16 v[144:147], v[28:31], a[112:115], v[144:147]
    v_mfma_f32_16x16x32_bf16 v[148:151], v[28:31], a[116:119], v[148:151]
    v_mfma_f32_16x16x32_bf16 v[148:151], v[24:27], a[100:103], v[148:151]
    v_mfma_f32_16x16x32_bf16 v[152:155], v[24:27], a[104:107], v[152:155]
    buffer_load_dwordx4 v[88:91], v251, s[16:19], s41 offen offset:0
    v_mfma_f32_16x16x32_bf16 v[152:155], v[28:31], a[120:123], v[152:155]
    v_mfma_f32_16x16x32_bf16 v[156:159], v[28:31], a[124:127], v[156:159]
    v_mfma_f32_16x16x32_bf16 v[156:159], v[24:27], a[108:111], v[156:159]
    s_waitcnt vmcnt(15)
    v_mfma_f32_16x16x32_bf16 v[144:147], v[32:35], a[128:131], v[144:147]
    buffer_load_dwordx4 v[92:95], v251, s[16:19], s41 offen offset:1024
    v_mfma_f32_16x16x32_bf16 v[144:147], v[36:39], a[144:147], v[144:147]
    v_mfma_f32_16x16x32_bf16 v[148:151], v[36:39], a[148:151], v[148:151]
    s_waitcnt vmcnt(14)
    s_mov_b64 exec, 1
    buffer_store_dword v253, v181, s[12:15], s35 offen sc1
    s_mov_b64 exec, -1
    v_mfma_f32_16x16x32_bf16 v[148:151], v[32:35], a[132:135], v[148:151]
    v_mfma_f32_16x16x32_bf16 v[152:155], v[32:35], a[136:139], v[152:155]
    buffer_load_dwordx4 v[96:99], v251, s[16:19], s41 offen offset:2048
    v_mfma_f32_16x16x32_bf16 v[152:155], v[36:39], a[152:155], v[152:155]
    v_mfma_f32_16x16x32_bf16 v[156:159], v[36:39], a[156:159], v[156:159]
    v_mfma_f32_16x16x32_bf16 v[156:159], v[32:35], a[140:143], v[156:159]
    s_waitcnt vmcnt(15)
    v_mfma_f32_16x16x32_bf16 v[144:147], v[40:43], a[160:163], v[144:147]
    buffer_load_dwordx4 v[100:103], v251, s[16:19], s41 offen offset:3072
    v_mfma_f32_16x16x32_bf16 v[144:147], v[44:47], a[176:179], v[144:147]
    v_mfma_f32_16x16x32_bf16 v[148:151], v[44:47], a[180:183], v[148:151]
    v_mfma_f32_16x16x32_bf16 v[148:151], v[40:43], a[164:167], v[148:151]
    v_mfma_f32_16x16x32_bf16 v[152:155], v[40:43], a[168:171], v[152:155]
    v_mfma_f32_16x16x32_bf16 v[152:155], v[44:47], a[184:187], v[152:155]
    v_mfma_f32_16x16x32_bf16 v[156:159], v[44:47], a[188:191], v[156:159]
    buffer_store_dwordx4 v[204:207], v251, s[12:15], s30 offen offset:1024 sc1
    v_mfma_f32_16x16x32_bf16 v[156:159], v[40:43], a[172:175], v[156:159]
    s_waitcnt vmcnt(15)
    v_mfma_f32_16x16x32_bf16 v[144:147], v[48:51], a[192:195], v[144:147]
    buffer_load_dwordx4 v[104:107], v251, s[16:19], s42 offen offset:0
    v_mfma_f32_16x16x32_bf16 v[144:147], v[52:55], a[208:211], v[144:147]
    v_mfma_f32_16x16x32_bf16 v[148:151], v[52:55], a[212:215], v[148:151]
    v_mfma_f32_16x16x32_bf16 v[148:151], v[48:51], a[196:199], v[148:151]
    v_mfma_f32_16x16x32_bf16 v[152:155], v[48:51], a[200:203], v[152:155]
    buffer_load_dwordx4 v[108:111], v251, s[16:19], s42 offen offset:1024
    v_mfma_f32_16x16x32_bf16 v[152:155], v[52:55], a[216:219], v[152:155]
    v_mfma_f32_16x16x32_bf16 v[156:159], v[52:55], a[220:223], v[156:159]
    v_mfma_f32_16x16x32_bf16 v[156:159], v[48:51], a[204:207], v[156:159]
    s_waitcnt vmcnt(15)
    v_mfma_f32_16x16x32_bf16 v[144:147], v[56:59], a[224:227], v[144:147]
    buffer_load_dwordx4 v[112:115], v251, s[16:19], s42 offen offset:2048
    v_mfma_f32_16x16x32_bf16 v[144:147], v[60:63], a[240:243], v[144:147]
    v_mfma_f32_16x16x32_bf16 v[148:151], v[60:63], a[244:247], v[148:151]
    v_mfma_f32_16x16x32_bf16 v[148:151], v[56:59], a[228:231], v[148:151]
    v_mfma_f32_16x16x32_bf16 v[152:155], v[56:59], a[232:235], v[152:155]
    buffer_load_dwordx4 v[116:119], v251, s[16:19], s42 offen offset:3072
    v_mfma_f32_16x16x32_bf16 v[152:155], v[60:63], a[248:251], v[152:155]
    v_mfma_f32_16x16x32_bf16 v[156:159], v[60:63], a[252:255], v[156:159]
    v_mfma_f32_16x16x32_bf16 v[156:159], v[56:59], a[236:239], v[156:159]
    s_waitcnt vmcnt(15)
    v_mfma_f32_16x16x32_bf16 v[144:147], v[64:67], v[216:219], v[144:147]
    buffer_load_dwordx4 v[120:123], v251, s[16:19], s43 offen offset:0
    v_mfma_f32_16x16x32_bf16 v[144:147], v[68:71], v[232:235], v[144:147]
    v_mfma_f32_16x16x32_bf16 v[148:151], v[68:71], v[236:239], v[148:151]
    v_mfma_f32_16x16x32_bf16 v[148:151], v[64:67], v[220:223], v[148:151]
    v_mfma_f32_16x16x32_bf16 v[152:155], v[64:67], v[224:227], v[152:155]
    v_mfma_f32_16x16x32_bf16 v[152:155], v[68:71], v[240:243], v[152:155]
    v_mfma_f32_16x16x32_bf16 v[156:159], v[68:71], v[244:247], v[156:159]
    v_mfma_f32_16x16x32_bf16 v[156:159], v[64:67], v[228:231], v[156:159]
    s_waitcnt vmcnt(14)
    s_add_u32 s33, s29, s74
    s_and_b32 s33, s33, 7
    s_lshl_b32 s30, s33, 11
    s_add_u32 s30, s30, s34
    v_mfma_f32_16x16x32_bf16 v[160:163], v[72:75], a[0:3], 0
    buffer_load_dwordx4 v[124:127], v251, s[16:19], s43 offen offset:1024
    v_mfma_f32_16x16x32_bf16 v[160:163], v[76:79], a[16:19], v[160:163]
    v_mfma_f32_16x16x32_bf16 v[164:167], v[76:79], a[20:23], 0
    v_mfma_f32_16x16x32_bf16 v[164:167], v[72:75], a[4:7], v[164:167]
    v_mfma_f32_16x16x32_bf16 v[168:171], v[72:75], a[8:11], 0
    buffer_load_dwordx4 v[128:131], v251, s[16:19], s43 offen offset:2048
    v_mfma_f32_16x16x32_bf16 v[168:171], v[76:79], a[24:27], v[168:171]
    v_mfma_f32_16x16x32_bf16 v[172:175], v[76:79], a[28:31], 0
    v_mfma_f32_16x16x32_bf16 v[172:175], v[72:75], a[12:15], v[172:175]
    s_waitcnt vmcnt(13)
    v_mfma_f32_16x16x32_bf16 v[160:163], v[80:83], a[32:35], v[160:163]
    buffer_load_dwordx4 v[132:135], v251, s[16:19], s43 offen offset:3072
    v_mfma_f32_16x16x32_bf16 v[160:163], v[84:87], a[48:51], v[160:163]
    v_cvt_pk_bf16_f32 v200, v144, v145
    v_cvt_pk_bf16_f32 v201, v146, v147
    v_mfma_f32_16x16x32_bf16 v[164:167], v[84:87], a[52:55], v[164:167]
    v_cvt_pk_bf16_f32 v202, v148, v149
    v_cvt_pk_bf16_f32 v203, v150, v151
    v_mfma_f32_16x16x32_bf16 v[164:167], v[80:83], a[36:39], v[164:167]
    v_cvt_pk_bf16_f32 v204, v152, v153
    v_cvt_pk_bf16_f32 v205, v154, v155
    v_mfma_f32_16x16x32_bf16 v[168:171], v[80:83], a[40:43], v[168:171]
    buffer_load_dwordx4 v[136:139], v251, s[16:19], s44 offen offset:0
    v_mfma_f32_16x16x32_bf16 v[168:171], v[84:87], a[56:59], v[168:171]
    v_cvt_pk_bf16_f32 v206, v156, v157
    v_cvt_pk_bf16_f32 v207, v158, v159
    v_mfma_f32_16x16x32_bf16 v[172:175], v[84:87], a[60:63], v[172:175]
    s_nop 0
    s_nop 0
    v_mfma_f32_16x16x32_bf16 v[172:175], v[80:83], a[44:47], v[172:175]
    s_nop 0
    s_waitcnt vmcnt(13)
    v_mfma_f32_16x16x32_bf16 v[160:163], v[88:91], a[64:67], v[160:163]
    s_nop 0
    s_nop 0
    v_mfma_f32_16x16x32_bf16 v[160:163], v[92:95], a[80:83], v[160:163]
    s_nop 0
    v_add_u32 v208, s53, v214
    ds_read_b64 v[0:1], v208
    v_mfma_f32_16x16x32_bf16 v[164:167], v[92:95], a[84:87], v[164:167]
    buffer_store_dwordx4 v[200:203], v251, s[12:15], s30 offen sc1
    v_add_u32 v208, s54, v214
    ds_read_b64 v[2:3], v208
    v_mfma_f32_16x16x32_bf16 v[164:167], v[88:91], a[68:71], v[164:167]
    v_add_u32 v208, s55, v214
    ds_read_b64 v[4:5], v208
    v_mfma_f32_16x16x32_bf16 v[168:171], v[88:91], a[72:75], v[168:171]
    buffer_load_dwordx4 v[140:143], v251, s[16:19], s44 offen offset:1024
    v_mfma_f32_16x16x32_bf16 v[168:171], v[92:95], a[88:91], v[168:171]
    v_add_u32 v208, s60, v214
    ds_read_b64 v[6:7], v208
    v_mfma_f32_16x16x32_bf16 v[172:175], v[92:95], a[92:95], v[172:175]
    buffer_store_dwordx4 v[204:207], v251, s[12:15], s30 offen offset:1024 sc1
    v_add_u32 v208, s61, v214
    ds_read_b64 v[8:9], v208
    v_mfma_f32_16x16x32_bf16 v[172:175], v[88:91], a[76:79], v[172:175]
    v_add_u32 v208, s62, v214
    ds_read_b64 v[10:11], v208
    s_waitcnt vmcnt(13)
    v_mfma_f32_16x16x32_bf16 v[160:163], v[96:99], a[96:99], v[160:163]
    s_lshl_b32 s25, s37, 5
    buffer_load_dwordx2 v[12:13], v252, s[8:11], s25 offen
    v_mfma_f32_16x16x32_bf16 v[160:163], v[100:103], a[112:115], v[160:163]
    s_lshl_b32 s25, s38, 5
    buffer_load_dwordx2 v[14:15], v252, s[8:11], s25 offen
    v_mfma_f32_16x16x32_bf16 v[164:167], v[100:103], a[116:119], v[164:167]
    v_mfma_f32_16x16x32_bf16 v[164:167], v[96:99], a[100:103], v[164:167]
    v_mfma_f32_16x16x32_bf16 v[168:171], v[96:99], a[104:107], v[168:171]
    v_mfma_f32_16x16x32_bf16 v[168:171], v[100:103], a[120:123], v[168:171]
    v_mfma_f32_16x16x32_bf16 v[172:175], v[100:103], a[124:127], v[172:175]
    v_mfma_f32_16x16x32_bf16 v[172:175], v[96:99], a[108:111], v[172:175]
    s_waitcnt vmcnt(12)
    v_mfma_f32_16x16x32_bf16 v[160:163], v[104:107], a[128:131], v[160:163]
    v_mfma_f32_16x16x32_bf16 v[160:163], v[108:111], a[144:147], v[160:163]
    v_mfma_f32_16x16x32_bf16 v[164:167], v[108:111], a[148:151], v[164:167]
    s_mov_b64 exec, 0xff
    buffer_load_dword v213, v212, s[12:15], s35 offen sc1
    s_mov_b64 exec, -1
    v_mfma_f32_16x16x32_bf16 v[164:167], v[104:107], a[132:135], v[164:167]
    v_mfma_f32_16x16x32_bf16 v[168:171], v[104:107], a[136:139], v[168:171]
    v_mfma_f32_16x16x32_bf16 v[168:171], v[108:111], a[152:155], v[168:171]
    v_mfma_f32_16x16x32_bf16 v[172:175], v[108:111], a[156:159], v[172:175]
    v_mfma_f32_16x16x32_bf16 v[172:175], v[104:107], a[140:143], v[172:175]
    s_waitcnt vmcnt(11)
    v_mfma_f32_16x16x32_bf16 v[160:163], v[112:115], a[160:163], v[160:163]
    v_mfma_f32_16x16x32_bf16 v[160:163], v[116:119], a[176:179], v[160:163]
    v_mfma_f32_16x16x32_bf16 v[164:167], v[116:119], a[180:183], v[164:167]
    v_mfma_f32_16x16x32_bf16 v[164:167], v[112:115], a[164:167], v[164:167]
    v_mfma_f32_16x16x32_bf16 v[168:171], v[112:115], a[168:171], v[168:171]
    v_mfma_f32_16x16x32_bf16 v[168:171], v[116:119], a[184:187], v[168:171]
    v_mfma_f32_16x16x32_bf16 v[172:175], v[116:119], a[188:191], v[172:175]
    v_mfma_f32_16x16x32_bf16 v[172:175], v[112:115], a[172:175], v[172:175]
    s_waitcnt vmcnt(9)
    v_mfma_f32_16x16x32_bf16 v[160:163], v[120:123], a[192:195], v[160:163]
    v_mfma_f32_16x16x32_bf16 v[160:163], v[124:127], a[208:211], v[160:163]
    v_mfma_f32_16x16x32_bf16 v[164:167], v[124:127], a[212:215], v[164:167]
    v_mfma_f32_16x16x32_bf16 v[164:167], v[120:123], a[196:199], v[164:167]
    v_mfma_f32_16x16x32_bf16 v[168:171], v[120:123], a[200:203], v[168:171]
    v_mfma_f32_16x16x32_bf16 v[168:171], v[124:127], a[216:219], v[168:171]
    v_mfma_f32_16x16x32_bf16 v[172:175], v[124:127], a[220:223], v[172:175]
    v_mfma_f32_16x16x32_bf16 v[172:175], v[120:123], a[204:207], v[172:175]
    s_waitcnt vmcnt(7)
    v_mfma_f32_16x16x32_bf16 v[160:163], v[128:131], a[224:227], v[160:163]
    v_mfma_f32_16x16x32_bf16 v[160:163], v[132:135], a[240:243], v[160:163]
    v_mfma_f32_16x16x32_bf16 v[164:167], v[132:135], a[244:247], v[164:167]
    v_mfma_f32_16x16x32_bf16 v[164:167], v[128:131], a[228:231], v[164:167]
    v_mfma_f32_16x16x32_bf16 v[168:171], v[128:131], a[232:235], v[168:171]
    v_mfma_f32_16x16x32_bf16 v[168:171], v[132:135], a[248:251], v[168:171]
    v_mfma_f32_16x16x32_bf16 v[172:175], v[132:135], a[252:255], v[172:175]
    v_mfma_f32_16x16x32_bf16 v[172:175], v[128:131], a[236:239], v[172:175]
    s_waitcnt vmcnt(4)
    v_mfma_f32_16x16x32_bf16 v[160:163], v[136:139], v[216:219], v[160:163]
    v_mfma_f32_16x16x32_bf16 v[160:163], v[140:143], v[232:235], v[160:163]
    v_mfma_f32_16x16x32_bf16 v[164:167], v[140:143], v[236:239], v[164:167]
    s_waitcnt vmcnt(0)
    s_barrier
    s_cmp_lg_u32 s20, 0
    s_cbranch_scc1 L_nof2
    s_mov_b64 exec, 1
    buffer_store_dword v253, v181, s[12:15], s57 offen sc1
    s_mov_b64 exec, -1
L_nof2:
    v_mfma_f32_16x16x32_bf16 v[164:167], v[136:139], v[220:223], v[164:167]
    v_mfma_f32_16x16x32_bf16 v[168:171], v[136:139], v[224:227], v[168:171]
    v_mfma_f32_16x16x32_bf16 v[168:171], v[140:143], v[240:243], v[168:171]
    v_mfma_f32_16x16x32_bf16 v[172:175], v[140:143], v[244:247], v[172:175]
    v_mfma_f32_16x16x32_bf16 v[172:175], v[136:139], v[228:231], v[172:175]
    s_add_u32 s33, s29, s74
    s_and_b32 s33, s33, 7
    s_lshl_b32 s30, s33, 11
    s_add_u32 s30, s30, s34
    s_waitcnt lgkmcnt(0)
    s_mov_b64 exec, 0xff
    v_cmp_gt_u32 vcc, 1, v213
    s_mov_b64 exec, -1
    s_nop 3
    s_cbranch_vccz L_fa
    s_mov_b64 exec, 0xff
    s_mov_b32 s27, 0
L_poll12:
    buffer_load_dword v213, v212, s[12:15], s35 offen offset:0 sc1
    s_waitcnt vmcnt(0)
    v_cmp_gt_u32 vcc, 1, v213
    s_add_u32 s27, s27, 1
    s_nop 3
    s_cbranch_vccz L_poll12_done
    s_cmp_ge_u32 s27, 0x4000
    s_cbranch_scc1 L_poll12_done
    s_sleep 4
    s_branch L_poll12
L_poll12_done:
    s_mov_b64 exec, -1
L_fa:
    s_sub_u32 s24, s29, s68
    s_and_b32 s24, s24, 7
    s_mul_i32 s24, s24, 2359296
    s_add_u32 s24, s24, s49
    s_lshl_b32 s25, s29, 11
    s_add_u32 s24, s24, s25
    buffer_load_dwordx4 v[16:19], v251, s[12:15], s24 offen offset:0 sc1
    buffer_load_dwordx4 v[20:23], v251, s[12:15], s24 offen offset:1024 sc1
    s_sub_u32 s24, s29, s69
    s_and_b32 s24, s24, 7
    s_mul_i32 s24, s24, 2359296
    s_add_u32 s24, s24, s49
    s_lshl_b32 s25, s29, 11
    s_add_u32 s24, s24, s25
    buffer_load_dwordx4 v[24:27], v251, s[12:15], s24 offen offset:0 sc1
    buffer_load_dwordx4 v[28:31], v251, s[12:15], s24 offen offset:1024 sc1
    s_sub_u32 s24, s29, s70
    s_and_b32 s24, s24, 7
    s_mul_i32 s24, s24, 2359296
    s_add_u32 s24, s24, s49
    s_lshl_b32 s25, s29, 11
    s_add_u32 s24, s24, s25
    buffer_load_dwordx4 v[32:35], v251, s[12:15], s24 offen offset:0 sc1
    buffer_load_dwordx4 v[36:39], v251, s[12:15], s24 offen offset:1024 sc1
    s_sub_u32 s24, s29, s71
    s_and_b32 s24, s24, 7
    s_mul_i32 s24, s24, 2359296
    s_add_u32 s24, s24, s49
    s_lshl_b32 s25, s29, 11
    s_add_u32 s24, s24, s25
    buffer_load_dwordx4 v[40:43], v251, s[12:15], s24 offen offset:0 sc1
    buffer_load_dwordx4 v[44:47], v251, s[12:15], s24 offen offset:1024 sc1
    s_sub_u32 s24, s29, s72
    s_and_b32 s24, s24, 7
    s_mul_i32 s24, s24, 2359296
    s_add_u32 s24, s24, s49
    s_lshl_b32 s25, s29, 11
    s_add_u32 s24, s24, s25
    buffer_load_dwordx4 v[48:51], v251, s[12:15], s24 offen offset:0 sc1
    buffer_load_dwordx4 v[52:55], v251, s[12:15], s24 offen offset:1024 sc1
    s_cmp_eq_u32 s39, 0
    s_cbranch_scc1 L_nox8a
    s_add_u32 s26, s49, 16384
    s_and_b32 s25, s29, 1
    s_lshl_b32 s25, s25, 10
    s_add_u32 s26, s26, s25
    s_cmp_eq_u32 s39, 1
    s_cselect_b32 s26, s26, 0x2800000
    buffer_load_dwordx4 v[72:75], v251, s[12:15], s26 offen sc1
    s_add_u32 s26, s26, 2359296
    buffer_load_dwordx4 v[76:79], v251, s[12:15], s26 offen sc1
    s_add_u32 s26, s26, 2359296
    buffer_load_dwordx4 v[80:83], v251, s[12:15], s26 offen sc1
    s_add_u32 s26, s26, 2359296
    buffer_load_dwordx4 v[84:87], v251, s[12:15], s26 offen sc1
    s_add_u32 s26, s26, 2359296
    buffer_load_dwordx4 v[88:91], v251, s[12:15], s26 offen sc1
    s_add_u32 s26, s26, 2359296
    buffer_load_dwordx4 v[92:95], v251, s[12:15], s26 offen sc1
    s_add_u32 s26, s26, 2359296
    buffer_load_dwordx4 v[96:99], v251, s[12:15], s26 offen sc1
    s_add_u32 s26, s26, 2359296
    buffer_load_dwordx4 v[100:103], v251, s[12:15], s26 offen sc1
    s_add_u32 s26, s26, 2359296
L_nox8a:
    s_waitcnt vmcnt(8)
    v_lshlrev_b32 v120, 16, v0
    v_and_b32 v121, s59, v0
    v_lshlrev_b32 v122, 16, v1
    v_and_b32 v123, s59, v1
    v_pk_add_f32 v[160:161], v[160:161], v[120:121]
    v_pk_add_f32 v[162:163], v[162:163], v[122:123]
    v_lshlrev_b32 v120, 16, v12
    v_and_b32 v121, s59, v12
    v_lshlrev_b32 v122, 16, v13
    v_and_b32 v123, s59, v13
    v_pk_add_f32 v[160:161], v[160:161], v[120:121]
    v_pk_add_f32 v[162:163], v[162:163], v[122:123]
    v_lshlrev_b32 v120, 16, v2
    v_and_b32 v121, s59, v2
    v_lshlrev_b32 v122, 16, v3
    v_and_b32 v123, s59, v3
    v_pk_add_f32 v[164:165], v[164:165], v[120:121]
    v_pk_add_f32 v[166:167], v[166:167], v[122:123]
    v_lshlrev_b32 v120, 16, v12
    v_and_b32 v121, s59, v12
    v_lshlrev_b32 v122, 16, v13
    v_and_b32 v123, s59, v13
    v_pk_add_f32 v[164:165], v[164:165], v[120:121]
    v_pk_add_f32 v[166:167], v[166:167], v[122:123]
    v_lshlrev_b32 v120, 16, v4
    v_and_b32 v121, s59, v4
    v_lshlrev_b32 v122, 16, v5
    v_and_b32 v123, s59, v5
    v_pk_add_f32 v[168:169], v[168:169], v[120:121]
    v_pk_add_f32 v[170:171], v[170:171], v[122:123]
    v_lshlrev_b32 v120, 16, v12
    v_and_b32 v121, s59, v12
    v_lshlrev_b32 v122, 16, v13
    v_and_b32 v123, s59, v13
    v_pk_add_f32 v[168:169], v[168:169], v[120:121]
    v_pk_add_f32 v[170:171], v[170:171], v[122:123]
    v_lshlrev_b32 v120, 16, v6
    v_and_b32 v121, s59, v6
    v_lshlrev_b32 v122, 16, v7
    v_and_b32 v123, s59, v7
    v_pk_add_f32 v[172:173], v[172:173], v[120:121]
    v_pk_add_f32 v[174:175], v[174:175], v[122:123]
    v_lshlrev_b32 v120, 16, v12
    v_and_b32 v121, s59, v12
    v_lshlrev_b32 v122, 16, v13
    v_and_b32 v123, s59, v13
    v_pk_add_f32 v[172:173], v[172:173], v[120:121]
    v_pk_add_f32 v[174:175], v[174:175], v[122:123]
    v_lshlrev_b32 v120, 16, v16
    v_and_b32 v121, s59, v16
    v_lshlrev_b32 v122, 16, v17
    v_and_b32 v123, s59, v17
    v_pk_add_f32 v[160:161], v[160:161], v[120:121]
    v_pk_add_f32 v[162:163], v[162:163], v[122:123]
    v_lshlrev_b32 v120, 16, v18
    v_and_b32 v121, s59, v18
    v_lshlrev_b32 v122, 16, v19
    v_and_b32 v123, s59, v19
    v_pk_add_f32 v[164:165], v[164:165], v[120:121]
    v_pk_add_f32 v[166:167], v[166:167], v[122:123]
    v_lshlrev_b32 v120, 16, v20
    v_and_b32 v121, s59, v20
    v_lshlrev_b32 v122, 16, v21
    v_and_b32 v123, s59, v21
    v_pk_add_f32 v[168:169], v[168:169], v[120:121]
    v_pk_add_f32 v[170:171], v[170:171], v[122:123]
    v_lshlrev_b32 v120, 16, v22
    v_and_b32 v121, s59, v22
    v_lshlrev_b32 v122, 16, v23
    v_and_b32 v123, s59, v23
    v_pk_add_f32 v[172:173], v[172:173], v[120:121]
    v_pk_add_f32 v[174:175], v[174:175], v[122:123]
    s_waitcnt vmcnt(6)
    v_lshlrev_b32 v120, 16, v24
    v_and_b32 v121, s59, v24
    v_lshlrev_b32 v122, 16, v25
    v_and_b32 v123, s59, v25
    v_pk_add_f32 v[160:161], v[160:161], v[120:121]
    v_pk_add_f32 v[162:163], v[162:163], v[122:123]
    v_lshlrev_b32 v120, 16, v26
    v_and_b32 v121, s59, v26
    v_lshlrev_b32 v122, 16, v27
    v_and_b32 v123, s59, v27
    v_pk_add_f32 v[164:165], v[164:165], v[120:121]
    v_pk_add_f32 v[166:167], v[166:167], v[122:123]
    v_lshlrev_b32 v120, 16, v28
    v_and_b32 v121, s59, v28
    v_lshlrev_b32 v122, 16, v29
    v_and_b32 v123, s59, v29
    v_pk_add_f32 v[168:169], v[168:169], v[120:121]
    v_pk_add_f32 v[170:171], v[170:171], v[122:123]
    v_lshlrev_b32 v120, 16, v30
    v_and_b32 v121, s59, v30
    v_lshlrev_b32 v122, 16, v31
    v_and_b32 v123, s59, v31
    v_pk_add_f32 v[172:173], v[172:173], v[120:121]
    v_pk_add_f32 v[174:175], v[174:175], v[122:123]
    s_waitcnt vmcnt(4)
    v_lshlrev_b32 v120, 16, v32
    v_and_b32 v121, s59, v32
    v_lshlrev_b32 v122, 16, v33
    v_and_b32 v123, s59, v33
    v_pk_add_f32 v[160:161], v[160:161], v[120:121]
    v_pk_add_f32 v[162:163], v[162:163], v[122:123]
    v_lshlrev_b32 v120, 16, v34
    v_and_b32 v121, s59, v34
    v_lshlrev_b32 v122, 16, v35
    v_and_b32 v123, s59, v35
    v_pk_add_f32 v[164:165], v[164:165], v[120:121]
    v_pk_add_f32 v[166:167], v[166:167], v[122:123]
    v_lshlrev_b32 v120, 16, v36
    v_and_b32 v121, s59, v36
    v_lshlrev_b32 v122, 16, v37
    v_and_b32 v123, s59, v37
    v_pk_add_f32 v[168:169], v[168:169], v[120:121]
    v_pk_add_f32 v[170:171], v[170:171], v[122:123]
    v_lshlrev_b32 v120, 16, v38
    v_and_b32 v121, s59, v38
    v_lshlrev_b32 v122, 16, v39
    v_and_b32 v123, s59, v39
    v_pk_add_f32 v[172:173], v[172:173], v[120:121]
    v_pk_add_f32 v[174:175], v[174:175], v[122:123]
    s_waitcnt vmcnt(2)
    v_lshlrev_b32 v120, 16, v40
    v_and_b32 v121, s59, v40
    v_lshlrev_b32 v122, 16, v41
    v_and_b32 v123, s59, v41
    v_pk_add_f32 v[160:161], v[160:161], v[120:121]
    v_pk_add_f32 v[162:163], v[162:163], v[122:123]
    v_lshlrev_b32 v120, 16, v42
    v_and_b32 v121, s59, v42
    v_lshlrev_b32 v122, 16, v43
    v_and_b32 v123, s59, v43
    v_pk_add_f32 v[164:165], v[164:165], v[120:121]
    v_pk_add_f32 v[166:167], v[166:167], v[122:123]
    v_lshlrev_b32 v120, 16, v44
    v_and_b32 v121, s59, v44
    v_lshlrev_b32 v122, 16, v45
    v_and_b32 v123, s59, v45
    v_pk_add_f32 v[168:169], v[168:169], v[120:121]
    v_pk_add_f32 v[170:171], v[170:171], v[122:123]
    v_lshlrev_b32 v120, 16, v46
    v_and_b32 v121, s59, v46
    v_lshlrev_b32 v122, 16, v47
    v_and_b32 v123, s59, v47
    v_pk_add_f32 v[172:173], v[172:173], v[120:121]
    v_pk_add_f32 v[174:175], v[174:175], v[122:123]
    s_waitcnt vmcnt(0)
    v_lshlrev_b32 v120, 16, v48
    v_and_b32 v121, s59, v48
    v_lshlrev_b32 v122, 16, v49
    v_and_b32 v123, s59, v49
    v_pk_add_f32 v[160:161], v[160:161], v[120:121]
    v_pk_add_f32 v[162:163], v[162:163], v[122:123]
    v_lshlrev_b32 v120, 16, v50
    v_and_b32 v121, s59, v50
    v_lshlrev_b32 v122, 16, v51
    v_and_b32 v123, s59, v51
    v_pk_add_f32 v[164:165], v[164:165], v[120:121]
    v_pk_add_f32 v[166:167], v[166:167], v[122:123]
    v_lshlrev_b32 v120, 16, v52
    v_and_b32 v121, s59, v52
    v_lshlrev_b32 v122, 16, v53
    v_and_b32 v123, s59, v53
    v_pk_add_f32 v[168:169], v[168:169], v[120:121]
    v_pk_add_f32 v[170:171], v[170:171], v[122:123]
    v_lshlrev_b32 v120, 16, v54
    v_and_b32 v121, s59, v54
    v_lshlrev_b32 v122, 16, v55
    v_and_b32 v123, s59, v55
    v_pk_add_f32 v[172:173], v[172:173], v[120:121]
    v_pk_add_f32 v[174:175], v[174:175], v[122:123]
    s_cmp_eq_u32 s39, 0
    s_cbranch_scc1 L_nox8b
    v_mov_b32 v144, 0
    v_mov_b32 v145, 0
    v_mov_b32 v146, 0
    v_mov_b32 v147, 0
    v_mov_b32 v148, 0
    v_mov_b32 v149, 0
    v_mov_b32 v150, 0
    v_mov_b32 v151, 0
    v_lshlrev_b32 v120, 16, v8
    v_and_b32 v121, s59, v8
    v_lshlrev_b32 v122, 16, v9
    v_and_b32 v123, s59, v9
    v_pk_add_f32 v[144:145], v[144:145], v[120:121]
    v_pk_add_f32 v[146:147], v[146:147], v[122:123]
    v_lshlrev_b32 v120, 16, v14
    v_and_b32 v121, s59, v14
    v_lshlrev_b32 v122, 16, v15
    v_and_b32 v123, s59, v15
    v_pk_add_f32 v[144:145], v[144:145], v[120:121]
    v_pk_add_f32 v[146:147], v[146:147], v[122:123]
    v_lshlrev_b32 v120, 16, v10
    v_and_b32 v121, s59, v10
    v_lshlrev_b32 v122, 16, v11
    v_and_b32 v123, s59, v11
    v_pk_add_f32 v[148:149], v[148:149], v[120:121]
    v_pk_add_f32 v[150:151], v[150:151], v[122:123]
    v_lshlrev_b32 v120, 16, v14
    v_and_b32 v121, s59, v14
    v_lshlrev_b32 v122, 16, v15
    v_and_b32 v123, s59, v15
    v_pk_add_f32 v[148:149], v[148:149], v[120:121]
    v_pk_add_f32 v[150:151], v[150:151], v[122:123]
    v_lshlrev_b32 v120, 16, v72
    v_and_b32 v121, s59, v72
    v_lshlrev_b32 v122, 16, v73
    v_and_b32 v123, s59, v73
    v_pk_add_f32 v[144:145], v[144:145], v[120:121]
    v_pk_add_f32 v[146:147], v[146:147], v[122:123]
    v_lshlrev_b32 v120, 16, v74
    v_and_b32 v121, s59, v74
    v_lshlrev_b32 v122, 16, v75
    v_and_b32 v123, s59, v75
    v_pk_add_f32 v[148:149], v[148:149], v[120:121]
    v_pk_add_f32 v[150:151], v[150:151], v[122:123]
    v_lshlrev_b32 v120, 16, v76
    v_and_b32 v121, s59, v76
    v_lshlrev_b32 v122, 16, v77
    v_and_b32 v123, s59, v77
    v_pk_add_f32 v[144:145], v[144:145], v[120:121]
    v_pk_add_f32 v[146:147], v[146:147], v[122:123]
    v_lshlrev_b32 v120, 16, v78
    v_and_b32 v121, s59, v78
    v_lshlrev_b32 v122, 16, v79
    v_and_b32 v123, s59, v79
    v_pk_add_f32 v[148:149], v[148:149], v[120:121]
    v_pk_add_f32 v[150:151], v[150:151], v[122:123]
    v_lshlrev_b32 v120, 16, v80
    v_and_b32 v121, s59, v80
    v_lshlrev_b32 v122, 16, v81
    v_and_b32 v123, s59, v81
    v_pk_add_f32 v[144:145], v[144:145], v[120:121]
    v_pk_add_f32 v[146:147], v[146:147], v[122:123]
    v_lshlrev_b32 v120, 16, v82
    v_and_b32 v121, s59, v82
    v_lshlrev_b32 v122, 16, v83
    v_and_b32 v123, s59, v83
    v_pk_add_f32 v[148:149], v[148:149], v[120:121]
    v_pk_add_f32 v[150:151], v[150:151], v[122:123]
    v_lshlrev_b32 v120, 16, v84
    v_and_b32 v121, s59, v84
    v_lshlrev_b32 v122, 16, v85
    v_and_b32 v123, s59, v85
    v_pk_add_f32 v[144:145], v[144:145], v[120:121]
    v_pk_add_f32 v[146:147], v[146:147], v[122:123]
    v_lshlrev_b32 v120, 16, v86
    v_and_b32 v121, s59, v86
    v_lshlrev_b32 v122, 16, v87
    v_and_b32 v123, s59, v87
    v_pk_add_f32 v[148:149], v[148:149], v[120:121]
    v_pk_add_f32 v[150:151], v[150:151], v[122:123]
    v_lshlrev_b32 v120, 16, v88
    v_and_b32 v121, s59, v88
    v_lshlrev_b32 v122, 16, v89
    v_and_b32 v123, s59, v89
    v_pk_add_f32 v[144:145], v[144:145], v[120:121]
    v_pk_add_f32 v[146:147], v[146:147], v[122:123]
    v_lshlrev_b32 v120, 16, v90
    v_and_b32 v121, s59, v90
    v_lshlrev_b32 v122, 16, v91
    v_and_b32 v123, s59, v91
    v_pk_add_f32 v[148:149], v[148:149], v[120:121]
    v_pk_add_f32 v[150:151], v[150:151], v[122:123]
    v_lshlrev_b32 v120, 16, v92
    v_and_b32 v121, s59, v92
    v_lshlrev_b32 v122, 16, v93
    v_and_b32 v123, s59, v93
    v_pk_add_f32 v[144:145], v[144:145], v[120:121]
    v_pk_add_f32 v[146:147], v[146:147], v[122:123]
    v_lshlrev_b32 v120, 16, v94
    v_and_b32 v121, s59, v94
    v_lshlrev_b32 v122, 16, v95
    v_and_b32 v123, s59, v95
    v_pk_add_f32 v[148:149], v[148:149], v[120:121]
    v_pk_add_f32 v[150:151], v[150:151], v[122:123]
    v_lshlrev_b32 v120, 16, v96
    v_and_b32 v121, s59, v96
    v_lshlrev_b32 v122, 16, v97
    v_and_b32 v123, s59, v97
    v_pk_add_f32 v[144:145], v[144:145], v[120:121]
    v_pk_add_f32 v[146:147], v[146:147], v[122:123]
    v_lshlrev_b32 v120, 16, v98
    v_and_b32 v121, s59, v98
    v_lshlrev_b32 v122, 16, v99
    v_and_b32 v123, s59, v99
    v_pk_add_f32 v[148:149], v[148:149], v[120:121]
    v_pk_add_f32 v[150:151], v[150:151], v[122:123]
    v_lshlrev_b32 v120, 16, v100
    v_and_b32 v121, s59, v100
    v_lshlrev_b32 v122, 16, v101
    v_and_b32 v123, s59, v101
    v_pk_add_f32 v[144:145], v[144:145], v[120:121]
    v_pk_add_f32 v[146:147], v[146:147], v[122:123]
    v_lshlrev_b32 v120, 16, v102
    v_and_b32 v121, s59, v102
    v_lshlrev_b32 v122, 16, v103
    v_and_b32 v123, s59, v103
    v_pk_add_f32 v[148:149], v[148:149], v[120:121]
    v_pk_add_f32 v[150:151], v[150:151], v[122:123]
    v_cvt_pk_bf16_f32 v144, v144, v145
    v_cvt_pk_bf16_f32 v145, v146, v147
    v_cvt_pk_bf16_f32 v146, v148, v149
    v_cvt_pk_bf16_f32 v147, v150, v151
    s_nop 1
    v_permlane16_swap_b32 v144, v146
    v_permlane16_swap_b32 v145, v147
    buffer_store_dwordx4 v[144:147], v215, s[4:7], s52 offen
L_nox8b:
    s_cmp_lg_u32 s20, 0
    s_cbranch_scc1 L_nop4
    s_mov_b64 exec, 0xff
    s_mov_b32 s27, 0
L_poll13:
    buffer_load_dword v213, v212, s[12:15], s57 offen offset:0 sc1
    s_waitcnt vmcnt(0)
    v_cmp_ne_u32 vcc, 1, v213
    s_add_u32 s27, s27, 1
    s_nop 3
    s_cbranch_vccz L_poll13_done
    s_cmp_ge_u32 s27, 0x4000
    s_cbranch_scc1 L_poll13_done
    s_sleep 1
    s_branch L_poll13
L_poll13_done:
    s_mov_b64 exec, -1
L_nop4:
    s_barrier
    s_sub_u32 s24, s29, s73
    s_and_b32 s24, s24, 7
    s_mul_i32 s24, s24, 2359296
    s_add_u32 s24, s24, s49
    s_lshl_b32 s25, s29, 11
    s_add_u32 s24, s24, s25
    buffer_load_dwordx4 v[56:59], v251, s[12:15], s24 offen offset:0 sc1
    buffer_load_dwordx4 v[60:63], v251, s[12:15], s24 offen offset:1024 sc1
    s_sub_u32 s24, s29, s74
    s_and_b32 s24, s24, 7
    s_mul_i32 s24, s24, 2359296
    s_add_u32 s24, s24, s49
    s_lshl_b32 s25, s29, 11
    s_add_u32 s24, s24, s25
    buffer_load_dwordx4 v[64:67], v251, s[12:15], s24 offen offset:0 sc1
    buffer_load_dwordx4 v[68:71], v251, s[12:15], s24 offen offset:1024 sc1
L_last:
    s_waitcnt vmcnt(2)
    v_lshlrev_b32 v120, 16, v56
    v_and_b32 v121, s59, v56
    v_lshlrev_b32 v122, 16, v57
    v_and_b32 v123, s59, v57
    v_pk_add_f32 v[160:161], v[160:161], v[120:121]
    v_pk_add_f32 v[162:163], v[162:163], v[122:123]
    v_lshlrev_b32 v120, 16, v58
    v_and_b32 v121, s59, v58
    v_lshlrev_b32 v122, 16, v59
    v_and_b32 v123, s59, v59
    v_pk_add_f32 v[164:165], v[164:165], v[120:121]
    v_pk_add_f32 v[166:167], v[166:167], v[122:123]
    v_lshlrev_b32 v120, 16, v60
    v_and_b32 v121, s59, v60
    v_lshlrev_b32 v122, 16, v61
    v_and_b32 v123, s59, v61
    v_pk_add_f32 v[168:169], v[168:169], v[120:121]
    v_pk_add_f32 v[170:171], v[170:171], v[122:123]
    v_lshlrev_b32 v120, 16, v62
    v_and_b32 v121, s59, v62
    v_lshlrev_b32 v122, 16, v63
    v_and_b32 v123, s59, v63
    v_pk_add_f32 v[172:173], v[172:173], v[120:121]
    v_pk_add_f32 v[174:175], v[174:175], v[122:123]
    s_waitcnt vmcnt(1)
    v_lshlrev_b32 v120, 16, v64
    v_and_b32 v121, s59, v64
    v_lshlrev_b32 v122, 16, v65
    v_and_b32 v123, s59, v65
    v_pk_add_f32 v[160:161], v[160:161], v[120:121]
    v_pk_add_f32 v[162:163], v[162:163], v[122:123]
    v_lshlrev_b32 v120, 16, v66
    v_and_b32 v121, s59, v66
    v_lshlrev_b32 v122, 16, v67
    v_and_b32 v123, s59, v67
    v_pk_add_f32 v[164:165], v[164:165], v[120:121]
    v_pk_add_f32 v[166:167], v[166:167], v[122:123]
    v_cvt_pk_bf16_f32 v160, v160, v161
    v_cvt_pk_bf16_f32 v161, v162, v163
    v_cvt_pk_bf16_f32 v162, v164, v165
    v_cvt_pk_bf16_f32 v163, v166, v167
    s_nop 1
    v_permlane16_swap_b32 v160, v162
    v_permlane16_swap_b32 v161, v163
    buffer_store_dwordx4 v[160:163], v215, s[4:7], s50 offen
    s_waitcnt vmcnt(1)
    v_lshlrev_b32 v120, 16, v68
    v_and_b32 v121, s59, v68
    v_lshlrev_b32 v122, 16, v69
    v_and_b32 v123, s59, v69
    v_pk_add_f32 v[168:169], v[168:169], v[120:121]
    v_pk_add_f32 v[170:171], v[170:171], v[122:123]
    v_lshlrev_b32 v120, 16, v70
    v_and_b32 v121, s59, v70
    v_lshlrev_b32 v122, 16, v71
    v_and_b32 v123, s59, v71
    v_pk_add_f32 v[172:173], v[172:173], v[120:121]
    v_pk_add_f32 v[174:175], v[174:175], v[122:123]
    v_cvt_pk_bf16_f32 v168, v168, v169
    v_cvt_pk_bf16_f32 v169, v170, v171
    v_cvt_pk_bf16_f32 v170, v172, v173
    v_cvt_pk_bf16_f32 v171, v174, v175
    s_nop 1
    v_permlane16_swap_b32 v168, v170
    v_permlane16_swap_b32 v169, v171
    buffer_store_dwordx4 v[168:171], v215, s[4:7], s51 offen
L_end:
    s_endpgm
.section .rodata,"a"
.p2align 6
.amdhsa_kernel sequential_preLN__linear_attn_block__dense_activation_squared_relu__prompt_kernel
  .amdhsa_next_free_vgpr 512
  .amdhsa_next_free_sgpr 102
  .amdhsa_accum_offset 256
  .amdhsa_group_segment_fixed_size 0
  .amdhsa_kernarg_size 88
  .amdhsa_user_sgpr_count 2
  .amdhsa_user_sgpr_kernarg_segment_ptr 1
  .amdhsa_system_sgpr_workgroup_id_x 1
.end_amdhsa_kernel
```
